```python
import torch

def _softmax(x, axis=-1):
    return torch.softmax(x, dim=axis)
def _gelu(x):
    return torch.nn.functional.gelu(x, approximate="tanh")
def _silu(x):
    return torch.nn.functional.silu(x)
def _sigmoid(x):
    return torch.sigmoid(x)
def _layernorm(x, axis=-1, eps=1e-5):
    m = x.mean(dim=axis, keepdim=True)
    v = x.var(dim=axis, keepdim=True, unbiased=False)
    return (x - m) / torch.sqrt(v + eps)
def _scatter_add(tgt, idx, src, axis=0):
    return tgt.clone().index_add_(axis, idx, src)
def _segment_sum(src, seg, n):
    out = torch.zeros((n,) + src.shape[1:], dtype=src.dtype)
    return out.index_add_(0, seg, src)
def _pad(x, pw):
    flat = tuple(v for pair in reversed(pw) for v in pair)
    return torch.nn.functional.pad(x, flat)

kernel_name = 'sequential_preLN__ssm_conv_h3__mixer_s_mlp__prompt'

def setup_inputs():

    _w = (lambda a: (lambda t: t.to(torch.bfloat16) if t.is_floating_point() else t)(torch.as_tensor(a)))
    def _A_setup():
        B, S, D = 1, 2048, 576
        ks = 4
        return {
            "q": _w((lambda *s: torch.randn(*s, dtype=torch.bfloat16) * 0.05)(B, S, D)),
            "k": _w((lambda *s: torch.randn(*s, dtype=torch.bfloat16) * 0.4)(B, S, D)),
            "v": _w((lambda *s: torch.randn(*s, dtype=torch.bfloat16) * 0.4)(B, S, D)),
            "shift_k": _w((lambda *s: torch.randn(*s, dtype=torch.bfloat16) * 0.4)(D, ks) * 0.5),
            "ssm_k": _w((lambda *s: torch.randn(*s, dtype=torch.bfloat16) * 0.4)(D, S) * (1.0 / S ** 0.5)),
            "ssm_D": _w((lambda *s: torch.randn(*s, dtype=torch.bfloat16) * 0.4)(D)),
        }
    _A_in = _A_setup()

    def _B_setup():
        B, S, D, F = 1, 2048, 576, 4608
        return {
            "x":  _w((lambda *s: torch.randn(*s, dtype=torch.bfloat16) * 0.05)(B, S, D)),
            "w1": _w((lambda *s: torch.randn(*s, dtype=torch.bfloat16) * 3.2)(D, D) * (D ** -0.5)),
            "w2": _w((lambda *s: torch.randn(*s, dtype=torch.bfloat16) * 3.2)(D, D) * (D ** -0.5)),
            "w3": _w((lambda *s: torch.randn(*s, dtype=torch.bfloat16) * 3.2)(D, F) * (D ** -0.5)),
            "w4": _w((lambda *s: torch.randn(*s, dtype=torch.bfloat16) * 1.6)(F, D) * (F ** -0.5)),
        }
    _B_in = _B_setup()

    return {
        "A_q": _A_in["q"],
        "A_k": _A_in["k"],
        "A_v": _A_in["v"],
        "A_shift_k": _A_in["shift_k"],
        "A_ssm_k": _A_in["ssm_k"],
        "A_ssm_D": _A_in["ssm_D"],
        "B_x": _B_in["x"],
        "B_w1": _B_in["w1"],
        "B_w2": _B_in["w2"],
        "B_w3": _B_in["w3"],
        "B_w4": _B_in["w4"],
    }

def reference(A_q, A_k, A_v, A_shift_k, A_ssm_k, A_ssm_D, B_x, B_w1, B_w2, B_w3, B_w4):
    def _A_ref(q, k, v, shift_k, ssm_k, ssm_D):
        B, S, D = q.shape
        ks = shift_k.shape[-1]
        k_pad = _pad(k, ((0, 0), (ks - 1, 0), (0, 0)))
        k_shift = torch.zeros_like(k)
        for t in range(ks):
            k_shift = k_shift + k_pad[:, t:t + S, :] * shift_k[:, ks - 1 - t][None, None, :]
        kv = k_shift * v
        L = 2 * S
        kv_pad = _pad(kv, ((0, 0), (0, S), (0, 0)))
        kf_pad = _pad(ssm_k, ((0, 0), (0, S)))
        kv_f = (lambda x, axes=(-2,-1): torch.fft.rfft2(x.float(), dim=axes))(kv_pad[:, None, :, :], axes=(1, 2))
        kf_f = (lambda x, axes=(-2,-1): torch.fft.rfft2(x.float(), dim=axes))(kf_pad[:, None, :], axes=(1, 2))
        kf_f = (lambda x, *d: x.permute(*d))(kf_f, 1, 2, 0)
        y_f = kv_f * kf_f[None, :, :, :]
        y = (lambda x, s, axes=(-2,-1): torch.fft.irfft2(x, s=s, dim=axes).to(torch.bfloat16))(y_f, (1, L), axes=(1, 2))[:, 0, :S, :]
        y = y + kv * ssm_D[None, None, :]
        return q * y

    def _B_ref(x, w1, w2, w3, w4):
        B, S, D = x.shape
        h = _gelu(_layernorm(x, axis=-1) @ w1)
        c = D // 4
        g0 = _pad(h[:, :, 0*c:1*c], ((0, 0), (1, 0), (0, 0)))[:, :S, :]
        g1 = _pad(h[:, :, 1*c:2*c], ((0, 0), (0, 1), (0, 0)))[:, 1:, :]
        g2 = _pad(h[:, :, 2*c:3*c], ((0, 0), (2, 0), (0, 0)))[:, :S, :]
        g3 = _pad(h[:, :, 3*c:   ], ((0, 0), (0, 2), (0, 0)))[:, 2:, :]
        hs = torch.concatenate([g0, g1, g2, g3], axis=-1) @ w2
        x1 = x + hs
        h2 = _gelu(_layernorm(x1, axis=-1) @ w3) @ w4
        return x1 + h2

    x = A_q
    h = x + _A_ref(_layernorm(x, axis=-1), A_k, A_v, A_shift_k, A_ssm_k, A_ssm_D)
    h2 = h + _B_ref(_layernorm(h, axis=-1), B_w1, B_w2, B_w3, B_w4)
    return h2
```

```asm
; @launch kernel=ka_kernel grid=(233,1,1) block=(512,1,1) lds=156672
; @launch kernel=kg_kernel grid=(256,1,1) block=(256,1,1) lds=147456
.amdgcn_target "amdgcn-amd-amdhsa--gfx950"
.text
.globl ka_kernel
.p2align 8
.type ka_kernel,@function
ka_kernel:
    s_load_dwordx16 s[16:31], s[0:1], 0
    s_load_dwordx8 s[32:39], s[0:1], 64
    s_load_dwordx4 s[40:43], s[0:1], 96
    s_cmp_ge_u32 s2, 233
    s_cbranch_scc1 L_ka_ker_exit_3
    s_cmp_ge_u32 s2, 225
    s_cbranch_scc1 L_ka_ker_qst_2
    s_cmp_ge_u32 s2, 144
    s_cbranch_scc1 L_ka_ker_prep_1
    s_and_b32 s3, s2, 7
    s_mul_i32 s3, s3, 18
    s_lshr_b32 s4, s2, 3
    s_add_u32 s3, s3, s4
    s_and_b32 s5, s4, 7
    v_lshrrev_b32 v2, 6, v0
    v_and_b32 v1, 63, v0
    v_readfirstlane_b32 s6, v2
    v_lshlrev_b32 v3, 4, v1
    s_waitcnt lgkmcnt(0)
    s_cmp_ge_u32 s6, 4
    s_cbranch_scc1 L_ka_ker_gwave_4
    s_lshl_b32 s7, s3, 2
    s_add_u32 s7, s7, s6
    s_lshl_b32 s7, s7, 12
    s_add_u32 s44, s24, s7
    s_addc_u32 s45, s25, 0
    s_mov_b32 s46, 4096
    s_mov_b32 s47, 0x20000
    v_subrev_u32 v4, 32, v3
    v_subrev_u32 v5, 16, v3
    buffer_load_dwordx4 v[16:19], v4, s[44:47], 0 offen
    buffer_load_dwordx4 v[20:23], v5, s[44:47], 0 offen
    buffer_load_dwordx4 v[24:27], v3, s[44:47], 0 offen offset:992
    buffer_load_dwordx4 v[28:31], v3, s[44:47], 0 offen offset:1008
    buffer_load_dwordx4 v[32:35], v3, s[44:47], 0 offen offset:2016
    buffer_load_dwordx4 v[36:39], v3, s[44:47], 0 offen offset:2032
    buffer_load_dwordx4 v[40:43], v3, s[44:47], 0 offen offset:3040
    buffer_load_dwordx4 v[44:47], v3, s[44:47], 0 offen offset:3056
    buffer_load_dwordx4 v[48:51], v3, s[44:47], 0 offen offset:4064
    buffer_load_dwordx4 v[52:55], v3, s[44:47], 0 offen offset:4080
    s_mul_i32 s8, s6, 5120
    s_add_u32 s8, s8, 136192
    v_add_u32 v10, s8, v3
    v_mov_b32 v112, 0
    v_mov_b32 v113, 0
    v_mov_b32 v114, 0
    v_mov_b32 v115, 0
    ds_write_b128 v10, v[112:115] offset:4096
    s_mul_i32 s7, s6, 34048
    v_add_u32 v10, s7, v3
    v_and_b32 v14, 15, v1
    v_add_u32 v11, 1, v14
    v_and_b32 v12, 7, v11
    v_lshrrev_b32 v11, 3, v11
    v_lshrrev_b32 v13, 4, v1
    v_add_u32 v11, v11, v13
    v_lshlrev_b32 v11, 4, v11
    s_movk_i32 s9, 4256
    v_mul_lo_u32 v12, v12, s9
    v_add3_u32 v11, v11, v12, s7
    v_lshlrev_b32 v14, 5, v14
    v_lshlrev_b32 v12, 4, v13
    v_sub_u32 v12, v12, v14
    v_add_u32 v12, s8, v12
    s_waitcnt vmcnt(0)
    ds_write_b128 v10, v[32:35] offset:2048
    v_alignbit_b32 v112, v33, v32, 16
    v_alignbit_b32 v113, v34, v33, 16
    v_alignbit_b32 v114, v35, v34, 16
    v_alignbit_b32 v115, v36, v35, 16
    ds_write_b128 v10, v[112:115] offset:6304
    v_mov_b32 v116, v33
    v_mov_b32 v117, v34
    v_mov_b32 v118, v35
    v_mov_b32 v119, v36
    ds_write_b128 v10, v[116:119] offset:10560
    v_alignbit_b32 v120, v34, v33, 16
    v_alignbit_b32 v121, v35, v34, 16
    v_alignbit_b32 v122, v36, v35, 16
    v_alignbit_b32 v123, v37, v36, 16
    ds_write_b128 v10, v[120:123] offset:14816
    ds_write_b128 v10, v[34:37] offset:19072
    v_alignbit_b32 v124, v35, v34, 16
    v_alignbit_b32 v125, v36, v35, 16
    v_alignbit_b32 v126, v37, v36, 16
    v_alignbit_b32 v127, v38, v37, 16
    ds_write_b128 v10, v[124:127] offset:23328
    v_mov_b32 v112, v35
    v_mov_b32 v113, v36
    v_mov_b32 v114, v37
    v_mov_b32 v115, v38
    ds_write_b128 v10, v[112:115] offset:27584
    v_alignbit_b32 v116, v36, v35, 16
    v_alignbit_b32 v117, v37, v36, 16
    v_alignbit_b32 v118, v38, v37, 16
    v_alignbit_b32 v119, v39, v38, 16
    ds_write_b128 v10, v[116:119] offset:31840
    ds_write_b128 v10, v[40:43] offset:3072
    v_alignbit_b32 v120, v41, v40, 16
    v_alignbit_b32 v121, v42, v41, 16
    v_alignbit_b32 v122, v43, v42, 16
    v_alignbit_b32 v123, v44, v43, 16
    ds_write_b128 v10, v[120:123] offset:7328
    v_mov_b32 v124, v41
    v_mov_b32 v125, v42
    v_mov_b32 v126, v43
    v_mov_b32 v127, v44
    ds_write_b128 v10, v[124:127] offset:11584
    v_alignbit_b32 v112, v42, v41, 16
    v_alignbit_b32 v113, v43, v42, 16
    v_alignbit_b32 v114, v44, v43, 16
    v_alignbit_b32 v115, v45, v44, 16
    ds_write_b128 v10, v[112:115] offset:15840
    ds_write_b128 v10, v[42:45] offset:20096
    v_alignbit_b32 v116, v43, v42, 16
    v_alignbit_b32 v117, v44, v43, 16
    v_alignbit_b32 v118, v45, v44, 16
    v_alignbit_b32 v119, v46, v45, 16
    ds_write_b128 v10, v[116:119] offset:24352
    v_mov_b32 v120, v43
    v_mov_b32 v121, v44
    v_mov_b32 v122, v45
    v_mov_b32 v123, v46
    ds_write_b128 v10, v[120:123] offset:28608
    v_alignbit_b32 v124, v44, v43, 16
    v_alignbit_b32 v125, v45, v44, 16
    v_alignbit_b32 v126, v46, v45, 16
    v_alignbit_b32 v127, v47, v46, 16
    ds_write_b128 v10, v[124:127] offset:32864
    s_mov_b64 exec, 3
    ds_write_b128 v10, v[48:51] offset:4096
    v_alignbit_b32 v112, v49, v48, 16
    v_alignbit_b32 v113, v50, v49, 16
    v_alignbit_b32 v114, v51, v50, 16
    v_alignbit_b32 v115, v52, v51, 16
    ds_write_b128 v10, v[112:115] offset:8352
    v_mov_b32 v116, v49
    v_mov_b32 v117, v50
    v_mov_b32 v118, v51
    v_mov_b32 v119, v52
    ds_write_b128 v10, v[116:119] offset:12608
    v_alignbit_b32 v120, v50, v49, 16
    v_alignbit_b32 v121, v51, v50, 16
    v_alignbit_b32 v122, v52, v51, 16
    v_alignbit_b32 v123, v53, v52, 16
    ds_write_b128 v10, v[120:123] offset:16864
    ds_write_b128 v10, v[50:53] offset:21120
    v_alignbit_b32 v124, v51, v50, 16
    v_alignbit_b32 v125, v52, v51, 16
    v_alignbit_b32 v126, v53, v52, 16
    v_alignbit_b32 v127, v54, v53, 16
    ds_write_b128 v10, v[124:127] offset:25376
    v_mov_b32 v112, v51
    v_mov_b32 v113, v52
    v_mov_b32 v114, v53
    v_mov_b32 v115, v54
    ds_write_b128 v10, v[112:115] offset:29632
    v_alignbit_b32 v116, v52, v51, 16
    v_alignbit_b32 v117, v53, v52, 16
    v_alignbit_b32 v118, v54, v53, 16
    v_alignbit_b32 v119, v55, v54, 16
    ds_write_b128 v10, v[116:119] offset:33888
    s_mov_b64 exec, -1
    ds_write_b128 v10, v[16:19] offset:0
    v_alignbit_b32 v120, v17, v16, 16
    v_alignbit_b32 v121, v18, v17, 16
    v_alignbit_b32 v122, v19, v18, 16
    v_alignbit_b32 v123, v20, v19, 16
    ds_write_b128 v10, v[120:123] offset:4256
    v_mov_b32 v124, v17
    v_mov_b32 v125, v18
    v_mov_b32 v126, v19
    v_mov_b32 v127, v20
    ds_write_b128 v10, v[124:127] offset:8512
    v_alignbit_b32 v112, v18, v17, 16
    v_alignbit_b32 v113, v19, v18, 16
    v_alignbit_b32 v114, v20, v19, 16
    v_alignbit_b32 v115, v21, v20, 16
    ds_write_b128 v10, v[112:115] offset:12768
    ds_write_b128 v10, v[18:21] offset:17024
    v_alignbit_b32 v116, v19, v18, 16
    v_alignbit_b32 v117, v20, v19, 16
    v_alignbit_b32 v118, v21, v20, 16
    v_alignbit_b32 v119, v22, v21, 16
    ds_write_b128 v10, v[116:119] offset:21280
    v_mov_b32 v120, v19
    v_mov_b32 v121, v20
    v_mov_b32 v122, v21
    v_mov_b32 v123, v22
    ds_write_b128 v10, v[120:123] offset:25536
    v_alignbit_b32 v124, v20, v19, 16
    v_alignbit_b32 v125, v21, v20, 16
    v_alignbit_b32 v126, v22, v21, 16
    v_alignbit_b32 v127, v23, v22, 16
    ds_write_b128 v10, v[124:127] offset:29792
    ds_write_b128 v10, v[24:27] offset:1024
    v_alignbit_b32 v112, v25, v24, 16
    v_alignbit_b32 v113, v26, v25, 16
    v_alignbit_b32 v114, v27, v26, 16
    v_alignbit_b32 v115, v28, v27, 16
    ds_write_b128 v10, v[112:115] offset:5280
    v_mov_b32 v116, v25
    v_mov_b32 v117, v26
    v_mov_b32 v118, v27
    v_mov_b32 v119, v28
    ds_write_b128 v10, v[116:119] offset:9536
    v_alignbit_b32 v120, v26, v25, 16
    v_alignbit_b32 v121, v27, v26, 16
    v_alignbit_b32 v122, v28, v27, 16
    v_alignbit_b32 v123, v29, v28, 16
    ds_write_b128 v10, v[120:123] offset:13792
    ds_write_b128 v10, v[26:29] offset:18048
    v_alignbit_b32 v124, v27, v26, 16
    v_alignbit_b32 v125, v28, v27, 16
    v_alignbit_b32 v126, v29, v28, 16
    v_alignbit_b32 v127, v30, v29, 16
    ds_write_b128 v10, v[124:127] offset:22304
    v_mov_b32 v112, v27
    v_mov_b32 v113, v28
    v_mov_b32 v114, v29
    v_mov_b32 v115, v30
    ds_write_b128 v10, v[112:115] offset:26560
    v_alignbit_b32 v116, v28, v27, 16
    v_alignbit_b32 v117, v29, v28, 16
    v_alignbit_b32 v118, v30, v29, 16
    v_alignbit_b32 v119, v31, v30, 16
    ds_write_b128 v10, v[116:119] offset:30816
    s_waitcnt lgkmcnt(0)
    ds_read_b128 a[0:3], v11 offset:2048
    ds_read_b128 a[4:7], v11 offset:2112
    ds_read_b128 a[8:11], v11 offset:2176
    ds_read_b128 a[12:15], v11 offset:2240
    ds_read_b128 a[16:19], v11 offset:2304
    ds_read_b128 a[20:23], v11 offset:2368
    ds_read_b128 a[24:27], v11 offset:2432
    ds_read_b128 a[28:31], v11 offset:2496
    ds_read_b128 a[32:35], v11 offset:2560
    ds_read_b128 a[36:39], v11 offset:2624
    ds_read_b128 a[40:43], v11 offset:2688
    ds_read_b128 a[44:47], v11 offset:2752
    ds_read_b128 a[48:51], v11 offset:2816
    ds_read_b128 a[52:55], v11 offset:2880
    ds_read_b128 a[56:59], v11 offset:2944
    ds_read_b128 a[60:63], v11 offset:3008
    ds_read_b128 a[64:67], v11 offset:3072
    ds_read_b128 a[68:71], v11 offset:3136
    ds_read_b128 a[72:75], v11 offset:3200
    ds_read_b128 a[76:79], v11 offset:3264
    ds_read_b128 a[80:83], v11 offset:3328
    ds_read_b128 a[84:87], v11 offset:3392
    ds_read_b128 a[88:91], v11 offset:3456
    ds_read_b128 a[92:95], v11 offset:3520
    ds_read_b128 a[96:99], v11 offset:3584
    ds_read_b128 a[100:103], v11 offset:3648
    ds_read_b128 a[104:107], v11 offset:3712
    ds_read_b128 a[108:111], v11 offset:3776
    ds_read_b128 a[112:115], v11 offset:3840
    ds_read_b128 a[116:119], v11 offset:3904
    ds_read_b128 a[120:123], v11 offset:3968
    ds_read_b128 a[124:127], v11 offset:4032
    s_waitcnt lgkmcnt(0)
    s_barrier
    ds_read_b128 v[48:51], v12 offset:4512
    ds_read_b128 v[52:55], v12 offset:4448
    ds_read_b128 v[56:59], v12 offset:4384
    ds_read_b128 v[60:63], v12 offset:4320
    ds_read_b128 v[64:67], v12 offset:4256
    s_waitcnt lgkmcnt(4)
    v_mfma_f32_16x16x32_bf16 v[32:35], a[28:31], v[48:51], 0
    v_mfma_f32_16x16x32_bf16 v[36:39], a[60:63], v[48:51], 0
    v_mfma_f32_16x16x32_bf16 v[40:43], a[92:95], v[48:51], 0
    v_mfma_f32_16x16x32_bf16 v[44:47], a[124:127], v[48:51], 0
    ds_read_b128 v[68:71], v12 offset:4192
    s_waitcnt lgkmcnt(4)
    v_mfma_f32_16x16x32_bf16 v[32:35], a[24:27], v[52:55], v[32:35]
    v_mfma_f32_16x16x32_bf16 v[36:39], a[56:59], v[52:55], v[36:39]
    v_mfma_f32_16x16x32_bf16 v[40:43], a[88:91], v[52:55], v[40:43]
    v_mfma_f32_16x16x32_bf16 v[44:47], a[120:123], v[52:55], v[44:47]
    ds_read_b128 v[48:51], v12 offset:4128
    s_waitcnt lgkmcnt(4)
    v_mfma_f32_16x16x32_bf16 v[32:35], a[20:23], v[56:59], v[32:35]
    v_mfma_f32_16x16x32_bf16 v[36:39], a[52:55], v[56:59], v[36:39]
    v_mfma_f32_16x16x32_bf16 v[40:43], a[84:87], v[56:59], v[40:43]
    v_mfma_f32_16x16x32_bf16 v[44:47], a[116:119], v[56:59], v[44:47]
    ds_read_b128 v[52:55], v12 offset:4064
    s_waitcnt lgkmcnt(4)
    v_mfma_f32_16x16x32_bf16 v[32:35], a[16:19], v[60:63], v[32:35]
    v_mfma_f32_16x16x32_bf16 v[36:39], a[48:51], v[60:63], v[36:39]
    v_mfma_f32_16x16x32_bf16 v[40:43], a[80:83], v[60:63], v[40:43]
    v_mfma_f32_16x16x32_bf16 v[44:47], a[112:115], v[60:63], v[44:47]
    ds_read_b128 v[56:59], v12 offset:4000
    s_waitcnt lgkmcnt(4)
    v_mfma_f32_16x16x32_bf16 v[32:35], a[12:15], v[64:67], v[32:35]
    v_mfma_f32_16x16x32_bf16 v[36:39], a[44:47], v[64:67], v[36:39]
    v_mfma_f32_16x16x32_bf16 v[40:43], a[76:79], v[64:67], v[40:43]
    v_mfma_f32_16x16x32_bf16 v[44:47], a[108:111], v[64:67], v[44:47]
    ds_read_b128 v[60:63], v12 offset:3936
    s_waitcnt lgkmcnt(4)
    v_mfma_f32_16x16x32_bf16 v[32:35], a[8:11], v[68:71], v[32:35]
    v_mfma_f32_16x16x32_bf16 v[36:39], a[40:43], v[68:71], v[36:39]
    v_mfma_f32_16x16x32_bf16 v[40:43], a[72:75], v[68:71], v[40:43]
    v_mfma_f32_16x16x32_bf16 v[44:47], a[104:107], v[68:71], v[44:47]
    ds_read_b128 v[64:67], v12 offset:3872
    s_waitcnt lgkmcnt(4)
    v_mfma_f32_16x16x32_bf16 v[32:35], a[4:7], v[48:51], v[32:35]
    v_mfma_f32_16x16x32_bf16 v[36:39], a[36:39], v[48:51], v[36:39]
    v_mfma_f32_16x16x32_bf16 v[40:43], a[68:71], v[48:51], v[40:43]
    v_mfma_f32_16x16x32_bf16 v[44:47], a[100:103], v[48:51], v[44:47]
    ds_read_b128 v[68:71], v12 offset:3808
    s_waitcnt lgkmcnt(4)
    v_mfma_f32_16x16x32_bf16 v[32:35], a[0:3], v[52:55], v[32:35]
    v_mfma_f32_16x16x32_bf16 v[36:39], a[32:35], v[52:55], v[36:39]
    v_mfma_f32_16x16x32_bf16 v[40:43], a[64:67], v[52:55], v[40:43]
    v_mfma_f32_16x16x32_bf16 v[44:47], a[96:99], v[52:55], v[44:47]
    ds_read_b128 v[48:51], v12 offset:3744
    s_waitcnt lgkmcnt(4)
    v_mfma_f32_16x16x32_bf16 v[36:39], a[28:31], v[56:59], v[36:39]
    v_mfma_f32_16x16x32_bf16 v[40:43], a[60:63], v[56:59], v[40:43]
    v_mfma_f32_16x16x32_bf16 v[44:47], a[92:95], v[56:59], v[44:47]
    ds_read_b128 v[52:55], v12 offset:3680
    s_waitcnt lgkmcnt(4)
    v_mfma_f32_16x16x32_bf16 v[36:39], a[24:27], v[60:63], v[36:39]
    v_mfma_f32_16x16x32_bf16 v[40:43], a[56:59], v[60:63], v[40:43]
    v_mfma_f32_16x16x32_bf16 v[44:47], a[88:91], v[60:63], v[44:47]
    ds_read_b128 v[56:59], v12 offset:3616
    s_waitcnt lgkmcnt(4)
    v_mfma_f32_16x16x32_bf16 v[36:39], a[20:23], v[64:67], v[36:39]
    v_mfma_f32_16x16x32_bf16 v[40:43], a[52:55], v[64:67], v[40:43]
    v_mfma_f32_16x16x32_bf16 v[44:47], a[84:87], v[64:67], v[44:47]
    ds_read_b128 v[60:63], v12 offset:3552
    s_waitcnt lgkmcnt(4)
    v_mfma_f32_16x16x32_bf16 v[36:39], a[16:19], v[68:71], v[36:39]
    v_mfma_f32_16x16x32_bf16 v[40:43], a[48:51], v[68:71], v[40:43]
    v_mfma_f32_16x16x32_bf16 v[44:47], a[80:83], v[68:71], v[44:47]
    ds_read_b128 v[64:67], v12 offset:3488
    s_waitcnt lgkmcnt(4)
    v_mfma_f32_16x16x32_bf16 v[36:39], a[12:15], v[48:51], v[36:39]
    v_mfma_f32_16x16x32_bf16 v[40:43], a[44:47], v[48:51], v[40:43]
    v_mfma_f32_16x16x32_bf16 v[44:47], a[76:79], v[48:51], v[44:47]
    ds_read_b128 v[68:71], v12 offset:3424
    s_waitcnt lgkmcnt(4)
    v_mfma_f32_16x16x32_bf16 v[36:39], a[8:11], v[52:55], v[36:39]
    v_mfma_f32_16x16x32_bf16 v[40:43], a[40:43], v[52:55], v[40:43]
    v_mfma_f32_16x16x32_bf16 v[44:47], a[72:75], v[52:55], v[44:47]
    ds_read_b128 v[48:51], v12 offset:3360
    s_waitcnt lgkmcnt(4)
    v_mfma_f32_16x16x32_bf16 v[36:39], a[4:7], v[56:59], v[36:39]
    v_mfma_f32_16x16x32_bf16 v[40:43], a[36:39], v[56:59], v[40:43]
    v_mfma_f32_16x16x32_bf16 v[44:47], a[68:71], v[56:59], v[44:47]
    ds_read_b128 v[52:55], v12 offset:3296
    s_waitcnt lgkmcnt(4)
    v_mfma_f32_16x16x32_bf16 v[36:39], a[0:3], v[60:63], v[36:39]
    v_mfma_f32_16x16x32_bf16 v[40:43], a[32:35], v[60:63], v[40:43]
    v_mfma_f32_16x16x32_bf16 v[44:47], a[64:67], v[60:63], v[44:47]
    ds_read_b128 v[56:59], v12 offset:3232
    s_waitcnt lgkmcnt(4)
    v_mfma_f32_16x16x32_bf16 v[40:43], a[28:31], v[64:67], v[40:43]
    v_mfma_f32_16x16x32_bf16 v[44:47], a[60:63], v[64:67], v[44:47]
    ds_read_b128 v[60:63], v12 offset:3168
    s_waitcnt lgkmcnt(4)
    v_mfma_f32_16x16x32_bf16 v[40:43], a[24:27], v[68:71], v[40:43]
    v_mfma_f32_16x16x32_bf16 v[44:47], a[56:59], v[68:71], v[44:47]
    ds_read_b128 v[64:67], v12 offset:3104
    s_waitcnt lgkmcnt(4)
    v_mfma_f32_16x16x32_bf16 v[40:43], a[20:23], v[48:51], v[40:43]
    v_mfma_f32_16x16x32_bf16 v[44:47], a[52:55], v[48:51], v[44:47]
    ds_read_b128 v[68:71], v12 offset:3040
    s_waitcnt lgkmcnt(4)
    v_mfma_f32_16x16x32_bf16 v[40:43], a[16:19], v[52:55], v[40:43]
    v_mfma_f32_16x16x32_bf16 v[44:47], a[48:51], v[52:55], v[44:47]
    ds_read_b128 v[48:51], v12 offset:2976
    s_waitcnt lgkmcnt(4)
    v_mfma_f32_16x16x32_bf16 v[40:43], a[12:15], v[56:59], v[40:43]
    v_mfma_f32_16x16x32_bf16 v[44:47], a[44:47], v[56:59], v[44:47]
    ds_read_b128 v[52:55], v12 offset:2912
    s_waitcnt lgkmcnt(4)
    v_mfma_f32_16x16x32_bf16 v[40:43], a[8:11], v[60:63], v[40:43]
    v_mfma_f32_16x16x32_bf16 v[44:47], a[40:43], v[60:63], v[44:47]
    ds_read_b128 v[56:59], v12 offset:2848
    s_waitcnt lgkmcnt(4)
    v_mfma_f32_16x16x32_bf16 v[40:43], a[4:7], v[64:67], v[40:43]
    v_mfma_f32_16x16x32_bf16 v[44:47], a[36:39], v[64:67], v[44:47]
    ds_read_b128 v[60:63], v12 offset:2784
    s_waitcnt lgkmcnt(4)
    v_mfma_f32_16x16x32_bf16 v[40:43], a[0:3], v[68:71], v[40:43]
    v_mfma_f32_16x16x32_bf16 v[44:47], a[32:35], v[68:71], v[44:47]
    ds_read_b128 v[64:67], v12 offset:2720
    s_waitcnt lgkmcnt(4)
    v_mfma_f32_16x16x32_bf16 v[44:47], a[28:31], v[48:51], v[44:47]
    ds_read_b128 v[68:71], v12 offset:2656
    s_waitcnt lgkmcnt(4)
    v_mfma_f32_16x16x32_bf16 v[44:47], a[24:27], v[52:55], v[44:47]
    ds_read_b128 v[48:51], v12 offset:2592
    s_waitcnt lgkmcnt(4)
    v_mfma_f32_16x16x32_bf16 v[44:47], a[20:23], v[56:59], v[44:47]
    ds_read_b128 v[52:55], v12 offset:2528
    s_waitcnt lgkmcnt(4)
    v_mfma_f32_16x16x32_bf16 v[44:47], a[16:19], v[60:63], v[44:47]
    s_waitcnt lgkmcnt(3)
    v_mfma_f32_16x16x32_bf16 v[44:47], a[12:15], v[64:67], v[44:47]
    s_waitcnt lgkmcnt(2)
    v_mfma_f32_16x16x32_bf16 v[44:47], a[8:11], v[68:71], v[44:47]
    s_waitcnt lgkmcnt(1)
    v_mfma_f32_16x16x32_bf16 v[44:47], a[4:7], v[48:51], v[44:47]
    s_waitcnt lgkmcnt(0)
    v_mfma_f32_16x16x32_bf16 v[44:47], a[0:3], v[52:55], v[44:47]
    s_nop 7
    ds_read_b128 a[0:3], v11 offset:0
    ds_read_b128 a[4:7], v11 offset:64
    ds_read_b128 a[8:11], v11 offset:128
    ds_read_b128 a[12:15], v11 offset:192
    ds_read_b128 a[16:19], v11 offset:256
    ds_read_b128 a[20:23], v11 offset:320
    ds_read_b128 a[24:27], v11 offset:384
    ds_read_b128 a[28:31], v11 offset:448
    ds_read_b128 a[32:35], v11 offset:512
    ds_read_b128 a[36:39], v11 offset:576
    ds_read_b128 a[40:43], v11 offset:640
    ds_read_b128 a[44:47], v11 offset:704
    ds_read_b128 a[48:51], v11 offset:768
    ds_read_b128 a[52:55], v11 offset:832
    ds_read_b128 a[56:59], v11 offset:896
    ds_read_b128 a[60:63], v11 offset:960
    ds_read_b128 a[64:67], v11 offset:1024
    ds_read_b128 a[68:71], v11 offset:1088
    ds_read_b128 a[72:75], v11 offset:1152
    ds_read_b128 a[76:79], v11 offset:1216
    ds_read_b128 a[80:83], v11 offset:1280
    ds_read_b128 a[84:87], v11 offset:1344
    ds_read_b128 a[88:91], v11 offset:1408
    ds_read_b128 a[92:95], v11 offset:1472
    ds_read_b128 a[96:99], v11 offset:1536
    ds_read_b128 a[100:103], v11 offset:1600
    ds_read_b128 a[104:107], v11 offset:1664
    ds_read_b128 a[108:111], v11 offset:1728
    ds_read_b128 a[112:115], v11 offset:1792
    ds_read_b128 a[116:119], v11 offset:1856
    ds_read_b128 a[120:123], v11 offset:1920
    ds_read_b128 a[124:127], v11 offset:1984
    s_waitcnt lgkmcnt(0)
    ds_read_b128 v[56:59], v12 offset:4512
    ds_read_b128 v[60:63], v12 offset:4448
    ds_read_b128 v[64:67], v12 offset:4384
    ds_read_b128 v[68:71], v12 offset:4320
    ds_read_b128 v[48:51], v12 offset:4256
    s_waitcnt lgkmcnt(4)
    v_mfma_f32_16x16x32_bf16 v[16:19], a[28:31], v[56:59], 0
    v_mfma_f32_16x16x32_bf16 v[20:23], a[60:63], v[56:59], 0
    v_mfma_f32_16x16x32_bf16 v[24:27], a[92:95], v[56:59], 0
    v_mfma_f32_16x16x32_bf16 v[28:31], a[124:127], v[56:59], 0
    ds_read_b128 v[52:55], v12 offset:4192
    s_waitcnt lgkmcnt(4)
    v_mfma_f32_16x16x32_bf16 v[16:19], a[24:27], v[60:63], v[16:19]
    v_mfma_f32_16x16x32_bf16 v[20:23], a[56:59], v[60:63], v[20:23]
    v_mfma_f32_16x16x32_bf16 v[24:27], a[88:91], v[60:63], v[24:27]
    v_mfma_f32_16x16x32_bf16 v[28:31], a[120:123], v[60:63], v[28:31]
    ds_read_b128 v[56:59], v12 offset:4128
    s_waitcnt lgkmcnt(4)
    v_mfma_f32_16x16x32_bf16 v[16:19], a[20:23], v[64:67], v[16:19]
    v_mfma_f32_16x16x32_bf16 v[20:23], a[52:55], v[64:67], v[20:23]
    v_mfma_f32_16x16x32_bf16 v[24:27], a[84:87], v[64:67], v[24:27]
    v_mfma_f32_16x16x32_bf16 v[28:31], a[116:119], v[64:67], v[28:31]
    ds_read_b128 v[60:63], v12 offset:4064
    s_waitcnt lgkmcnt(4)
    v_mfma_f32_16x16x32_bf16 v[16:19], a[16:19], v[68:71], v[16:19]
    v_mfma_f32_16x16x32_bf16 v[20:23], a[48:51], v[68:71], v[20:23]
    v_mfma_f32_16x16x32_bf16 v[24:27], a[80:83], v[68:71], v[24:27]
    v_mfma_f32_16x16x32_bf16 v[28:31], a[112:115], v[68:71], v[28:31]
    ds_read_b128 v[64:67], v12 offset:4000
    s_waitcnt lgkmcnt(4)
    v_mfma_f32_16x16x32_bf16 v[16:19], a[12:15], v[48:51], v[16:19]
    v_mfma_f32_16x16x32_bf16 v[20:23], a[44:47], v[48:51], v[20:23]
    v_mfma_f32_16x16x32_bf16 v[24:27], a[76:79], v[48:51], v[24:27]
    v_mfma_f32_16x16x32_bf16 v[28:31], a[108:111], v[48:51], v[28:31]
    ds_read_b128 v[68:71], v12 offset:3936
    s_waitcnt lgkmcnt(4)
    v_mfma_f32_16x16x32_bf16 v[16:19], a[8:11], v[52:55], v[16:19]
    v_mfma_f32_16x16x32_bf16 v[20:23], a[40:43], v[52:55], v[20:23]
    v_mfma_f32_16x16x32_bf16 v[24:27], a[72:75], v[52:55], v[24:27]
    v_mfma_f32_16x16x32_bf16 v[28:31], a[104:107], v[52:55], v[28:31]
    ds_read_b128 v[48:51], v12 offset:3872
    s_waitcnt lgkmcnt(4)
    v_mfma_f32_16x16x32_bf16 v[16:19], a[4:7], v[56:59], v[16:19]
    v_mfma_f32_16x16x32_bf16 v[20:23], a[36:39], v[56:59], v[20:23]
    v_mfma_f32_16x16x32_bf16 v[24:27], a[68:71], v[56:59], v[24:27]
    v_mfma_f32_16x16x32_bf16 v[28:31], a[100:103], v[56:59], v[28:31]
    ds_read_b128 v[52:55], v12 offset:3808
    s_waitcnt lgkmcnt(4)
    v_mfma_f32_16x16x32_bf16 v[16:19], a[0:3], v[60:63], v[16:19]
    v_mfma_f32_16x16x32_bf16 v[20:23], a[32:35], v[60:63], v[20:23]
    v_mfma_f32_16x16x32_bf16 v[24:27], a[64:67], v[60:63], v[24:27]
    v_mfma_f32_16x16x32_bf16 v[28:31], a[96:99], v[60:63], v[28:31]
    ds_read_b128 v[56:59], v12 offset:3744
    s_waitcnt lgkmcnt(4)
    v_mfma_f32_16x16x32_bf16 v[20:23], a[28:31], v[64:67], v[20:23]
    v_mfma_f32_16x16x32_bf16 v[24:27], a[60:63], v[64:67], v[24:27]
    v_mfma_f32_16x16x32_bf16 v[28:31], a[92:95], v[64:67], v[28:31]
    v_mfma_f32_16x16x32_bf16 v[32:35], a[124:127], v[64:67], v[32:35]
    ds_read_b128 v[60:63], v12 offset:3680
    s_waitcnt lgkmcnt(4)
    v_mfma_f32_16x16x32_bf16 v[20:23], a[24:27], v[68:71], v[20:23]
    v_mfma_f32_16x16x32_bf16 v[24:27], a[56:59], v[68:71], v[24:27]
    v_mfma_f32_16x16x32_bf16 v[28:31], a[88:91], v[68:71], v[28:31]
    v_mfma_f32_16x16x32_bf16 v[32:35], a[120:123], v[68:71], v[32:35]
    ds_read_b128 v[64:67], v12 offset:3616
    s_waitcnt lgkmcnt(4)
    v_mfma_f32_16x16x32_bf16 v[20:23], a[20:23], v[48:51], v[20:23]
    v_mfma_f32_16x16x32_bf16 v[24:27], a[52:55], v[48:51], v[24:27]
    v_mfma_f32_16x16x32_bf16 v[28:31], a[84:87], v[48:51], v[28:31]
    v_mfma_f32_16x16x32_bf16 v[32:35], a[116:119], v[48:51], v[32:35]
    ds_read_b128 v[68:71], v12 offset:3552
    s_waitcnt lgkmcnt(4)
    v_mfma_f32_16x16x32_bf16 v[20:23], a[16:19], v[52:55], v[20:23]
    v_mfma_f32_16x16x32_bf16 v[24:27], a[48:51], v[52:55], v[24:27]
    v_mfma_f32_16x16x32_bf16 v[28:31], a[80:83], v[52:55], v[28:31]
    v_mfma_f32_16x16x32_bf16 v[32:35], a[112:115], v[52:55], v[32:35]
    ds_read_b128 v[48:51], v12 offset:3488
    s_waitcnt lgkmcnt(4)
    v_mfma_f32_16x16x32_bf16 v[20:23], a[12:15], v[56:59], v[20:23]
    v_mfma_f32_16x16x32_bf16 v[24:27], a[44:47], v[56:59], v[24:27]
    v_mfma_f32_16x16x32_bf16 v[28:31], a[76:79], v[56:59], v[28:31]
    v_mfma_f32_16x16x32_bf16 v[32:35], a[108:111], v[56:59], v[32:35]
    ds_read_b128 v[52:55], v12 offset:3424
    s_waitcnt lgkmcnt(4)
    v_mfma_f32_16x16x32_bf16 v[20:23], a[8:11], v[60:63], v[20:23]
    v_mfma_f32_16x16x32_bf16 v[24:27], a[40:43], v[60:63], v[24:27]
    v_mfma_f32_16x16x32_bf16 v[28:31], a[72:75], v[60:63], v[28:31]
    v_mfma_f32_16x16x32_bf16 v[32:35], a[104:107], v[60:63], v[32:35]
    ds_read_b128 v[56:59], v12 offset:3360
    s_waitcnt lgkmcnt(4)
    v_mfma_f32_16x16x32_bf16 v[20:23], a[4:7], v[64:67], v[20:23]
    v_mfma_f32_16x16x32_bf16 v[24:27], a[36:39], v[64:67], v[24:27]
    v_mfma_f32_16x16x32_bf16 v[28:31], a[68:71], v[64:67], v[28:31]
    v_mfma_f32_16x16x32_bf16 v[32:35], a[100:103], v[64:67], v[32:35]
    ds_read_b128 v[60:63], v12 offset:3296
    s_waitcnt lgkmcnt(4)
    v_mfma_f32_16x16x32_bf16 v[20:23], a[0:3], v[68:71], v[20:23]
    v_mfma_f32_16x16x32_bf16 v[24:27], a[32:35], v[68:71], v[24:27]
    v_mfma_f32_16x16x32_bf16 v[28:31], a[64:67], v[68:71], v[28:31]
    v_mfma_f32_16x16x32_bf16 v[32:35], a[96:99], v[68:71], v[32:35]
    ds_read_b128 v[64:67], v12 offset:3232
    s_waitcnt lgkmcnt(4)
    v_mfma_f32_16x16x32_bf16 v[24:27], a[28:31], v[48:51], v[24:27]
    v_mfma_f32_16x16x32_bf16 v[28:31], a[60:63], v[48:51], v[28:31]
    v_mfma_f32_16x16x32_bf16 v[32:35], a[92:95], v[48:51], v[32:35]
    v_mfma_f32_16x16x32_bf16 v[36:39], a[124:127], v[48:51], v[36:39]
    ds_read_b128 v[68:71], v12 offset:3168
    s_waitcnt lgkmcnt(4)
    v_mfma_f32_16x16x32_bf16 v[24:27], a[24:27], v[52:55], v[24:27]
    v_mfma_f32_16x16x32_bf16 v[28:31], a[56:59], v[52:55], v[28:31]
    v_mfma_f32_16x16x32_bf16 v[32:35], a[88:91], v[52:55], v[32:35]
    v_mfma_f32_16x16x32_bf16 v[36:39], a[120:123], v[52:55], v[36:39]
    ds_read_b128 v[48:51], v12 offset:3104
    s_waitcnt lgkmcnt(4)
    v_mfma_f32_16x16x32_bf16 v[24:27], a[20:23], v[56:59], v[24:27]
    v_mfma_f32_16x16x32_bf16 v[28:31], a[52:55], v[56:59], v[28:31]
    v_mfma_f32_16x16x32_bf16 v[32:35], a[84:87], v[56:59], v[32:35]
    v_mfma_f32_16x16x32_bf16 v[36:39], a[116:119], v[56:59], v[36:39]
    ds_read_b128 v[52:55], v12 offset:3040
    s_waitcnt lgkmcnt(4)
    v_mfma_f32_16x16x32_bf16 v[24:27], a[16:19], v[60:63], v[24:27]
    v_mfma_f32_16x16x32_bf16 v[28:31], a[48:51], v[60:63], v[28:31]
    v_mfma_f32_16x16x32_bf16 v[32:35], a[80:83], v[60:63], v[32:35]
    v_mfma_f32_16x16x32_bf16 v[36:39], a[112:115], v[60:63], v[36:39]
    ds_read_b128 v[56:59], v12 offset:2976
    s_waitcnt lgkmcnt(4)
    v_mfma_f32_16x16x32_bf16 v[24:27], a[12:15], v[64:67], v[24:27]
    v_mfma_f32_16x16x32_bf16 v[28:31], a[44:47], v[64:67], v[28:31]
    v_mfma_f32_16x16x32_bf16 v[32:35], a[76:79], v[64:67], v[32:35]
    v_mfma_f32_16x16x32_bf16 v[36:39], a[108:111], v[64:67], v[36:39]
    ds_read_b128 v[60:63], v12 offset:2912
    s_waitcnt lgkmcnt(4)
    v_mfma_f32_16x16x32_bf16 v[24:27], a[8:11], v[68:71], v[24:27]
    v_mfma_f32_16x16x32_bf16 v[28:31], a[40:43], v[68:71], v[28:31]
    v_mfma_f32_16x16x32_bf16 v[32:35], a[72:75], v[68:71], v[32:35]
    v_mfma_f32_16x16x32_bf16 v[36:39], a[104:107], v[68:71], v[36:39]
    ds_read_b128 v[64:67], v12 offset:2848
    s_waitcnt lgkmcnt(4)
    v_mfma_f32_16x16x32_bf16 v[24:27], a[4:7], v[48:51], v[24:27]
    v_mfma_f32_16x16x32_bf16 v[28:31], a[36:39], v[48:51], v[28:31]
    v_mfma_f32_16x16x32_bf16 v[32:35], a[68:71], v[48:51], v[32:35]
    v_mfma_f32_16x16x32_bf16 v[36:39], a[100:103], v[48:51], v[36:39]
    ds_read_b128 v[68:71], v12 offset:2784
    s_waitcnt lgkmcnt(4)
    v_mfma_f32_16x16x32_bf16 v[24:27], a[0:3], v[52:55], v[24:27]
    v_mfma_f32_16x16x32_bf16 v[28:31], a[32:35], v[52:55], v[28:31]
    v_mfma_f32_16x16x32_bf16 v[32:35], a[64:67], v[52:55], v[32:35]
    v_mfma_f32_16x16x32_bf16 v[36:39], a[96:99], v[52:55], v[36:39]
    ds_read_b128 v[48:51], v12 offset:2720
    s_waitcnt lgkmcnt(4)
    v_mfma_f32_16x16x32_bf16 v[28:31], a[28:31], v[56:59], v[28:31]
    v_mfma_f32_16x16x32_bf16 v[32:35], a[60:63], v[56:59], v[32:35]
    v_mfma_f32_16x16x32_bf16 v[36:39], a[92:95], v[56:59], v[36:39]
    v_mfma_f32_16x16x32_bf16 v[40:43], a[124:127], v[56:59], v[40:43]
    ds_read_b128 v[52:55], v12 offset:2656
    s_waitcnt lgkmcnt(4)
    v_mfma_f32_16x16x32_bf16 v[28:31], a[24:27], v[60:63], v[28:31]
    v_mfma_f32_16x16x32_bf16 v[32:35], a[56:59], v[60:63], v[32:35]
    v_mfma_f32_16x16x32_bf16 v[36:39], a[88:91], v[60:63], v[36:39]
    v_mfma_f32_16x16x32_bf16 v[40:43], a[120:123], v[60:63], v[40:43]
    ds_read_b128 v[56:59], v12 offset:2592
    s_waitcnt lgkmcnt(4)
    v_mfma_f32_16x16x32_bf16 v[28:31], a[20:23], v[64:67], v[28:31]
    v_mfma_f32_16x16x32_bf16 v[32:35], a[52:55], v[64:67], v[32:35]
    v_mfma_f32_16x16x32_bf16 v[36:39], a[84:87], v[64:67], v[36:39]
    v_mfma_f32_16x16x32_bf16 v[40:43], a[116:119], v[64:67], v[40:43]
    ds_read_b128 v[60:63], v12 offset:2528
    s_waitcnt lgkmcnt(4)
    v_mfma_f32_16x16x32_bf16 v[28:31], a[16:19], v[68:71], v[28:31]
    v_mfma_f32_16x16x32_bf16 v[32:35], a[48:51], v[68:71], v[32:35]
    v_mfma_f32_16x16x32_bf16 v[36:39], a[80:83], v[68:71], v[36:39]
    v_mfma_f32_16x16x32_bf16 v[40:43], a[112:115], v[68:71], v[40:43]
    s_waitcnt lgkmcnt(3)
    v_mfma_f32_16x16x32_bf16 v[28:31], a[12:15], v[48:51], v[28:31]
    v_mfma_f32_16x16x32_bf16 v[32:35], a[44:47], v[48:51], v[32:35]
    v_mfma_f32_16x16x32_bf16 v[36:39], a[76:79], v[48:51], v[36:39]
    v_mfma_f32_16x16x32_bf16 v[40:43], a[108:111], v[48:51], v[40:43]
    s_waitcnt lgkmcnt(2)
    v_mfma_f32_16x16x32_bf16 v[28:31], a[8:11], v[52:55], v[28:31]
    v_mfma_f32_16x16x32_bf16 v[32:35], a[40:43], v[52:55], v[32:35]
    v_mfma_f32_16x16x32_bf16 v[36:39], a[72:75], v[52:55], v[36:39]
    v_mfma_f32_16x16x32_bf16 v[40:43], a[104:107], v[52:55], v[40:43]
    s_waitcnt lgkmcnt(1)
    v_mfma_f32_16x16x32_bf16 v[28:31], a[4:7], v[56:59], v[28:31]
    v_mfma_f32_16x16x32_bf16 v[32:35], a[36:39], v[56:59], v[32:35]
    v_mfma_f32_16x16x32_bf16 v[36:39], a[68:71], v[56:59], v[36:39]
    v_mfma_f32_16x16x32_bf16 v[40:43], a[100:103], v[56:59], v[40:43]
    s_waitcnt lgkmcnt(0)
    v_mfma_f32_16x16x32_bf16 v[28:31], a[0:3], v[60:63], v[28:31]
    v_mfma_f32_16x16x32_bf16 v[32:35], a[32:35], v[60:63], v[32:35]
    v_mfma_f32_16x16x32_bf16 v[36:39], a[64:67], v[60:63], v[36:39]
    v_mfma_f32_16x16x32_bf16 v[40:43], a[96:99], v[60:63], v[40:43]
    s_barrier
    ds_read_b128 v[64:67], v12 offset:2464
    ds_read_b128 v[68:71], v12 offset:2400
    ds_read_b128 v[48:51], v12 offset:2336
    ds_read_b128 v[52:55], v12 offset:2272
    ds_read_b128 v[56:59], v12 offset:2208
    s_waitcnt lgkmcnt(4)
    v_mfma_f32_16x16x32_bf16 v[32:35], a[28:31], v[64:67], v[32:35]
    v_mfma_f32_16x16x32_bf16 v[36:39], a[60:63], v[64:67], v[36:39]
    v_mfma_f32_16x16x32_bf16 v[40:43], a[92:95], v[64:67], v[40:43]
    v_mfma_f32_16x16x32_bf16 v[44:47], a[124:127], v[64:67], v[44:47]
    ds_read_b128 v[60:63], v12 offset:2144
    s_waitcnt lgkmcnt(4)
    v_mfma_f32_16x16x32_bf16 v[32:35], a[24:27], v[68:71], v[32:35]
    v_mfma_f32_16x16x32_bf16 v[36:39], a[56:59], v[68:71], v[36:39]
    v_mfma_f32_16x16x32_bf16 v[40:43], a[88:91], v[68:71], v[40:43]
    v_mfma_f32_16x16x32_bf16 v[44:47], a[120:123], v[68:71], v[44:47]
    ds_read_b128 v[64:67], v12 offset:2080
    s_waitcnt lgkmcnt(4)
    v_mfma_f32_16x16x32_bf16 v[32:35], a[20:23], v[48:51], v[32:35]
    v_mfma_f32_16x16x32_bf16 v[36:39], a[52:55], v[48:51], v[36:39]
    v_mfma_f32_16x16x32_bf16 v[40:43], a[84:87], v[48:51], v[40:43]
    v_mfma_f32_16x16x32_bf16 v[44:47], a[116:119], v[48:51], v[44:47]
    ds_read_b128 v[68:71], v12 offset:2016
    s_waitcnt lgkmcnt(4)
    v_mfma_f32_16x16x32_bf16 v[32:35], a[16:19], v[52:55], v[32:35]
    v_mfma_f32_16x16x32_bf16 v[36:39], a[48:51], v[52:55], v[36:39]
    v_mfma_f32_16x16x32_bf16 v[40:43], a[80:83], v[52:55], v[40:43]
    v_mfma_f32_16x16x32_bf16 v[44:47], a[112:115], v[52:55], v[44:47]
    ds_read_b128 v[48:51], v12 offset:1952
    s_waitcnt lgkmcnt(4)
    v_mfma_f32_16x16x32_bf16 v[32:35], a[12:15], v[56:59], v[32:35]
    v_mfma_f32_16x16x32_bf16 v[36:39], a[44:47], v[56:59], v[36:39]
    v_mfma_f32_16x16x32_bf16 v[40:43], a[76:79], v[56:59], v[40:43]
    v_mfma_f32_16x16x32_bf16 v[44:47], a[108:111], v[56:59], v[44:47]
    ds_read_b128 v[52:55], v12 offset:1888
    s_waitcnt lgkmcnt(4)
    v_mfma_f32_16x16x32_bf16 v[32:35], a[8:11], v[60:63], v[32:35]
    v_mfma_f32_16x16x32_bf16 v[36:39], a[40:43], v[60:63], v[36:39]
    v_mfma_f32_16x16x32_bf16 v[40:43], a[72:75], v[60:63], v[40:43]
    v_mfma_f32_16x16x32_bf16 v[44:47], a[104:107], v[60:63], v[44:47]
    ds_read_b128 v[56:59], v12 offset:1824
    s_waitcnt lgkmcnt(4)
    v_mfma_f32_16x16x32_bf16 v[32:35], a[4:7], v[64:67], v[32:35]
    v_mfma_f32_16x16x32_bf16 v[36:39], a[36:39], v[64:67], v[36:39]
    v_mfma_f32_16x16x32_bf16 v[40:43], a[68:71], v[64:67], v[40:43]
    v_mfma_f32_16x16x32_bf16 v[44:47], a[100:103], v[64:67], v[44:47]
    ds_read_b128 v[60:63], v12 offset:1760
    s_waitcnt lgkmcnt(4)
    v_mfma_f32_16x16x32_bf16 v[32:35], a[0:3], v[68:71], v[32:35]
    v_mfma_f32_16x16x32_bf16 v[36:39], a[32:35], v[68:71], v[36:39]
    v_mfma_f32_16x16x32_bf16 v[40:43], a[64:67], v[68:71], v[40:43]
    v_mfma_f32_16x16x32_bf16 v[44:47], a[96:99], v[68:71], v[44:47]
    ds_read_b128 v[64:67], v12 offset:1696
    s_waitcnt lgkmcnt(4)
    v_mfma_f32_16x16x32_bf16 v[36:39], a[28:31], v[48:51], v[36:39]
    v_mfma_f32_16x16x32_bf16 v[40:43], a[60:63], v[48:51], v[40:43]
    v_mfma_f32_16x16x32_bf16 v[44:47], a[92:95], v[48:51], v[44:47]
    ds_read_b128 v[68:71], v12 offset:1632
    s_waitcnt lgkmcnt(4)
    v_mfma_f32_16x16x32_bf16 v[36:39], a[24:27], v[52:55], v[36:39]
    v_mfma_f32_16x16x32_bf16 v[40:43], a[56:59], v[52:55], v[40:43]
    v_mfma_f32_16x16x32_bf16 v[44:47], a[88:91], v[52:55], v[44:47]
    ds_read_b128 v[48:51], v12 offset:1568
    s_waitcnt lgkmcnt(4)
    v_mfma_f32_16x16x32_bf16 v[36:39], a[20:23], v[56:59], v[36:39]
    v_mfma_f32_16x16x32_bf16 v[40:43], a[52:55], v[56:59], v[40:43]
    v_mfma_f32_16x16x32_bf16 v[44:47], a[84:87], v[56:59], v[44:47]
    ds_read_b128 v[52:55], v12 offset:1504
    s_waitcnt lgkmcnt(4)
    v_mfma_f32_16x16x32_bf16 v[36:39], a[16:19], v[60:63], v[36:39]
    v_mfma_f32_16x16x32_bf16 v[40:43], a[48:51], v[60:63], v[40:43]
    v_mfma_f32_16x16x32_bf16 v[44:47], a[80:83], v[60:63], v[44:47]
    ds_read_b128 v[56:59], v12 offset:1440
    s_waitcnt lgkmcnt(4)
    v_mfma_f32_16x16x32_bf16 v[36:39], a[12:15], v[64:67], v[36:39]
    v_mfma_f32_16x16x32_bf16 v[40:43], a[44:47], v[64:67], v[40:43]
    v_mfma_f32_16x16x32_bf16 v[44:47], a[76:79], v[64:67], v[44:47]
    ds_read_b128 v[60:63], v12 offset:1376
    s_waitcnt lgkmcnt(4)
    v_mfma_f32_16x16x32_bf16 v[36:39], a[8:11], v[68:71], v[36:39]
    v_mfma_f32_16x16x32_bf16 v[40:43], a[40:43], v[68:71], v[40:43]
    v_mfma_f32_16x16x32_bf16 v[44:47], a[72:75], v[68:71], v[44:47]
    ds_read_b128 v[64:67], v12 offset:1312
    s_waitcnt lgkmcnt(4)
    v_mfma_f32_16x16x32_bf16 v[36:39], a[4:7], v[48:51], v[36:39]
    v_mfma_f32_16x16x32_bf16 v[40:43], a[36:39], v[48:51], v[40:43]
    v_mfma_f32_16x16x32_bf16 v[44:47], a[68:71], v[48:51], v[44:47]
    ds_read_b128 v[68:71], v12 offset:1248
    s_waitcnt lgkmcnt(4)
    v_mfma_f32_16x16x32_bf16 v[36:39], a[0:3], v[52:55], v[36:39]
    v_mfma_f32_16x16x32_bf16 v[40:43], a[32:35], v[52:55], v[40:43]
    v_mfma_f32_16x16x32_bf16 v[44:47], a[64:67], v[52:55], v[44:47]
    ds_read_b128 v[48:51], v12 offset:1184
    s_waitcnt lgkmcnt(4)
    v_mfma_f32_16x16x32_bf16 v[40:43], a[28:31], v[56:59], v[40:43]
    v_mfma_f32_16x16x32_bf16 v[44:47], a[60:63], v[56:59], v[44:47]
    ds_read_b128 v[52:55], v12 offset:1120
    s_waitcnt lgkmcnt(4)
    v_mfma_f32_16x16x32_bf16 v[40:43], a[24:27], v[60:63], v[40:43]
    v_mfma_f32_16x16x32_bf16 v[44:47], a[56:59], v[60:63], v[44:47]
    ds_read_b128 v[56:59], v12 offset:1056
    s_waitcnt lgkmcnt(4)
    v_mfma_f32_16x16x32_bf16 v[40:43], a[20:23], v[64:67], v[40:43]
    v_mfma_f32_16x16x32_bf16 v[44:47], a[52:55], v[64:67], v[44:47]
    ds_read_b128 v[60:63], v12 offset:992
    s_waitcnt lgkmcnt(4)
    v_mfma_f32_16x16x32_bf16 v[40:43], a[16:19], v[68:71], v[40:43]
    v_mfma_f32_16x16x32_bf16 v[44:47], a[48:51], v[68:71], v[44:47]
    ds_read_b128 v[64:67], v12 offset:928
    s_waitcnt lgkmcnt(4)
    v_mfma_f32_16x16x32_bf16 v[40:43], a[12:15], v[48:51], v[40:43]
    v_mfma_f32_16x16x32_bf16 v[44:47], a[44:47], v[48:51], v[44:47]
    ds_read_b128 v[68:71], v12 offset:864
    s_waitcnt lgkmcnt(4)
    v_mfma_f32_16x16x32_bf16 v[40:43], a[8:11], v[52:55], v[40:43]
    v_mfma_f32_16x16x32_bf16 v[44:47], a[40:43], v[52:55], v[44:47]
    ds_read_b128 v[48:51], v12 offset:800
    s_waitcnt lgkmcnt(4)
    v_mfma_f32_16x16x32_bf16 v[40:43], a[4:7], v[56:59], v[40:43]
    v_mfma_f32_16x16x32_bf16 v[44:47], a[36:39], v[56:59], v[44:47]
    ds_read_b128 v[52:55], v12 offset:736
    s_waitcnt lgkmcnt(4)
    v_mfma_f32_16x16x32_bf16 v[40:43], a[0:3], v[60:63], v[40:43]
    v_mfma_f32_16x16x32_bf16 v[44:47], a[32:35], v[60:63], v[44:47]
    ds_read_b128 v[56:59], v12 offset:672
    s_waitcnt lgkmcnt(4)
    v_mfma_f32_16x16x32_bf16 v[44:47], a[28:31], v[64:67], v[44:47]
    ds_read_b128 v[60:63], v12 offset:608
    s_waitcnt lgkmcnt(4)
    v_mfma_f32_16x16x32_bf16 v[44:47], a[24:27], v[68:71], v[44:47]
    ds_read_b128 v[64:67], v12 offset:544
    s_waitcnt lgkmcnt(4)
    v_mfma_f32_16x16x32_bf16 v[44:47], a[20:23], v[48:51], v[44:47]
    ds_read_b128 v[68:71], v12 offset:480
    s_waitcnt lgkmcnt(4)
    v_mfma_f32_16x16x32_bf16 v[44:47], a[16:19], v[52:55], v[44:47]
    s_waitcnt lgkmcnt(3)
    v_mfma_f32_16x16x32_bf16 v[44:47], a[12:15], v[56:59], v[44:47]
    s_waitcnt lgkmcnt(2)
    v_mfma_f32_16x16x32_bf16 v[44:47], a[8:11], v[60:63], v[44:47]
    s_waitcnt lgkmcnt(1)
    v_mfma_f32_16x16x32_bf16 v[44:47], a[4:7], v[64:67], v[44:47]
    s_waitcnt lgkmcnt(0)
    v_mfma_f32_16x16x32_bf16 v[44:47], a[0:3], v[68:71], v[44:47]
    s_lshl_b32 s7, s6, 12
    v_lshlrev_b32 v12, 3, v13
    v_add3_u32 v12, v12, v14, s7
    v_cvt_pk_bf16_f32 v48, v16, v17
    v_cvt_pk_bf16_f32 v49, v18, v19
    ds_write_b64 v12, v[48:49] offset:0
    v_cvt_pk_bf16_f32 v50, v20, v21
    v_cvt_pk_bf16_f32 v51, v22, v23
    ds_write_b64 v12, v[50:51] offset:512
    v_cvt_pk_bf16_f32 v52, v24, v25
    v_cvt_pk_bf16_f32 v53, v26, v27
    ds_write_b64 v12, v[52:53] offset:1024
    v_cvt_pk_bf16_f32 v54, v28, v29
    v_cvt_pk_bf16_f32 v55, v30, v31
    ds_write_b64 v12, v[54:55] offset:1536
    v_cvt_pk_bf16_f32 v56, v32, v33
    v_cvt_pk_bf16_f32 v57, v34, v35
    ds_write_b64 v12, v[56:57] offset:2048
    v_cvt_pk_bf16_f32 v58, v36, v37
    v_cvt_pk_bf16_f32 v59, v38, v39
    ds_write_b64 v12, v[58:59] offset:2560
    v_cvt_pk_bf16_f32 v60, v40, v41
    v_cvt_pk_bf16_f32 v61, v42, v43
    ds_write_b64 v12, v[60:61] offset:3072
    v_cvt_pk_bf16_f32 v62, v44, v45
    v_cvt_pk_bf16_f32 v63, v46, v47
    ds_write_b64 v12, v[62:63] offset:3584
    s_cmp_lg_u32 s6, 0
    s_cbranch_scc1 L_ka_ker_nocp_5
    s_getpc_b64 s[48:49]
L_ka_ker_pc_6:
    s_add_u32 s48, s48, kg_kernel-L_ka_ker_pc_6
    s_addc_u32 s49, s49, 0
    v_lshlrev_b32 v15, 7, v1
    global_load_dword v120, v15, s[48:49]
    v_add_u32 v15, 8192, v15
    global_load_dword v120, v15, s[48:49]
    v_add_u32 v15, 8192, v15
    global_load_dword v120, v15, s[48:49]
    v_add_u32 v15, 8192, v15
    global_load_dword v120, v15, s[48:49]
    v_lshlrev_b32 v15, 7, v1
    v_add_u32 v15, L_code_end-kg_kernel-8192, v15
    global_load_dword v120, v15, s[48:49]
L_ka_ker_nocp_5:
    s_waitcnt lgkmcnt(0)
    s_barrier
    s_endpgm
L_ka_ker_gwave_4:
    s_setprio 3
    s_lshl_b32 s7, s3, 5
    s_load_dwordx8 s[64:71], s[22:23], s7
    s_lshl_b32 s7, s3, 3
    s_load_dwordx2 s[72:73], s[26:27], s7
    s_mov_b32 s48, s18
    s_mov_b32 s49, s19
    s_mov_b32 s50, 2359296
    s_mov_b32 s51, 0x20000
    s_mov_b32 s52, s20
    s_mov_b32 s53, s21
    s_mov_b32 s54, 2359296
    s_mov_b32 s55, 0x20000
    s_lshl_b32 s8, s3, 14
    s_add_u32 s8, s8, 0
    s_add_u32 s56, s42, s8
    s_addc_u32 s57, s43, 0
    s_mov_b32 s58, 16384
    s_mov_b32 s59, 0x20000
    v_subrev_u32 v4, 256, v0
    s_movk_i32 s9, 4608
    v_mul_lo_u32 v6, v4, s9
    v_add_u32 v6, s7, v6
    s_mov_b32 s8, 1179648
    v_subrev_u32 v7, 3456, v6
    v_subrev_u32 v8, 2304, v6
    v_subrev_u32 v9, 1152, v6
    v_add_u32 v10, s8, v7
    s_mov_b64 exec, 1
    buffer_load_dwordx2 v[16:17], v7, s[48:51], 0 offen
    buffer_load_dwordx2 v[18:19], v8, s[48:51], 0 offen
    buffer_load_dwordx2 v[20:21], v9, s[48:51], 0 offen
    buffer_load_dwordx2 v[40:41], v10, s[48:51], 0 offen offset:0
    buffer_load_dwordx2 v[42:43], v10, s[48:51], 0 offen offset:1152
    buffer_load_dwordx2 v[44:45], v10, s[48:51], 0 offen offset:2304
    s_mov_b64 exec, -1
    s_cmp_eq_u32 s5, 1
    s_cbranch_scc1 L_ka_ker_g1_9
    s_cmp_eq_u32 s5, 2
    s_cbranch_scc1 L_ka_ker_g2_10
    s_cmp_eq_u32 s5, 3
    s_cbranch_scc1 L_ka_ker_g3_11
    s_cmp_eq_u32 s5, 4
    s_cbranch_scc1 L_ka_ker_g4_12
    s_cmp_eq_u32 s5, 5
    s_cbranch_scc1 L_ka_ker_g5_13
    s_cmp_eq_u32 s5, 6
    s_cbranch_scc1 L_ka_ker_g6_14
    s_cmp_eq_u32 s5, 7
    s_cbranch_scc1 L_ka_ker_g7_15
L_ka_ker_g0_8:
    buffer_load_dwordx2 v[22:23], v6, s[48:51], 0 offen offset:0
    buffer_load_dwordx2 v[24:25], v6, s[48:51], 0 offen offset:1152
    buffer_load_dwordx2 v[26:27], v6, s[48:51], 0 offen offset:2304
    buffer_load_dwordx2 v[28:29], v6, s[48:51], 0 offen offset:3456
    buffer_load_dwordx2 v[30:31], v6, s[52:55], 0 offen offset:0
    buffer_load_dwordx2 v[32:33], v6, s[52:55], 0 offen offset:1152
    buffer_load_dwordx2 v[34:35], v6, s[52:55], 0 offen offset:2304
    buffer_load_dwordx2 v[36:37], v6, s[52:55], 0 offen offset:3456
    s_branch L_ka_ker_gdone_7
L_ka_ker_g1_9:
    buffer_load_dwordx2 v[24:25], v6, s[48:51], 0 offen offset:1152
    buffer_load_dwordx2 v[26:27], v6, s[48:51], 0 offen offset:2304
    buffer_load_dwordx2 v[28:29], v6, s[48:51], 0 offen offset:3456
    buffer_load_dwordx2 v[30:31], v6, s[52:55], 0 offen offset:0
    buffer_load_dwordx2 v[32:33], v6, s[52:55], 0 offen offset:1152
    buffer_load_dwordx2 v[34:35], v6, s[52:55], 0 offen offset:2304
    buffer_load_dwordx2 v[36:37], v6, s[52:55], 0 offen offset:3456
    buffer_load_dwordx2 v[22:23], v6, s[48:51], 0 offen offset:0
    s_branch L_ka_ker_gdone_7
L_ka_ker_g2_10:
    buffer_load_dwordx2 v[26:27], v6, s[48:51], 0 offen offset:2304
    buffer_load_dwordx2 v[28:29], v6, s[48:51], 0 offen offset:3456
    buffer_load_dwordx2 v[30:31], v6, s[52:55], 0 offen offset:0
    buffer_load_dwordx2 v[32:33], v6, s[52:55], 0 offen offset:1152
    buffer_load_dwordx2 v[34:35], v6, s[52:55], 0 offen offset:2304
    buffer_load_dwordx2 v[36:37], v6, s[52:55], 0 offen offset:3456
    buffer_load_dwordx2 v[22:23], v6, s[48:51], 0 offen offset:0
    buffer_load_dwordx2 v[24:25], v6, s[48:51], 0 offen offset:1152
    s_branch L_ka_ker_gdone_7
L_ka_ker_g3_11:
    buffer_load_dwordx2 v[28:29], v6, s[48:51], 0 offen offset:3456
    buffer_load_dwordx2 v[30:31], v6, s[52:55], 0 offen offset:0
    buffer_load_dwordx2 v[32:33], v6, s[52:55], 0 offen offset:1152
    buffer_load_dwordx2 v[34:35], v6, s[52:55], 0 offen offset:2304
    buffer_load_dwordx2 v[36:37], v6, s[52:55], 0 offen offset:3456
    buffer_load_dwordx2 v[22:23], v6, s[48:51], 0 offen offset:0
    buffer_load_dwordx2 v[24:25], v6, s[48:51], 0 offen offset:1152
    buffer_load_dwordx2 v[26:27], v6, s[48:51], 0 offen offset:2304
    s_branch L_ka_ker_gdone_7
L_ka_ker_g4_12:
    buffer_load_dwordx2 v[30:31], v6, s[52:55], 0 offen offset:0
    buffer_load_dwordx2 v[32:33], v6, s[52:55], 0 offen offset:1152
    buffer_load_dwordx2 v[34:35], v6, s[52:55], 0 offen offset:2304
    buffer_load_dwordx2 v[36:37], v6, s[52:55], 0 offen offset:3456
    buffer_load_dwordx2 v[22:23], v6, s[48:51], 0 offen offset:0
    buffer_load_dwordx2 v[24:25], v6, s[48:51], 0 offen offset:1152
    buffer_load_dwordx2 v[26:27], v6, s[48:51], 0 offen offset:2304
    buffer_load_dwordx2 v[28:29], v6, s[48:51], 0 offen offset:3456
    s_branch L_ka_ker_gdone_7
L_ka_ker_g5_13:
    buffer_load_dwordx2 v[32:33], v6, s[52:55], 0 offen offset:1152
    buffer_load_dwordx2 v[34:35], v6, s[52:55], 0 offen offset:2304
    buffer_load_dwordx2 v[36:37], v6, s[52:55], 0 offen offset:3456
    buffer_load_dwordx2 v[22:23], v6, s[48:51], 0 offen offset:0
    buffer_load_dwordx2 v[24:25], v6, s[48:51], 0 offen offset:1152
    buffer_load_dwordx2 v[26:27], v6, s[48:51], 0 offen offset:2304
    buffer_load_dwordx2 v[28:29], v6, s[48:51], 0 offen offset:3456
    buffer_load_dwordx2 v[30:31], v6, s[52:55], 0 offen offset:0
    s_branch L_ka_ker_gdone_7
L_ka_ker_g6_14:
    buffer_load_dwordx2 v[34:35], v6, s[52:55], 0 offen offset:2304
    buffer_load_dwordx2 v[36:37], v6, s[52:55], 0 offen offset:3456
    buffer_load_dwordx2 v[22:23], v6, s[48:51], 0 offen offset:0
    buffer_load_dwordx2 v[24:25], v6, s[48:51], 0 offen offset:1152
    buffer_load_dwordx2 v[26:27], v6, s[48:51], 0 offen offset:2304
    buffer_load_dwordx2 v[28:29], v6, s[48:51], 0 offen offset:3456
    buffer_load_dwordx2 v[30:31], v6, s[52:55], 0 offen offset:0
    buffer_load_dwordx2 v[32:33], v6, s[52:55], 0 offen offset:1152
    s_branch L_ka_ker_gdone_7
L_ka_ker_g7_15:
    buffer_load_dwordx2 v[36:37], v6, s[52:55], 0 offen offset:3456
    buffer_load_dwordx2 v[22:23], v6, s[48:51], 0 offen offset:0
    buffer_load_dwordx2 v[24:25], v6, s[48:51], 0 offen offset:1152
    buffer_load_dwordx2 v[26:27], v6, s[48:51], 0 offen offset:2304
    buffer_load_dwordx2 v[28:29], v6, s[48:51], 0 offen offset:3456
    buffer_load_dwordx2 v[30:31], v6, s[52:55], 0 offen offset:0
    buffer_load_dwordx2 v[32:33], v6, s[52:55], 0 offen offset:1152
    buffer_load_dwordx2 v[34:35], v6, s[52:55], 0 offen offset:2304
L_ka_ker_gdone_7:
    buffer_load_dwordx2 v[46:47], v6, s[48:51], s8 offen offset:0
    s_waitcnt lgkmcnt(0)
    s_and_b32 s76, s64, 0xffff
    s_lshr_b32 s77, s64, 16
    s_and_b32 s78, s65, 0xffff
    s_lshr_b32 s79, s65, 16
    s_lshl_b32 s92, s72, 16
    s_lshl_b32 s80, s66, 16
    s_and_b32 s81, s66, 0xffff0000
    s_lshl_b32 s82, s67, 16
    s_and_b32 s83, s67, 0xffff0000
    s_and_b32 s93, s72, 0xffff0000
    s_and_b32 s84, s68, 0xffff
    s_lshr_b32 s85, s68, 16
    s_and_b32 s86, s69, 0xffff
    s_lshr_b32 s87, s69, 16
    s_lshl_b32 s94, s73, 16
    s_lshl_b32 s88, s70, 16
    s_and_b32 s89, s70, 0xffff0000
    s_lshl_b32 s90, s71, 16
    s_and_b32 s91, s71, 0xffff0000
    s_and_b32 s95, s73, 0xffff0000
    s_mov_b32 s10, 0x3f803f80
    s_mov_b32 s11, 0xffff0000
    s_mov_b32 s9, 140280
    v_lshlrev_b32 v11, 3, v4
    v_sub_u32 v11, s9, v11
    s_waitcnt vmcnt(1)
    v_mov_b32_dpp v16, v24 wave_shr:1 row_mask:0xf bank_mask:0xf
    v_mov_b32_dpp v17, v25 wave_shr:1 row_mask:0xf bank_mask:0xf
    v_mov_b32_dpp v18, v26 wave_shr:1 row_mask:0xf bank_mask:0xf
    v_mov_b32_dpp v19, v27 wave_shr:1 row_mask:0xf bank_mask:0xf
    v_mov_b32_dpp v20, v28 wave_shr:1 row_mask:0xf bank_mask:0xf
    v_mov_b32_dpp v21, v29 wave_shr:1 row_mask:0xf bank_mask:0xf
    v_dot2_f32_bf16 v96, v16, s79, 0
    v_dot2_f32_bf16 v97, v18, s79, 0
    v_dot2_f32_bf16 v98, v20, s79, 0
    v_dot2_f32_bf16 v99, v22, s79, 0
    v_dot2_f32_bf16 v100, v16, s83, 0
    v_dot2_f32_bf16 v101, v18, s83, 0
    v_dot2_f32_bf16 v102, v20, s83, 0
    v_dot2_f32_bf16 v103, v22, s83, 0
    buffer_load_dwordx2 v[48:49], v6, s[48:51], s8 offen offset:1152
    v_dot2_f32_bf16 v104, v18, s78, 0
    v_dot2_f32_bf16 v105, v20, s78, 0
    v_dot2_f32_bf16 v106, v22, s78, 0
    v_dot2_f32_bf16 v107, v24, s78, 0
    v_dot2_f32_bf16 v108, v18, s82, 0
    v_dot2_f32_bf16 v109, v20, s82, 0
    v_dot2_f32_bf16 v110, v22, s82, 0
    v_dot2_f32_bf16 v111, v24, s82, 0
    v_cvt_pk_bf16_f32 v112, v96, v104
    v_cvt_pk_bf16_f32 v113, v97, v105
    v_cvt_pk_bf16_f32 v114, v98, v106
    v_cvt_pk_bf16_f32 v115, v99, v107
    v_cvt_pk_bf16_f32 v116, v100, v108
    v_cvt_pk_bf16_f32 v117, v101, v109
    v_cvt_pk_bf16_f32 v118, v102, v110
    v_cvt_pk_bf16_f32 v119, v103, v111
    v_dot2_f32_bf16 v96, v112, s10, 0
    v_dot2_f32_bf16 v97, v113, s10, 0
    v_dot2_f32_bf16 v98, v114, s10, 0
    v_dot2_f32_bf16 v99, v115, s10, 0
    v_dot2_f32_bf16 v100, v116, s10, 0
    v_dot2_f32_bf16 v101, v117, s10, 0
    v_dot2_f32_bf16 v102, v118, s10, 0
    v_dot2_f32_bf16 v103, v119, s10, 0
    buffer_load_dwordx2 v[50:51], v6, s[48:51], s8 offen offset:2304
    v_dot2_f32_bf16 v104, v20, s77, 0
    v_dot2_f32_bf16 v105, v22, s77, 0
    v_dot2_f32_bf16 v106, v24, s77, 0
    v_dot2_f32_bf16 v107, v26, s77, 0
    v_dot2_f32_bf16 v108, v20, s81, 0
    v_dot2_f32_bf16 v109, v22, s81, 0
    v_dot2_f32_bf16 v110, v24, s81, 0
    v_dot2_f32_bf16 v111, v26, s81, 0
    v_cvt_pk_bf16_f32 v112, v96, v104
    v_cvt_pk_bf16_f32 v113, v97, v105
    v_cvt_pk_bf16_f32 v114, v98, v106
    v_cvt_pk_bf16_f32 v115, v99, v107
    v_cvt_pk_bf16_f32 v116, v100, v108
    v_cvt_pk_bf16_f32 v117, v101, v109
    v_cvt_pk_bf16_f32 v118, v102, v110
    v_cvt_pk_bf16_f32 v119, v103, v111
    v_dot2_f32_bf16 v96, v112, s10, 0
    v_dot2_f32_bf16 v97, v113, s10, 0
    v_dot2_f32_bf16 v98, v114, s10, 0
    v_dot2_f32_bf16 v99, v115, s10, 0
    v_dot2_f32_bf16 v100, v116, s10, 0
    v_dot2_f32_bf16 v101, v117, s10, 0
    v_dot2_f32_bf16 v102, v118, s10, 0
    v_dot2_f32_bf16 v103, v119, s10, 0
    buffer_load_dwordx2 v[52:53], v6, s[48:51], s8 offen offset:3456
    v_dot2_f32_bf16 v104, v22, s76, 0
    v_dot2_f32_bf16 v105, v24, s76, 0
    v_dot2_f32_bf16 v106, v26, s76, 0
    v_dot2_f32_bf16 v107, v28, s76, 0
    v_dot2_f32_bf16 v108, v22, s80, 0
    v_dot2_f32_bf16 v109, v24, s80, 0
    v_dot2_f32_bf16 v110, v26, s80, 0
    v_dot2_f32_bf16 v111, v28, s80, 0
    v_cvt_pk_bf16_f32 v112, v96, v104
    v_cvt_pk_bf16_f32 v113, v97, v105
    v_cvt_pk_bf16_f32 v114, v98, v106
    v_cvt_pk_bf16_f32 v115, v99, v107
    v_cvt_pk_bf16_f32 v116, v100, v108
    v_cvt_pk_bf16_f32 v117, v101, v109
    v_cvt_pk_bf16_f32 v118, v102, v110
    v_cvt_pk_bf16_f32 v119, v103, v111
    v_dot2_f32_bf16 v96, v112, s10, 0
    v_dot2_f32_bf16 v97, v113, s10, 0
    v_dot2_f32_bf16 v98, v114, s10, 0
    v_dot2_f32_bf16 v99, v115, s10, 0
    v_dot2_f32_bf16 v100, v116, s10, 0
    v_dot2_f32_bf16 v101, v117, s10, 0
    v_dot2_f32_bf16 v102, v118, s10, 0
    v_dot2_f32_bf16 v103, v119, s10, 0
    buffer_load_dwordx2 v[54:55], v6, s[52:55], s8 offen offset:0
    v_and_b32 v104, 0xffff, v30
    v_and_b32 v108, s11, v30
    v_and_b32 v105, 0xffff, v32
    v_and_b32 v109, s11, v32
    v_and_b32 v106, 0xffff, v34
    v_and_b32 v110, s11, v34
    v_and_b32 v107, 0xffff, v36
    v_and_b32 v111, s11, v36
    v_cvt_pk_bf16_f32 v112, v96, v100
    v_cvt_pk_bf16_f32 v113, v97, v101
    v_cvt_pk_bf16_f32 v114, v98, v102
    v_cvt_pk_bf16_f32 v115, v99, v103
    v_dot2_f32_bf16 v96, v112, v104, 0
    v_dot2_f32_bf16 v97, v113, v105, 0
    v_dot2_f32_bf16 v98, v114, v106, 0
    v_dot2_f32_bf16 v99, v115, v107, 0
    v_dot2_f32_bf16 v100, v112, v108, 0
    v_dot2_f32_bf16 v101, v113, v109, 0
    v_dot2_f32_bf16 v102, v114, v110, 0
    v_dot2_f32_bf16 v103, v115, v111, 0
    v_cvt_pk_bf16_f32 v116, v99, v98
    v_cvt_pk_bf16_f32 v117, v97, v96
    ds_write_b64 v11, v[116:117] offset:0
    v_lshlrev_b32 v67, 16, v116
    v_and_b32 v66, 0xffff0000, v116
    v_lshlrev_b32 v65, 16, v117
    v_and_b32 v64, 0xffff0000, v117
    v_cvt_pk_bf16_f32 v118, v103, v102
    v_cvt_pk_bf16_f32 v119, v101, v100
    ds_write_b64 v11, v[118:119] offset:5120
    v_lshlrev_b32 v71, 16, v118
    v_and_b32 v70, 0xffff0000, v118
    v_lshlrev_b32 v69, 16, v119
    v_and_b32 v68, 0xffff0000, v119
    v_dot2_f32_bf16 v96, v17, s87, 0
    v_dot2_f32_bf16 v97, v19, s87, 0
    v_dot2_f32_bf16 v98, v21, s87, 0
    v_dot2_f32_bf16 v99, v23, s87, 0
    v_dot2_f32_bf16 v100, v17, s91, 0
    v_dot2_f32_bf16 v101, v19, s91, 0
    v_dot2_f32_bf16 v102, v21, s91, 0
    v_dot2_f32_bf16 v103, v23, s91, 0
    buffer_load_dwordx2 v[56:57], v6, s[52:55], s8 offen offset:1152
    v_dot2_f32_bf16 v104, v19, s86, 0
    v_dot2_f32_bf16 v105, v21, s86, 0
    v_dot2_f32_bf16 v106, v23, s86, 0
    v_dot2_f32_bf16 v107, v25, s86, 0
    v_dot2_f32_bf16 v108, v19, s90, 0
    v_dot2_f32_bf16 v109, v21, s90, 0
    v_dot2_f32_bf16 v110, v23, s90, 0
    v_dot2_f32_bf16 v111, v25, s90, 0
    v_cvt_pk_bf16_f32 v112, v96, v104
    v_cvt_pk_bf16_f32 v113, v97, v105
    v_cvt_pk_bf16_f32 v114, v98, v106
    v_cvt_pk_bf16_f32 v115, v99, v107
    v_cvt_pk_bf16_f32 v116, v100, v108
    v_cvt_pk_bf16_f32 v117, v101, v109
    v_cvt_pk_bf16_f32 v118, v102, v110
    v_cvt_pk_bf16_f32 v119, v103, v111
    v_dot2_f32_bf16 v96, v112, s10, 0
    v_dot2_f32_bf16 v97, v113, s10, 0
    v_dot2_f32_bf16 v98, v114, s10, 0
    v_dot2_f32_bf16 v99, v115, s10, 0
    v_dot2_f32_bf16 v100, v116, s10, 0
    v_dot2_f32_bf16 v101, v117, s10, 0
    v_dot2_f32_bf16 v102, v118, s10, 0
    v_dot2_f32_bf16 v103, v119, s10, 0
    buffer_load_dwordx2 v[58:59], v6, s[52:55], s8 offen offset:2304
    v_dot2_f32_bf16 v104, v21, s85, 0
    v_dot2_f32_bf16 v105, v23, s85, 0
    v_dot2_f32_bf16 v106, v25, s85, 0
    v_dot2_f32_bf16 v107, v27, s85, 0
    v_dot2_f32_bf16 v108, v21, s89, 0
    v_dot2_f32_bf16 v109, v23, s89, 0
    v_dot2_f32_bf16 v110, v25, s89, 0
    v_dot2_f32_bf16 v111, v27, s89, 0
    v_cvt_pk_bf16_f32 v112, v96, v104
    v_cvt_pk_bf16_f32 v113, v97, v105
    v_cvt_pk_bf16_f32 v114, v98, v106
    v_cvt_pk_bf16_f32 v115, v99, v107
    v_cvt_pk_bf16_f32 v116, v100, v108
    v_cvt_pk_bf16_f32 v117, v101, v109
    v_cvt_pk_bf16_f32 v118, v102, v110
    v_cvt_pk_bf16_f32 v119, v103, v111
    v_dot2_f32_bf16 v96, v112, s10, 0
    v_dot2_f32_bf16 v97, v113, s10, 0
    v_dot2_f32_bf16 v98, v114, s10, 0
    v_dot2_f32_bf16 v99, v115, s10, 0
    v_dot2_f32_bf16 v100, v116, s10, 0
    v_dot2_f32_bf16 v101, v117, s10, 0
    v_dot2_f32_bf16 v102, v118, s10, 0
    v_dot2_f32_bf16 v103, v119, s10, 0
    buffer_load_dwordx2 v[60:61], v6, s[52:55], s8 offen offset:3456
    v_dot2_f32_bf16 v104, v23, s84, 0
    v_dot2_f32_bf16 v105, v25, s84, 0
    v_dot2_f32_bf16 v106, v27, s84, 0
    v_dot2_f32_bf16 v107, v29, s84, 0
    v_dot2_f32_bf16 v108, v23, s88, 0
    v_dot2_f32_bf16 v109, v25, s88, 0
    v_dot2_f32_bf16 v110, v27, s88, 0
    v_dot2_f32_bf16 v111, v29, s88, 0
    v_cvt_pk_bf16_f32 v112, v96, v104
    v_cvt_pk_bf16_f32 v113, v97, v105
    v_cvt_pk_bf16_f32 v114, v98, v106
    v_cvt_pk_bf16_f32 v115, v99, v107
    v_cvt_pk_bf16_f32 v116, v100, v108
    v_cvt_pk_bf16_f32 v117, v101, v109
    v_cvt_pk_bf16_f32 v118, v102, v110
    v_cvt_pk_bf16_f32 v119, v103, v111
    v_dot2_f32_bf16 v96, v112, s10, 0
    v_dot2_f32_bf16 v97, v113, s10, 0
    v_dot2_f32_bf16 v98, v114, s10, 0
    v_dot2_f32_bf16 v99, v115, s10, 0
    v_dot2_f32_bf16 v100, v116, s10, 0
    v_dot2_f32_bf16 v101, v117, s10, 0
    v_dot2_f32_bf16 v102, v118, s10, 0
    v_dot2_f32_bf16 v103, v119, s10, 0
    v_and_b32 v104, 0xffff, v31
    v_and_b32 v108, s11, v31
    v_and_b32 v105, 0xffff, v33
    v_and_b32 v109, s11, v33
    v_and_b32 v106, 0xffff, v35
    v_and_b32 v110, s11, v35
    v_and_b32 v107, 0xffff, v37
    v_and_b32 v111, s11, v37
    v_cvt_pk_bf16_f32 v112, v96, v100
    v_cvt_pk_bf16_f32 v113, v97, v101
    v_cvt_pk_bf16_f32 v114, v98, v102
    v_cvt_pk_bf16_f32 v115, v99, v103
    v_dot2_f32_bf16 v96, v112, v104, 0
    v_dot2_f32_bf16 v97, v113, v105, 0
    v_dot2_f32_bf16 v98, v114, v106, 0
    v_dot2_f32_bf16 v99, v115, v107, 0
    v_dot2_f32_bf16 v100, v112, v108, 0
    v_dot2_f32_bf16 v101, v113, v109, 0
    v_dot2_f32_bf16 v102, v114, v110, 0
    v_dot2_f32_bf16 v103, v115, v111, 0
    v_cvt_pk_bf16_f32 v116, v99, v98
    v_cvt_pk_bf16_f32 v117, v97, v96
    ds_write_b64 v11, v[116:117] offset:10240
    v_lshlrev_b32 v75, 16, v116
    v_and_b32 v74, 0xffff0000, v116
    v_lshlrev_b32 v73, 16, v117
    v_and_b32 v72, 0xffff0000, v117
    v_cvt_pk_bf16_f32 v118, v103, v102
    v_cvt_pk_bf16_f32 v119, v101, v100
    ds_write_b64 v11, v[118:119] offset:15360
    v_lshlrev_b32 v79, 16, v118
    v_and_b32 v78, 0xffff0000, v118
    v_lshlrev_b32 v77, 16, v119
    v_and_b32 v76, 0xffff0000, v119
    v_subrev_u32 v12, 2048, v11
    s_waitcnt lgkmcnt(0)
    s_barrier
    s_waitcnt vmcnt(0)
    v_mov_b32_dpp v40, v48 wave_shr:1 row_mask:0xf bank_mask:0xf
    v_mov_b32_dpp v41, v49 wave_shr:1 row_mask:0xf bank_mask:0xf
    v_mov_b32_dpp v42, v50 wave_shr:1 row_mask:0xf bank_mask:0xf
    v_mov_b32_dpp v43, v51 wave_shr:1 row_mask:0xf bank_mask:0xf
    v_mov_b32_dpp v44, v52 wave_shr:1 row_mask:0xf bank_mask:0xf
    v_mov_b32_dpp v45, v53 wave_shr:1 row_mask:0xf bank_mask:0xf
    v_dot2_f32_bf16 v96, v40, s79, 0
    v_dot2_f32_bf16 v97, v42, s79, 0
    v_dot2_f32_bf16 v98, v44, s79, 0
    v_dot2_f32_bf16 v99, v46, s79, 0
    v_dot2_f32_bf16 v100, v40, s83, 0
    v_dot2_f32_bf16 v101, v42, s83, 0
    v_dot2_f32_bf16 v102, v44, s83, 0
    v_dot2_f32_bf16 v103, v46, s83, 0
    v_dot2_f32_bf16 v104, v42, s78, 0
    v_dot2_f32_bf16 v105, v44, s78, 0
    v_dot2_f32_bf16 v106, v46, s78, 0
    v_dot2_f32_bf16 v107, v48, s78, 0
    v_dot2_f32_bf16 v108, v42, s82, 0
    v_dot2_f32_bf16 v109, v44, s82, 0
    v_dot2_f32_bf16 v110, v46, s82, 0
    v_dot2_f32_bf16 v111, v48, s82, 0
    v_cvt_pk_bf16_f32 v112, v96, v104
    v_cvt_pk_bf16_f32 v113, v97, v105
    v_cvt_pk_bf16_f32 v114, v98, v106
    v_cvt_pk_bf16_f32 v115, v99, v107
    v_cvt_pk_bf16_f32 v116, v100, v108
    v_cvt_pk_bf16_f32 v117, v101, v109
    v_cvt_pk_bf16_f32 v118, v102, v110
    v_cvt_pk_bf16_f32 v119, v103, v111
    v_dot2_f32_bf16 v96, v112, s10, 0
    v_dot2_f32_bf16 v97, v113, s10, 0
    v_dot2_f32_bf16 v98, v114, s10, 0
    v_dot2_f32_bf16 v99, v115, s10, 0
    v_dot2_f32_bf16 v100, v116, s10, 0
    v_dot2_f32_bf16 v101, v117, s10, 0
    v_dot2_f32_bf16 v102, v118, s10, 0
    v_dot2_f32_bf16 v103, v119, s10, 0
    v_dot2_f32_bf16 v104, v44, s77, 0
    v_dot2_f32_bf16 v105, v46, s77, 0
    v_dot2_f32_bf16 v106, v48, s77, 0
    v_dot2_f32_bf16 v107, v50, s77, 0
    v_dot2_f32_bf16 v108, v44, s81, 0
    v_dot2_f32_bf16 v109, v46, s81, 0
    v_dot2_f32_bf16 v110, v48, s81, 0
    v_dot2_f32_bf16 v111, v50, s81, 0
    v_cvt_pk_bf16_f32 v112, v96, v104
    v_cvt_pk_bf16_f32 v113, v97, v105
    v_cvt_pk_bf16_f32 v114, v98, v106
    v_cvt_pk_bf16_f32 v115, v99, v107
    v_cvt_pk_bf16_f32 v116, v100, v108
    v_cvt_pk_bf16_f32 v117, v101, v109
    v_cvt_pk_bf16_f32 v118, v102, v110
    v_cvt_pk_bf16_f32 v119, v103, v111
    v_dot2_f32_bf16 v96, v112, s10, 0
    v_dot2_f32_bf16 v97, v113, s10, 0
    v_dot2_f32_bf16 v98, v114, s10, 0
    v_dot2_f32_bf16 v99, v115, s10, 0
    v_dot2_f32_bf16 v100, v116, s10, 0
    v_dot2_f32_bf16 v101, v117, s10, 0
    v_dot2_f32_bf16 v102, v118, s10, 0
    v_dot2_f32_bf16 v103, v119, s10, 0
    v_dot2_f32_bf16 v104, v46, s76, 0
    v_dot2_f32_bf16 v105, v48, s76, 0
    v_dot2_f32_bf16 v106, v50, s76, 0
    v_dot2_f32_bf16 v107, v52, s76, 0
    v_dot2_f32_bf16 v108, v46, s80, 0
    v_dot2_f32_bf16 v109, v48, s80, 0
    v_dot2_f32_bf16 v110, v50, s80, 0
    v_dot2_f32_bf16 v111, v52, s80, 0
    v_cvt_pk_bf16_f32 v112, v96, v104
    v_cvt_pk_bf16_f32 v113, v97, v105
    v_cvt_pk_bf16_f32 v114, v98, v106
    v_cvt_pk_bf16_f32 v115, v99, v107
    v_cvt_pk_bf16_f32 v116, v100, v108
    v_cvt_pk_bf16_f32 v117, v101, v109
    v_cvt_pk_bf16_f32 v118, v102, v110
    v_cvt_pk_bf16_f32 v119, v103, v111
    v_dot2_f32_bf16 v96, v112, s10, 0
    v_dot2_f32_bf16 v97, v113, s10, 0
    v_dot2_f32_bf16 v98, v114, s10, 0
    v_dot2_f32_bf16 v99, v115, s10, 0
    v_dot2_f32_bf16 v100, v116, s10, 0
    v_dot2_f32_bf16 v101, v117, s10, 0
    v_dot2_f32_bf16 v102, v118, s10, 0
    v_dot2_f32_bf16 v103, v119, s10, 0
    v_and_b32 v104, 0xffff, v54
    v_and_b32 v108, s11, v54
    v_and_b32 v105, 0xffff, v56
    v_and_b32 v109, s11, v56
    v_and_b32 v106, 0xffff, v58
    v_and_b32 v110, s11, v58
    v_and_b32 v107, 0xffff, v60
    v_and_b32 v111, s11, v60
    v_cvt_pk_bf16_f32 v112, v96, v100
    v_cvt_pk_bf16_f32 v113, v97, v101
    v_cvt_pk_bf16_f32 v114, v98, v102
    v_cvt_pk_bf16_f32 v115, v99, v103
    v_dot2_f32_bf16 v96, v112, v104, 0
    v_dot2_f32_bf16 v97, v113, v105, 0
    v_dot2_f32_bf16 v98, v114, v106, 0
    v_dot2_f32_bf16 v99, v115, v107, 0
    v_dot2_f32_bf16 v100, v112, v108, 0
    v_dot2_f32_bf16 v101, v113, v109, 0
    v_dot2_f32_bf16 v102, v114, v110, 0
    v_dot2_f32_bf16 v103, v115, v111, 0
    v_cvt_pk_bf16_f32 v116, v99, v98
    v_cvt_pk_bf16_f32 v117, v97, v96
    ds_write_b64 v12, v[116:117] offset:0
    v_lshlrev_b32 v83, 16, v116
    v_and_b32 v82, 0xffff0000, v116
    v_lshlrev_b32 v81, 16, v117
    v_and_b32 v80, 0xffff0000, v117
    v_cvt_pk_bf16_f32 v118, v103, v102
    v_cvt_pk_bf16_f32 v119, v101, v100
    ds_write_b64 v12, v[118:119] offset:5120
    v_lshlrev_b32 v87, 16, v118
    v_and_b32 v86, 0xffff0000, v118
    v_lshlrev_b32 v85, 16, v119
    v_and_b32 v84, 0xffff0000, v119
    v_dot2_f32_bf16 v96, v41, s87, 0
    v_dot2_f32_bf16 v97, v43, s87, 0
    v_dot2_f32_bf16 v98, v45, s87, 0
    v_dot2_f32_bf16 v99, v47, s87, 0
    v_dot2_f32_bf16 v100, v41, s91, 0
    v_dot2_f32_bf16 v101, v43, s91, 0
    v_dot2_f32_bf16 v102, v45, s91, 0
    v_dot2_f32_bf16 v103, v47, s91, 0
    v_dot2_f32_bf16 v104, v43, s86, 0
    v_dot2_f32_bf16 v105, v45, s86, 0
    v_dot2_f32_bf16 v106, v47, s86, 0
    v_dot2_f32_bf16 v107, v49, s86, 0
    v_dot2_f32_bf16 v108, v43, s90, 0
    v_dot2_f32_bf16 v109, v45, s90, 0
    v_dot2_f32_bf16 v110, v47, s90, 0
    v_dot2_f32_bf16 v111, v49, s90, 0
    v_cvt_pk_bf16_f32 v112, v96, v104
    v_cvt_pk_bf16_f32 v113, v97, v105
    v_cvt_pk_bf16_f32 v114, v98, v106
    v_cvt_pk_bf16_f32 v115, v99, v107
    v_cvt_pk_bf16_f32 v116, v100, v108
    v_cvt_pk_bf16_f32 v117, v101, v109
    v_cvt_pk_bf16_f32 v118, v102, v110
    v_cvt_pk_bf16_f32 v119, v103, v111
    v_dot2_f32_bf16 v96, v112, s10, 0
    v_dot2_f32_bf16 v97, v113, s10, 0
    v_dot2_f32_bf16 v98, v114, s10, 0
    v_dot2_f32_bf16 v99, v115, s10, 0
    v_dot2_f32_bf16 v100, v116, s10, 0
    v_dot2_f32_bf16 v101, v117, s10, 0
    v_dot2_f32_bf16 v102, v118, s10, 0
    v_dot2_f32_bf16 v103, v119, s10, 0
    v_dot2_f32_bf16 v104, v45, s85, 0
    v_dot2_f32_bf16 v105, v47, s85, 0
    v_dot2_f32_bf16 v106, v49, s85, 0
    v_dot2_f32_bf16 v107, v51, s85, 0
    v_dot2_f32_bf16 v108, v45, s89, 0
    v_dot2_f32_bf16 v109, v47, s89, 0
    v_dot2_f32_bf16 v110, v49, s89, 0
    v_dot2_f32_bf16 v111, v51, s89, 0
    v_cvt_pk_bf16_f32 v112, v96, v104
    v_cvt_pk_bf16_f32 v113, v97, v105
    v_cvt_pk_bf16_f32 v114, v98, v106
    v_cvt_pk_bf16_f32 v115, v99, v107
    v_cvt_pk_bf16_f32 v116, v100, v108
    v_cvt_pk_bf16_f32 v117, v101, v109
    v_cvt_pk_bf16_f32 v118, v102, v110
    v_cvt_pk_bf16_f32 v119, v103, v111
    v_dot2_f32_bf16 v96, v112, s10, 0
    v_dot2_f32_bf16 v97, v113, s10, 0
    v_dot2_f32_bf16 v98, v114, s10, 0
    v_dot2_f32_bf16 v99, v115, s10, 0
    v_dot2_f32_bf16 v100, v116, s10, 0
    v_dot2_f32_bf16 v101, v117, s10, 0
    v_dot2_f32_bf16 v102, v118, s10, 0
    v_dot2_f32_bf16 v103, v119, s10, 0
    v_dot2_f32_bf16 v104, v47, s84, 0
    v_dot2_f32_bf16 v105, v49, s84, 0
    v_dot2_f32_bf16 v106, v51, s84, 0
    v_dot2_f32_bf16 v107, v53, s84, 0
    v_dot2_f32_bf16 v108, v47, s88, 0
    v_dot2_f32_bf16 v109, v49, s88, 0
    v_dot2_f32_bf16 v110, v51, s88, 0
    v_dot2_f32_bf16 v111, v53, s88, 0
    v_cvt_pk_bf16_f32 v112, v96, v104
    v_cvt_pk_bf16_f32 v113, v97, v105
    v_cvt_pk_bf16_f32 v114, v98, v106
    v_cvt_pk_bf16_f32 v115, v99, v107
    v_cvt_pk_bf16_f32 v116, v100, v108
    v_cvt_pk_bf16_f32 v117, v101, v109
    v_cvt_pk_bf16_f32 v118, v102, v110
    v_cvt_pk_bf16_f32 v119, v103, v111
    v_dot2_f32_bf16 v96, v112, s10, 0
    v_dot2_f32_bf16 v97, v113, s10, 0
    v_dot2_f32_bf16 v98, v114, s10, 0
    v_dot2_f32_bf16 v99, v115, s10, 0
    v_dot2_f32_bf16 v100, v116, s10, 0
    v_dot2_f32_bf16 v101, v117, s10, 0
    v_dot2_f32_bf16 v102, v118, s10, 0
    v_dot2_f32_bf16 v103, v119, s10, 0
    v_and_b32 v104, 0xffff, v55
    v_and_b32 v108, s11, v55
    v_and_b32 v105, 0xffff, v57
    v_and_b32 v109, s11, v57
    v_and_b32 v106, 0xffff, v59
    v_and_b32 v110, s11, v59
    v_and_b32 v107, 0xffff, v61
    v_and_b32 v111, s11, v61
    v_cvt_pk_bf16_f32 v112, v96, v100
    v_cvt_pk_bf16_f32 v113, v97, v101
    v_cvt_pk_bf16_f32 v114, v98, v102
    v_cvt_pk_bf16_f32 v115, v99, v103
    v_dot2_f32_bf16 v96, v112, v104, 0
    v_dot2_f32_bf16 v97, v113, v105, 0
    v_dot2_f32_bf16 v98, v114, v106, 0
    v_dot2_f32_bf16 v99, v115, v107, 0
    v_dot2_f32_bf16 v100, v112, v108, 0
    v_dot2_f32_bf16 v101, v113, v109, 0
    v_dot2_f32_bf16 v102, v114, v110, 0
    v_dot2_f32_bf16 v103, v115, v111, 0
    v_cvt_pk_bf16_f32 v116, v99, v98
    v_cvt_pk_bf16_f32 v117, v97, v96
    ds_write_b64 v12, v[116:117] offset:10240
    v_lshlrev_b32 v91, 16, v116
    v_and_b32 v90, 0xffff0000, v116
    v_lshlrev_b32 v89, 16, v117
    v_and_b32 v88, 0xffff0000, v117
    v_cvt_pk_bf16_f32 v118, v103, v102
    v_cvt_pk_bf16_f32 v119, v101, v100
    ds_write_b64 v12, v[118:119] offset:15360
    v_lshlrev_b32 v95, 16, v118
    v_and_b32 v94, 0xffff0000, v118
    v_lshlrev_b32 v93, 16, v119
    v_and_b32 v92, 0xffff0000, v119
    s_waitcnt lgkmcnt(0)
    s_barrier
    v_mul_f32 v64, s92, v64
    v_mul_f32 v65, s92, v65
    v_mul_f32 v66, s92, v66
    v_mul_f32 v67, s92, v67
    v_cvt_pk_bf16_f32 v96, v64, v65
    v_lshlrev_b32 v64, 16, v96
    v_and_b32 v65, 0xffff0000, v96
    v_cvt_pk_bf16_f32 v97, v66, v67
    v_lshlrev_b32 v66, 16, v97
    v_and_b32 v67, 0xffff0000, v97
    v_mul_f32 v68, s93, v68
    v_mul_f32 v69, s93, v69
    v_mul_f32 v70, s93, v70
    v_mul_f32 v71, s93, v71
    v_cvt_pk_bf16_f32 v96, v68, v69
    v_lshlrev_b32 v68, 16, v96
    v_and_b32 v69, 0xffff0000, v96
    v_cvt_pk_bf16_f32 v97, v70, v71
    v_lshlrev_b32 v70, 16, v97
    v_and_b32 v71, 0xffff0000, v97
    v_mul_f32 v72, s94, v72
    v_mul_f32 v73, s94, v73
    v_mul_f32 v74, s94, v74
    v_mul_f32 v75, s94, v75
    v_cvt_pk_bf16_f32 v96, v72, v73
    v_lshlrev_b32 v72, 16, v96
    v_and_b32 v73, 0xffff0000, v96
    v_cvt_pk_bf16_f32 v97, v74, v75
    v_lshlrev_b32 v74, 16, v97
    v_and_b32 v75, 0xffff0000, v97
    v_mul_f32 v76, s95, v76
    v_mul_f32 v77, s95, v77
    v_mul_f32 v78, s95, v78
    v_mul_f32 v79, s95, v79
    v_cvt_pk_bf16_f32 v96, v76, v77
    v_lshlrev_b32 v76, 16, v96
    v_and_b32 v77, 0xffff0000, v96
    v_cvt_pk_bf16_f32 v97, v78, v79
    v_lshlrev_b32 v78, 16, v97
    v_and_b32 v79, 0xffff0000, v97
    v_mul_f32 v80, s92, v80
    v_mul_f32 v81, s92, v81
    v_mul_f32 v82, s92, v82
    v_mul_f32 v83, s92, v83
    v_cvt_pk_bf16_f32 v96, v80, v81
    v_lshlrev_b32 v80, 16, v96
    v_and_b32 v81, 0xffff0000, v96
    v_cvt_pk_bf16_f32 v97, v82, v83
    v_lshlrev_b32 v82, 16, v97
    v_and_b32 v83, 0xffff0000, v97
    v_mul_f32 v84, s93, v84
    v_mul_f32 v85, s93, v85
    v_mul_f32 v86, s93, v86
    v_mul_f32 v87, s93, v87
    v_cvt_pk_bf16_f32 v96, v84, v85
    v_lshlrev_b32 v84, 16, v96
    v_and_b32 v85, 0xffff0000, v96
    v_cvt_pk_bf16_f32 v97, v86, v87
    v_lshlrev_b32 v86, 16, v97
    v_and_b32 v87, 0xffff0000, v97
    v_mul_f32 v88, s94, v88
    v_mul_f32 v89, s94, v89
    v_mul_f32 v90, s94, v90
    v_mul_f32 v91, s94, v91
    v_cvt_pk_bf16_f32 v96, v88, v89
    v_lshlrev_b32 v88, 16, v96
    v_and_b32 v89, 0xffff0000, v96
    v_cvt_pk_bf16_f32 v97, v90, v91
    v_lshlrev_b32 v90, 16, v97
    v_and_b32 v91, 0xffff0000, v97
    v_mul_f32 v92, s95, v92
    v_mul_f32 v93, s95, v93
    v_mul_f32 v94, s95, v94
    v_mul_f32 v95, s95, v95
    v_cvt_pk_bf16_f32 v96, v92, v93
    v_lshlrev_b32 v92, 16, v96
    v_and_b32 v93, 0xffff0000, v96
    v_cvt_pk_bf16_f32 v97, v94, v95
    v_lshlrev_b32 v94, 16, v97
    v_and_b32 v95, 0xffff0000, v97
    v_lshlrev_b32 v10, 3, v4
    v_lshlrev_b32 v13, 5, v4
    s_mov_b32 s8, 0x00003f80
    s_mov_b32 s9, 0x3f800000
    s_movk_i32 s12, 8192
    s_barrier
    ds_read_b64 v[16:17], v10 offset:0
    ds_read_b64 v[18:19], v10 offset:4096
    ds_read_b64 v[20:21], v10 offset:8192
    ds_read_b64 v[22:23], v10 offset:12288
    ds_read_b64 v[24:25], v10 offset:2048
    ds_read_b64 v[26:27], v10 offset:6144
    ds_read_b64 v[28:29], v10 offset:10240
    ds_read_b64 v[30:31], v10 offset:14336
    s_waitcnt lgkmcnt(4)
    v_dot2_f32_bf16 v64, v16, s8, v64
    v_dot2_f32_bf16 v65, v16, s9, v65
    v_dot2_f32_bf16 v66, v17, s8, v66
    v_dot2_f32_bf16 v67, v17, s9, v67
    v_dot2_f32_bf16 v68, v18, s8, v68
    v_dot2_f32_bf16 v69, v18, s9, v69
    v_dot2_f32_bf16 v70, v19, s8, v70
    v_dot2_f32_bf16 v71, v19, s9, v71
    v_dot2_f32_bf16 v72, v20, s8, v72
    v_dot2_f32_bf16 v73, v20, s9, v73
    v_dot2_f32_bf16 v74, v21, s8, v74
    v_dot2_f32_bf16 v75, v21, s9, v75
    v_dot2_f32_bf16 v76, v22, s8, v76
    v_dot2_f32_bf16 v77, v22, s9, v77
    v_dot2_f32_bf16 v78, v23, s8, v78
    v_dot2_f32_bf16 v79, v23, s9, v79
    v_cvt_pk_bf16_f32 v32, v64, v68
    v_cvt_pk_bf16_f32 v33, v72, v76
    v_cvt_pk_bf16_f32 v34, v65, v69
    v_cvt_pk_bf16_f32 v35, v73, v77
    v_cvt_pk_bf16_f32 v36, v66, v70
    v_cvt_pk_bf16_f32 v37, v74, v78
    v_cvt_pk_bf16_f32 v38, v67, v71
    v_cvt_pk_bf16_f32 v39, v75, v79
    buffer_store_dwordx4 v[32:35], v13, s[56:59], 0 offen
    buffer_store_dwordx4 v[36:39], v13, s[56:59], 0 offen offset:16
    s_waitcnt lgkmcnt(0)
    v_dot2_f32_bf16 v80, v24, s8, v80
    v_dot2_f32_bf16 v81, v24, s9, v81
    v_dot2_f32_bf16 v82, v25, s8, v82
    v_dot2_f32_bf16 v83, v25, s9, v83
    v_dot2_f32_bf16 v84, v26, s8, v84
    v_dot2_f32_bf16 v85, v26, s9, v85
    v_dot2_f32_bf16 v86, v27, s8, v86
    v_dot2_f32_bf16 v87, v27, s9, v87
    v_dot2_f32_bf16 v88, v28, s8, v88
    v_dot2_f32_bf16 v89, v28, s9, v89
    v_dot2_f32_bf16 v90, v29, s8, v90
    v_dot2_f32_bf16 v91, v29, s9, v91
    v_dot2_f32_bf16 v92, v30, s8, v92
    v_dot2_f32_bf16 v93, v30, s9, v93
    v_dot2_f32_bf16 v94, v31, s8, v94
    v_dot2_f32_bf16 v95, v31, s9, v95
    v_cvt_pk_bf16_f32 v40, v80, v84
    v_cvt_pk_bf16_f32 v41, v88, v92
    v_cvt_pk_bf16_f32 v42, v81, v85
    v_cvt_pk_bf16_f32 v43, v89, v93
    v_cvt_pk_bf16_f32 v44, v82, v86
    v_cvt_pk_bf16_f32 v45, v90, v94
    v_cvt_pk_bf16_f32 v46, v83, v87
    v_cvt_pk_bf16_f32 v47, v91, v95
    buffer_store_dwordx4 v[40:43], v13, s[56:59], s12 offen
    buffer_store_dwordx4 v[44:47], v13, s[56:59], s12 offen offset:16
    s_endpgm
L_ka_ker_prep_1:
    s_getpc_b64 s[44:45]
L_ka_ker_sp_16:
    s_sub_u32 s44, s44, L_ka_ker_sp_16-ka_kernel
    s_subb_u32 s45, s45, 0
    v_lshlrev_b32 v1, 7, v0
    v_cmp_gt_u32 vcc, 20480, v1
    s_nop 0
    s_and_saveexec_b64 s[46:47], vcc
    s_cbranch_execz L_ka_ker_spskip_17
    global_load_dword v127, v1, s[44:45]
L_ka_ker_spskip_17:
    s_mov_b64 exec, -1
    s_sub_u32 s3, s2, 144
    v_lshrrev_b32 v2, 6, v0
    v_and_b32 v1, 63, v0
    v_readfirstlane_b32 s6, v2
    v_lshrrev_b32 v3, 3, v1
    v_and_b32 v4, 7, v1
    s_waitcnt lgkmcnt(0)
    s_cmp_lt_u32 s3, 72
    s_cbranch_scc1 L_ka_ker_p3_18
    s_cmp_lt_u32 s3, 144
    s_cbranch_scc1 L_ka_ker_p4_19
    s_cmp_lt_u32 s3, 153
    s_cbranch_scc1 L_ka_ker_p1_20
    s_branch L_ka_ker_p2_21
L_ka_ker_p3_18:
    s_mov_b32 s44, s34
    s_mov_b32 s45, s35
    s_mov_b32 s46, 5308416
    s_mov_b32 s47, 0x20000
    s_add_u32 s48, s42, 10887168
    s_addc_u32 s49, s43, 0
    s_mov_b32 s50, 5308416
    s_mov_b32 s51, 0x20000
    s_add_u32 s52, s42, 10866688
    s_addc_u32 s53, s43, 0
    s_mov_b32 s54, 18432
    s_mov_b32 s55, 0x20000
    s_movk_i32 s8, 9216
    s_mov_b32 s4, s3
    s_lshl_b32 s9, s3, 7
    s_mov_b32 s5, 1
    s_branch L_ka_ker_pgo_22
L_ka_ker_p4_19:
    s_mov_b32 s44, s36
    s_mov_b32 s45, s37
    s_mov_b32 s46, 5308416
    s_mov_b32 s47, 0x20000
    s_add_u32 s48, s42, 16195584
    s_addc_u32 s49, s43, 0
    s_mov_b32 s50, 5308416
    s_mov_b32 s51, 0x20000
    s_add_u32 s52, s42, 10866688
    s_addc_u32 s53, s43, 0
    s_mov_b32 s54, 0
    s_mov_b32 s55, 0x20000
    s_movk_i32 s8, 1152
    s_sub_u32 s4, s3, 72
    s_mul_hi_u32 s12, s4, 477218589
    s_mul_i32 s13, s12, 9
    s_sub_u32 s13, s4, s13
    s_mul_i32 s9, s12, 663552
    s_lshl_b32 s13, s13, 7
    s_add_u32 s9, s9, s13
    s_mov_b32 s5, 0
    s_branch L_ka_ker_pgo_22
L_ka_ker_p1_20:
    s_mov_b32 s44, s30
    s_mov_b32 s45, s31
    s_mov_b32 s46, 663552
    s_mov_b32 s47, 0x20000
    s_add_u32 s48, s42, 9535488
    s_addc_u32 s49, s43, 0
    s_mov_b32 s50, 663552
    s_mov_b32 s51, 0x20000
    s_add_u32 s52, s42, 10862592
    s_addc_u32 s53, s43, 0
    s_mov_b32 s54, 2304
    s_mov_b32 s55, 0x20000
    s_movk_i32 s8, 1152
    s_sub_u32 s4, s3, 144
    s_lshl_b32 s9, s4, 7
    s_mov_b32 s5, 1
    s_branch L_ka_ker_pgo_22
L_ka_ker_p2_21:
    s_mov_b32 s44, s32
    s_mov_b32 s45, s33
    s_mov_b32 s46, 663552
    s_mov_b32 s47, 0x20000
    s_add_u32 s48, s42, 10199040
    s_addc_u32 s49, s43, 0
    s_mov_b32 s50, 663552
    s_mov_b32 s51, 0x20000
    s_add_u32 s52, s42, 10862592
    s_addc_u32 s53, s43, 0
    s_mov_b32 s54, 0
    s_mov_b32 s55, 0x20000
    s_movk_i32 s8, 1152
    s_sub_u32 s4, s3, 153
    s_lshl_b32 s9, s4, 7
    s_mov_b32 s5, 0
L_ka_ker_pgo_22:
    s_mov_b32 s64, 0
    s_mul_i32 s65, s8, 1
    s_mul_i32 s66, s8, 2
    s_mul_i32 s67, s8, 3
    s_mul_i32 s68, s8, 4
    s_mul_i32 s69, s8, 5
    s_mul_i32 s70, s8, 6
    s_mul_i32 s71, s8, 7
    s_lshl_b32 s7, s8, 3
    v_mul_lo_u32 v5, v3, s7
    v_lshl_add_u32 v5, v4, 4, v5
    v_add_u32 v5, s9, v5
    s_lshl_b32 s8, s8, 6
    s_mul_i32 s7, s6, s8
    v_add_u32 v7, s7, v5
    buffer_load_dwordx4 v[16:19], v7, s[44:47], s64 offen
    buffer_load_dwordx4 v[20:23], v7, s[44:47], s65 offen
    buffer_load_dwordx4 v[24:27], v7, s[44:47], s66 offen
    buffer_load_dwordx4 v[28:31], v7, s[44:47], s67 offen
    buffer_load_dwordx4 v[32:35], v7, s[44:47], s68 offen
    buffer_load_dwordx4 v[36:39], v7, s[44:47], s69 offen
    buffer_load_dwordx4 v[40:43], v7, s[44:47], s70 offen
    buffer_load_dwordx4 v[44:47], v7, s[44:47], s71 offen
    s_cmp_lg_u32 s6, 0
    s_cbranch_scc1 L_ka_ker_pskip_23
    s_lshl_b32 s7, s8, 3
    v_add_u32 v7, s7, v5
    buffer_load_dwordx4 v[80:83], v7, s[44:47], s64 offen
    buffer_load_dwordx4 v[84:87], v7, s[44:47], s65 offen
    buffer_load_dwordx4 v[88:91], v7, s[44:47], s66 offen
    buffer_load_dwordx4 v[92:95], v7, s[44:47], s67 offen
    buffer_load_dwordx4 v[96:99], v7, s[44:47], s68 offen
    buffer_load_dwordx4 v[100:103], v7, s[44:47], s69 offen
    buffer_load_dwordx4 v[104:107], v7, s[44:47], s70 offen
    buffer_load_dwordx4 v[108:111], v7, s[44:47], s71 offen
L_ka_ker_pskip_23:
    s_mul_i32 s7, s4, 73728
    s_lshl_b32 s9, s6, 11
    s_add_u32 s72, s7, s9
    s_add_u32 s73, s72, 18432
    s_add_u32 s74, s72, 36864
    s_add_u32 s75, s72, 55296
    s_add_u32 s3, s3, 81
    s_cmp_lt_u32 s3, 72
    s_cbranch_scc1 L_ka_ker_p3_24
    s_cmp_lt_u32 s3, 144
    s_cbranch_scc1 L_ka_ker_p4_25
    s_cmp_lt_u32 s3, 153
    s_cbranch_scc1 L_ka_ker_p1_26
    s_branch L_ka_ker_p2_27
L_ka_ker_p3_24:
    s_mov_b32 s56, s34
    s_mov_b32 s57, s35
    s_mov_b32 s58, 5308416
    s_mov_b32 s59, 0x20000
    s_add_u32 s60, s42, 10887168
    s_addc_u32 s61, s43, 0
    s_mov_b32 s62, 5308416
    s_mov_b32 s63, 0x20000
    s_add_u32 s76, s42, 10866688
    s_addc_u32 s77, s43, 0
    s_mov_b32 s78, 18432
    s_mov_b32 s79, 0x20000
    s_movk_i32 s8, 9216
    s_mov_b32 s10, s3
    s_lshl_b32 s9, s3, 7
    s_mov_b32 s11, 1
    s_branch L_ka_ker_pgo_28
L_ka_ker_p4_25:
    s_mov_b32 s56, s36
    s_mov_b32 s57, s37
    s_mov_b32 s58, 5308416
    s_mov_b32 s59, 0x20000
    s_add_u32 s60, s42, 16195584
    s_addc_u32 s61, s43, 0
    s_mov_b32 s62, 5308416
    s_mov_b32 s63, 0x20000
    s_add_u32 s76, s42, 10866688
    s_addc_u32 s77, s43, 0
    s_mov_b32 s78, 0
    s_mov_b32 s79, 0x20000
    s_movk_i32 s8, 1152
    s_sub_u32 s10, s3, 72
    s_mul_hi_u32 s12, s10, 477218589
    s_mul_i32 s13, s12, 9
    s_sub_u32 s13, s10, s13
    s_mul_i32 s9, s12, 663552
    s_lshl_b32 s13, s13, 7
    s_add_u32 s9, s9, s13
    s_mov_b32 s11, 0
    s_branch L_ka_ker_pgo_28
L_ka_ker_p1_26:
    s_mov_b32 s56, s30
    s_mov_b32 s57, s31
    s_mov_b32 s58, 663552
    s_mov_b32 s59, 0x20000
    s_add_u32 s60, s42, 9535488
    s_addc_u32 s61, s43, 0
    s_mov_b32 s62, 663552
    s_mov_b32 s63, 0x20000
    s_add_u32 s76, s42, 10862592
    s_addc_u32 s77, s43, 0
    s_mov_b32 s78, 2304
    s_mov_b32 s79, 0x20000
    s_movk_i32 s8, 1152
    s_sub_u32 s10, s3, 144
    s_lshl_b32 s9, s10, 7
    s_mov_b32 s11, 1
    s_branch L_ka_ker_pgo_28
L_ka_ker_p2_27:
    s_mov_b32 s56, s32
    s_mov_b32 s57, s33
    s_mov_b32 s58, 663552
    s_mov_b32 s59, 0x20000
    s_add_u32 s60, s42, 10199040
    s_addc_u32 s61, s43, 0
    s_mov_b32 s62, 663552
    s_mov_b32 s63, 0x20000
    s_add_u32 s76, s42, 10862592
    s_addc_u32 s77, s43, 0
    s_mov_b32 s78, 0
    s_mov_b32 s79, 0x20000
    s_movk_i32 s8, 1152
    s_sub_u32 s10, s3, 153
    s_lshl_b32 s9, s10, 7
    s_mov_b32 s11, 0
L_ka_ker_pgo_28:
    s_mov_b32 s64, 0
    s_mul_i32 s65, s8, 1
    s_mul_i32 s66, s8, 2
    s_mul_i32 s67, s8, 3
    s_mul_i32 s68, s8, 4
    s_mul_i32 s69, s8, 5
    s_mul_i32 s70, s8, 6
    s_mul_i32 s71, s8, 7
    s_lshl_b32 s7, s8, 3
    v_mul_lo_u32 v5, v3, s7
    v_lshl_add_u32 v5, v4, 4, v5
    v_add_u32 v5, s9, v5
    s_lshl_b32 s8, s8, 6
    s_mul_i32 s7, s6, s8
    v_add_u32 v7, s7, v5
    buffer_load_dwordx4 v[48:51], v7, s[56:59], s64 offen
    buffer_load_dwordx4 v[52:55], v7, s[56:59], s65 offen
    buffer_load_dwordx4 v[56:59], v7, s[56:59], s66 offen
    buffer_load_dwordx4 v[60:63], v7, s[56:59], s67 offen
    buffer_load_dwordx4 v[64:67], v7, s[56:59], s68 offen
    buffer_load_dwordx4 v[68:71], v7, s[56:59], s69 offen
    buffer_load_dwordx4 v[72:75], v7, s[56:59], s70 offen
    buffer_load_dwordx4 v[76:79], v7, s[56:59], s71 offen
    s_cmp_lg_u32 s6, 1
    s_cbranch_scc1 L_ka_ker_pskip_29
    s_lshl_b32 s7, s8, 3
    v_add_u32 v7, s7, v5
    buffer_load_dwordx4 v[80:83], v7, s[56:59], s64 offen
    buffer_load_dwordx4 v[84:87], v7, s[56:59], s65 offen
    buffer_load_dwordx4 v[88:91], v7, s[56:59], s66 offen
    buffer_load_dwordx4 v[92:95], v7, s[56:59], s67 offen
    buffer_load_dwordx4 v[96:99], v7, s[56:59], s68 offen
    buffer_load_dwordx4 v[100:103], v7, s[56:59], s69 offen
    buffer_load_dwordx4 v[104:107], v7, s[56:59], s70 offen
    buffer_load_dwordx4 v[108:111], v7, s[56:59], s71 offen
L_ka_ker_pskip_29:
    s_mul_i32 s7, s10, 73728
    s_lshl_b32 s9, s6, 11
    s_add_u32 s80, s7, s9
    s_add_u32 s81, s80, 18432
    s_add_u32 s82, s80, 36864
    s_add_u32 s83, s80, 55296
    v_lshrrev_b32 v8, 1, v4
    v_lshlrev_b32 v8, 4, v8
    v_lshrrev_b32 v9, 2, v3
    v_lshl_add_u32 v8, v9, 3, v8
    v_and_b32 v9, 1, v4
    v_add_u32 v8, v8, v9
    v_and_b32 v9, 3, v3
    v_lshl_add_u32 v8, v9, 1, v8
    v_mul_u32_u24 v8, 144, v8
    s_mul_i32 s7, s6, 9216
    s_add_u32 s7, s7, 8192
    v_add_u32 v8, s7, v8
    v_mul_u32_u24 v9, 144, v3
    v_lshl_add_u32 v9, v4, 4, v9
    v_add_u32 v9, s7, v9
    v_lshlrev_b32 v6, 4, v1
    s_mov_b32 s12, 0x05040100
    s_mov_b32 s13, 0x07060302
    s_mov_b32 s14, 0x3f803f80
    s_waitcnt vmcnt(0)
    v_perm_b32 v112, v20, v16, s12
    v_perm_b32 v113, v28, v24, s12
    v_perm_b32 v114, v36, v32, s12
    v_perm_b32 v115, v44, v40, s12
    ds_write_b128 v8, v[112:115] offset:0
    v_dot2_f32_bf16 v120, v112, s14, 0
    v_dot2_f32_bf16 v120, v113, s14, v120
    v_dot2_f32_bf16 v120, v114, s14, v120
    v_dot2_f32_bf16 v120, v115, s14, v120
    v_perm_b32 v116, v20, v16, s13
    v_perm_b32 v117, v28, v24, s13
    v_perm_b32 v118, v36, v32, s13
    v_perm_b32 v119, v44, v40, s13
    ds_write_b128 v8, v[116:119] offset:16
    v_dot2_f32_bf16 v121, v116, s14, 0
    v_dot2_f32_bf16 v121, v117, s14, v121
    v_dot2_f32_bf16 v121, v118, s14, v121
    v_dot2_f32_bf16 v121, v119, s14, v121
    v_perm_b32 v112, v21, v17, s12
    v_perm_b32 v113, v29, v25, s12
    v_perm_b32 v114, v37, v33, s12
    v_perm_b32 v115, v45, v41, s12
    ds_write_b128 v8, v[112:115] offset:32
    v_dot2_f32_bf16 v122, v112, s14, 0
    v_dot2_f32_bf16 v122, v113, s14, v122
    v_dot2_f32_bf16 v122, v114, s14, v122
    v_dot2_f32_bf16 v122, v115, s14, v122
    v_perm_b32 v116, v21, v17, s13
    v_perm_b32 v117, v29, v25, s13
    v_perm_b32 v118, v37, v33, s13
    v_perm_b32 v119, v45, v41, s13
    ds_write_b128 v8, v[116:119] offset:48
    v_dot2_f32_bf16 v123, v116, s14, 0
    v_dot2_f32_bf16 v123, v117, s14, v123
    v_dot2_f32_bf16 v123, v118, s14, v123
    v_dot2_f32_bf16 v123, v119, s14, v123
    v_perm_b32 v112, v22, v18, s12
    v_perm_b32 v113, v30, v26, s12
    v_perm_b32 v114, v38, v34, s12
    v_perm_b32 v115, v46, v42, s12
    ds_write_b128 v8, v[112:115] offset:64
    v_dot2_f32_bf16 v124, v112, s14, 0
    v_dot2_f32_bf16 v124, v113, s14, v124
    v_dot2_f32_bf16 v124, v114, s14, v124
    v_dot2_f32_bf16 v124, v115, s14, v124
    v_perm_b32 v116, v22, v18, s13
    v_perm_b32 v117, v30, v26, s13
    v_perm_b32 v118, v38, v34, s13
    v_perm_b32 v119, v46, v42, s13
    ds_write_b128 v8, v[116:119] offset:80
    v_dot2_f32_bf16 v125, v116, s14, 0
    v_dot2_f32_bf16 v125, v117, s14, v125
    v_dot2_f32_bf16 v125, v118, s14, v125
    v_dot2_f32_bf16 v125, v119, s14, v125
    v_perm_b32 v112, v23, v19, s12
    v_perm_b32 v113, v31, v27, s12
    v_perm_b32 v114, v39, v35, s12
    v_perm_b32 v115, v47, v43, s12
    ds_write_b128 v8, v[112:115] offset:96
    v_dot2_f32_bf16 v126, v112, s14, 0
    v_dot2_f32_bf16 v126, v113, s14, v126
    v_dot2_f32_bf16 v126, v114, s14, v126
    v_dot2_f32_bf16 v126, v115, s14, v126
    v_perm_b32 v116, v23, v19, s13
    v_perm_b32 v117, v31, v27, s13
    v_perm_b32 v118, v39, v35, s13
    v_perm_b32 v119, v47, v43, s13
    ds_write_b128 v8, v[116:119] offset:112
    v_dot2_f32_bf16 v127, v116, s14, 0
    v_dot2_f32_bf16 v127, v117, s14, v127
    v_dot2_f32_bf16 v127, v118, s14, v127
    v_dot2_f32_bf16 v127, v119, s14, v127
    s_waitcnt lgkmcnt(0)
    ds_read_b128 v[16:19], v9 offset:0
    ds_read_b128 v[20:23], v9 offset:1152
    ds_read_b128 v[24:27], v9 offset:2304
    ds_read_b128 v[28:31], v9 offset:3456
    ds_read_b128 v[32:35], v9 offset:4608
    ds_read_b128 v[36:39], v9 offset:5760
    ds_read_b128 v[40:43], v9 offset:6912
    ds_read_b128 v[44:47], v9 offset:8064
    s_waitcnt lgkmcnt(7)
    buffer_store_dwordx4 v[16:19], v6, s[48:51], s72 offen offset:0
    s_waitcnt lgkmcnt(6)
    buffer_store_dwordx4 v[20:23], v6, s[48:51], s72 offen offset:1024
    s_waitcnt lgkmcnt(5)
    buffer_store_dwordx4 v[24:27], v6, s[48:51], s73 offen offset:0
    s_waitcnt lgkmcnt(4)
    buffer_store_dwordx4 v[28:31], v6, s[48:51], s73 offen offset:1024
    s_waitcnt lgkmcnt(3)
    buffer_store_dwordx4 v[32:35], v6, s[48:51], s74 offen offset:0
    s_waitcnt lgkmcnt(2)
    buffer_store_dwordx4 v[36:39], v6, s[48:51], s74 offen offset:1024
    s_waitcnt lgkmcnt(1)
    buffer_store_dwordx4 v[40:43], v6, s[48:51], s75 offen offset:0
    s_waitcnt lgkmcnt(0)
    buffer_store_dwordx4 v[44:47], v6, s[48:51], s75 offen offset:1024
    s_cmp_lg_u32 s6, 0
    s_cbranch_scc1 L_ka_ker_pskip2_30
    s_add_u32 s72, s72, 16384
    s_add_u32 s73, s73, 16384
    s_add_u32 s74, s74, 16384
    s_add_u32 s75, s75, 16384
    v_perm_b32 v112, v84, v80, s12
    v_perm_b32 v113, v92, v88, s12
    v_perm_b32 v114, v100, v96, s12
    v_perm_b32 v115, v108, v104, s12
    ds_write_b128 v8, v[112:115] offset:0
    v_dot2_f32_bf16 v120, v112, s14, v120
    v_dot2_f32_bf16 v120, v113, s14, v120
    v_dot2_f32_bf16 v120, v114, s14, v120
    v_dot2_f32_bf16 v120, v115, s14, v120
    v_perm_b32 v116, v84, v80, s13
    v_perm_b32 v117, v92, v88, s13
    v_perm_b32 v118, v100, v96, s13
    v_perm_b32 v119, v108, v104, s13
    ds_write_b128 v8, v[116:119] offset:16
    v_dot2_f32_bf16 v121, v116, s14, v121
    v_dot2_f32_bf16 v121, v117, s14, v121
    v_dot2_f32_bf16 v121, v118, s14, v121
    v_dot2_f32_bf16 v121, v119, s14, v121
    v_perm_b32 v112, v85, v81, s12
    v_perm_b32 v113, v93, v89, s12
    v_perm_b32 v114, v101, v97, s12
    v_perm_b32 v115, v109, v105, s12
    ds_write_b128 v8, v[112:115] offset:32
    v_dot2_f32_bf16 v122, v112, s14, v122
    v_dot2_f32_bf16 v122, v113, s14, v122
    v_dot2_f32_bf16 v122, v114, s14, v122
    v_dot2_f32_bf16 v122, v115, s14, v122
    v_perm_b32 v116, v85, v81, s13
    v_perm_b32 v117, v93, v89, s13
    v_perm_b32 v118, v101, v97, s13
    v_perm_b32 v119, v109, v105, s13
    ds_write_b128 v8, v[116:119] offset:48
    v_dot2_f32_bf16 v123, v116, s14, v123
    v_dot2_f32_bf16 v123, v117, s14, v123
    v_dot2_f32_bf16 v123, v118, s14, v123
    v_dot2_f32_bf16 v123, v119, s14, v123
    v_perm_b32 v112, v86, v82, s12
    v_perm_b32 v113, v94, v90, s12
    v_perm_b32 v114, v102, v98, s12
    v_perm_b32 v115, v110, v106, s12
    ds_write_b128 v8, v[112:115] offset:64
    v_dot2_f32_bf16 v124, v112, s14, v124
    v_dot2_f32_bf16 v124, v113, s14, v124
    v_dot2_f32_bf16 v124, v114, s14, v124
    v_dot2_f32_bf16 v124, v115, s14, v124
    v_perm_b32 v116, v86, v82, s13
    v_perm_b32 v117, v94, v90, s13
    v_perm_b32 v118, v102, v98, s13
    v_perm_b32 v119, v110, v106, s13
    ds_write_b128 v8, v[116:119] offset:80
    v_dot2_f32_bf16 v125, v116, s14, v125
    v_dot2_f32_bf16 v125, v117, s14, v125
    v_dot2_f32_bf16 v125, v118, s14, v125
    v_dot2_f32_bf16 v125, v119, s14, v125
    v_perm_b32 v112, v87, v83, s12
    v_perm_b32 v113, v95, v91, s12
    v_perm_b32 v114, v103, v99, s12
    v_perm_b32 v115, v111, v107, s12
    ds_write_b128 v8, v[112:115] offset:96
    v_dot2_f32_bf16 v126, v112, s14, v126
    v_dot2_f32_bf16 v126, v113, s14, v126
    v_dot2_f32_bf16 v126, v114, s14, v126
    v_dot2_f32_bf16 v126, v115, s14, v126
    v_perm_b32 v116, v87, v83, s13
    v_perm_b32 v117, v95, v91, s13
    v_perm_b32 v118, v103, v99, s13
    v_perm_b32 v119, v111, v107, s13
    ds_write_b128 v8, v[116:119] offset:112
    v_dot2_f32_bf16 v127, v116, s14, v127
    v_dot2_f32_bf16 v127, v117, s14, v127
    v_dot2_f32_bf16 v127, v118, s14, v127
    v_dot2_f32_bf16 v127, v119, s14, v127
    s_waitcnt lgkmcnt(0)
    ds_read_b128 v[80:83], v9 offset:0
    ds_read_b128 v[84:87], v9 offset:1152
    ds_read_b128 v[88:91], v9 offset:2304
    ds_read_b128 v[92:95], v9 offset:3456
    ds_read_b128 v[96:99], v9 offset:4608
    ds_read_b128 v[100:103], v9 offset:5760
    ds_read_b128 v[104:107], v9 offset:6912
    ds_read_b128 v[108:111], v9 offset:8064
    s_waitcnt lgkmcnt(7)
    buffer_store_dwordx4 v[80:83], v6, s[48:51], s72 offen offset:0
    s_waitcnt lgkmcnt(6)
    buffer_store_dwordx4 v[84:87], v6, s[48:51], s72 offen offset:1024
    s_waitcnt lgkmcnt(5)
    buffer_store_dwordx4 v[88:91], v6, s[48:51], s73 offen offset:0
    s_waitcnt lgkmcnt(4)
    buffer_store_dwordx4 v[92:95], v6, s[48:51], s73 offen offset:1024
    s_waitcnt lgkmcnt(3)
    buffer_store_dwordx4 v[96:99], v6, s[48:51], s74 offen offset:0
    s_waitcnt lgkmcnt(2)
    buffer_store_dwordx4 v[100:103], v6, s[48:51], s74 offen offset:1024
    s_waitcnt lgkmcnt(1)
    buffer_store_dwordx4 v[104:107], v6, s[48:51], s75 offen offset:0
    s_waitcnt lgkmcnt(0)
    buffer_store_dwordx4 v[108:111], v6, s[48:51], s75 offen offset:1024
L_ka_ker_pskip2_30:
    s_nop 3
    v_add_f32_dpp v120, v120, v120 row_ror:8 row_mask:0xf bank_mask:0xf
    v_add_f32_dpp v121, v121, v121 row_ror:8 row_mask:0xf bank_mask:0xf
    v_add_f32_dpp v122, v122, v122 row_ror:8 row_mask:0xf bank_mask:0xf
    v_add_f32_dpp v123, v123, v123 row_ror:8 row_mask:0xf bank_mask:0xf
    v_add_f32_dpp v124, v124, v124 row_ror:8 row_mask:0xf bank_mask:0xf
    v_add_f32_dpp v125, v125, v125 row_ror:8 row_mask:0xf bank_mask:0xf
    v_add_f32_dpp v126, v126, v126 row_ror:8 row_mask:0xf bank_mask:0xf
    v_add_f32_dpp v127, v127, v127 row_ror:8 row_mask:0xf bank_mask:0xf
    v_mov_b32 v112, v120
    s_nop 1
    v_permlane16_swap_b32 v120, v112
    v_add_f32 v120, v120, v112
    v_mov_b32 v112, v120
    s_nop 1
    v_permlane32_swap_b32 v120, v112
    v_add_f32 v120, v120, v112
    v_mov_b32 v113, v121
    s_nop 1
    v_permlane16_swap_b32 v121, v113
    v_add_f32 v121, v121, v113
    v_mov_b32 v113, v121
    s_nop 1
    v_permlane32_swap_b32 v121, v113
    v_add_f32 v121, v121, v113
    v_mov_b32 v114, v122
    s_nop 1
    v_permlane16_swap_b32 v122, v114
    v_add_f32 v122, v122, v114
    v_mov_b32 v114, v122
    s_nop 1
    v_permlane32_swap_b32 v122, v114
    v_add_f32 v122, v122, v114
    v_mov_b32 v115, v123
    s_nop 1
    v_permlane16_swap_b32 v123, v115
    v_add_f32 v123, v123, v115
    v_mov_b32 v115, v123
    s_nop 1
    v_permlane32_swap_b32 v123, v115
    v_add_f32 v123, v123, v115
    v_mov_b32 v112, v124
    s_nop 1
    v_permlane16_swap_b32 v124, v112
    v_add_f32 v124, v124, v112
    v_mov_b32 v112, v124
    s_nop 1
    v_permlane32_swap_b32 v124, v112
    v_add_f32 v124, v124, v112
    v_mov_b32 v113, v125
    s_nop 1
    v_permlane16_swap_b32 v125, v113
    v_add_f32 v125, v125, v113
    v_mov_b32 v113, v125
    s_nop 1
    v_permlane32_swap_b32 v125, v113
    v_add_f32 v125, v125, v113
    v_mov_b32 v114, v126
    s_nop 1
    v_permlane16_swap_b32 v126, v114
    v_add_f32 v126, v126, v114
    v_mov_b32 v114, v126
    s_nop 1
    v_permlane32_swap_b32 v126, v114
    v_add_f32 v126, v126, v114
    v_mov_b32 v115, v127
    s_nop 1
    v_permlane16_swap_b32 v127, v115
    v_add_f32 v127, v127, v115
    v_mov_b32 v115, v127
    s_nop 1
    v_permlane32_swap_b32 v127, v115
    v_add_f32 v127, v127, v115
    s_lshl_b32 s7, s6, 8
    v_lshlrev_b32 v7, 5, v4
    v_add_u32 v7, s7, v7
    s_mov_b64 exec, 0xff
    ds_write_b128 v7, v[120:123] offset:0
    ds_write_b128 v7, v[124:127] offset:16
    s_mov_b64 exec, -1
    v_perm_b32 v112, v52, v48, s12
    v_perm_b32 v113, v60, v56, s12
    v_perm_b32 v114, v68, v64, s12
    v_perm_b32 v115, v76, v72, s12
    ds_write_b128 v8, v[112:115] offset:0
    v_dot2_f32_bf16 v120, v112, s14, 0
    v_dot2_f32_bf16 v120, v113, s14, v120
    v_dot2_f32_bf16 v120, v114, s14, v120
    v_dot2_f32_bf16 v120, v115, s14, v120
    v_perm_b32 v116, v52, v48, s13
    v_perm_b32 v117, v60, v56, s13
    v_perm_b32 v118, v68, v64, s13
    v_perm_b32 v119, v76, v72, s13
    ds_write_b128 v8, v[116:119] offset:16
    v_dot2_f32_bf16 v121, v116, s14, 0
    v_dot2_f32_bf16 v121, v117, s14, v121
    v_dot2_f32_bf16 v121, v118, s14, v121
    v_dot2_f32_bf16 v121, v119, s14, v121
    v_perm_b32 v112, v53, v49, s12
    v_perm_b32 v113, v61, v57, s12
    v_perm_b32 v114, v69, v65, s12
    v_perm_b32 v115, v77, v73, s12
    ds_write_b128 v8, v[112:115] offset:32
    v_dot2_f32_bf16 v122, v112, s14, 0
    v_dot2_f32_bf16 v122, v113, s14, v122
    v_dot2_f32_bf16 v122, v114, s14, v122
    v_dot2_f32_bf16 v122, v115, s14, v122
    v_perm_b32 v116, v53, v49, s13
    v_perm_b32 v117, v61, v57, s13
    v_perm_b32 v118, v69, v65, s13
    v_perm_b32 v119, v77, v73, s13
    ds_write_b128 v8, v[116:119] offset:48
    v_dot2_f32_bf16 v123, v116, s14, 0
    v_dot2_f32_bf16 v123, v117, s14, v123
    v_dot2_f32_bf16 v123, v118, s14, v123
    v_dot2_f32_bf16 v123, v119, s14, v123
    v_perm_b32 v112, v54, v50, s12
    v_perm_b32 v113, v62, v58, s12
    v_perm_b32 v114, v70, v66, s12
    v_perm_b32 v115, v78, v74, s12
    ds_write_b128 v8, v[112:115] offset:64
    v_dot2_f32_bf16 v124, v112, s14, 0
    v_dot2_f32_bf16 v124, v113, s14, v124
    v_dot2_f32_bf16 v124, v114, s14, v124
    v_dot2_f32_bf16 v124, v115, s14, v124
    v_perm_b32 v116, v54, v50, s13
    v_perm_b32 v117, v62, v58, s13
    v_perm_b32 v118, v70, v66, s13
    v_perm_b32 v119, v78, v74, s13
    ds_write_b128 v8, v[116:119] offset:80
    v_dot2_f32_bf16 v125, v116, s14, 0
    v_dot2_f32_bf16 v125, v117, s14, v125
    v_dot2_f32_bf16 v125, v118, s14, v125
    v_dot2_f32_bf16 v125, v119, s14, v125
    v_perm_b32 v112, v55, v51, s12
    v_perm_b32 v113, v63, v59, s12
    v_perm_b32 v114, v71, v67, s12
    v_perm_b32 v115, v79, v75, s12
    ds_write_b128 v8, v[112:115] offset:96
    v_dot2_f32_bf16 v126, v112, s14, 0
    v_dot2_f32_bf16 v126, v113, s14, v126
    v_dot2_f32_bf16 v126, v114, s14, v126
    v_dot2_f32_bf16 v126, v115, s14, v126
    v_perm_b32 v116, v55, v51, s13
    v_perm_b32 v117, v63, v59, s13
    v_perm_b32 v118, v71, v67, s13
    v_perm_b32 v119, v79, v75, s13
    ds_write_b128 v8, v[116:119] offset:112
    v_dot2_f32_bf16 v127, v116, s14, 0
    v_dot2_f32_bf16 v127, v117, s14, v127
    v_dot2_f32_bf16 v127, v118, s14, v127
    v_dot2_f32_bf16 v127, v119, s14, v127
    s_waitcnt lgkmcnt(0)
    ds_read_b128 v[48:51], v9 offset:0
    ds_read_b128 v[52:55], v9 offset:1152
    ds_read_b128 v[56:59], v9 offset:2304
    ds_read_b128 v[60:63], v9 offset:3456
    ds_read_b128 v[64:67], v9 offset:4608
    ds_read_b128 v[68:71], v9 offset:5760
    ds_read_b128 v[72:75], v9 offset:6912
    ds_read_b128 v[76:79], v9 offset:8064
    s_waitcnt lgkmcnt(7)
    buffer_store_dwordx4 v[48:51], v6, s[60:63], s80 offen offset:0
    s_waitcnt lgkmcnt(6)
    buffer_store_dwordx4 v[52:55], v6, s[60:63], s80 offen offset:1024
    s_waitcnt lgkmcnt(5)
    buffer_store_dwordx4 v[56:59], v6, s[60:63], s81 offen offset:0
    s_waitcnt lgkmcnt(4)
    buffer_store_dwordx4 v[60:63], v6, s[60:63], s81 offen offset:1024
    s_waitcnt lgkmcnt(3)
    buffer_store_dwordx4 v[64:67], v6, s[60:63], s82 offen offset:0
    s_waitcnt lgkmcnt(2)
    buffer_store_dwordx4 v[68:71], v6, s[60:63], s82 offen offset:1024
    s_waitcnt lgkmcnt(1)
    buffer_store_dwordx4 v[72:75], v6, s[60:63], s83 offen offset:0
    s_waitcnt lgkmcnt(0)
    buffer_store_dwordx4 v[76:79], v6, s[60:63], s83 offen offset:1024
    s_cmp_lg_u32 s6, 1
    s_cbranch_scc1 L_ka_ker_pskip2_31
    s_add_u32 s80, s80, 14336
    s_add_u32 s81, s81, 14336
    s_add_u32 s82, s82, 14336
    s_add_u32 s83, s83, 14336
    v_perm_b32 v112, v84, v80, s12
    v_perm_b32 v113, v92, v88, s12
    v_perm_b32 v114, v100, v96, s12
    v_perm_b32 v115, v108, v104, s12
    ds_write_b128 v8, v[112:115] offset:0
    v_dot2_f32_bf16 v120, v112, s14, v120
    v_dot2_f32_bf16 v120, v113, s14, v120
    v_dot2_f32_bf16 v120, v114, s14, v120
    v_dot2_f32_bf16 v120, v115, s14, v120
    v_perm_b32 v116, v84, v80, s13
    v_perm_b32 v117, v92, v88, s13
    v_perm_b32 v118, v100, v96, s13
    v_perm_b32 v119, v108, v104, s13
    ds_write_b128 v8, v[116:119] offset:16
    v_dot2_f32_bf16 v121, v116, s14, v121
    v_dot2_f32_bf16 v121, v117, s14, v121
    v_dot2_f32_bf16 v121, v118, s14, v121
    v_dot2_f32_bf16 v121, v119, s14, v121
    v_perm_b32 v112, v85, v81, s12
    v_perm_b32 v113, v93, v89, s12
    v_perm_b32 v114, v101, v97, s12
    v_perm_b32 v115, v109, v105, s12
    ds_write_b128 v8, v[112:115] offset:32
    v_dot2_f32_bf16 v122, v112, s14, v122
    v_dot2_f32_bf16 v122, v113, s14, v122
    v_dot2_f32_bf16 v122, v114, s14, v122
    v_dot2_f32_bf16 v122, v115, s14, v122
    v_perm_b32 v116, v85, v81, s13
    v_perm_b32 v117, v93, v89, s13
    v_perm_b32 v118, v101, v97, s13
    v_perm_b32 v119, v109, v105, s13
    ds_write_b128 v8, v[116:119] offset:48
    v_dot2_f32_bf16 v123, v116, s14, v123
    v_dot2_f32_bf16 v123, v117, s14, v123
    v_dot2_f32_bf16 v123, v118, s14, v123
    v_dot2_f32_bf16 v123, v119, s14, v123
    v_perm_b32 v112, v86, v82, s12
    v_perm_b32 v113, v94, v90, s12
    v_perm_b32 v114, v102, v98, s12
    v_perm_b32 v115, v110, v106, s12
    ds_write_b128 v8, v[112:115] offset:64
    v_dot2_f32_bf16 v124, v112, s14, v124
    v_dot2_f32_bf16 v124, v113, s14, v124
    v_dot2_f32_bf16 v124, v114, s14, v124
    v_dot2_f32_bf16 v124, v115, s14, v124
    v_perm_b32 v116, v86, v82, s13
    v_perm_b32 v117, v94, v90, s13
    v_perm_b32 v118, v102, v98, s13
    v_perm_b32 v119, v110, v106, s13
    ds_write_b128 v8, v[116:119] offset:80
    v_dot2_f32_bf16 v125, v116, s14, v125
    v_dot2_f32_bf16 v125, v117, s14, v125
    v_dot2_f32_bf16 v125, v118, s14, v125
    v_dot2_f32_bf16 v125, v119, s14, v125
    v_perm_b32 v112, v87, v83, s12
    v_perm_b32 v113, v95, v91, s12
    v_perm_b32 v114, v103, v99, s12
    v_perm_b32 v115, v111, v107, s12
    ds_write_b128 v8, v[112:115] offset:96
    v_dot2_f32_bf16 v126, v112, s14, v126
    v_dot2_f32_bf16 v126, v113, s14, v126
    v_dot2_f32_bf16 v126, v114, s14, v126
    v_dot2_f32_bf16 v126, v115, s14, v126
    v_perm_b32 v116, v87, v83, s13
    v_perm_b32 v117, v95, v91, s13
    v_perm_b32 v118, v103, v99, s13
    v_perm_b32 v119, v111, v107, s13
    ds_write_b128 v8, v[116:119] offset:112
    v_dot2_f32_bf16 v127, v116, s14, v127
    v_dot2_f32_bf16 v127, v117, s14, v127
    v_dot2_f32_bf16 v127, v118, s14, v127
    v_dot2_f32_bf16 v127, v119, s14, v127
    s_waitcnt lgkmcnt(0)
    ds_read_b128 v[80:83], v9 offset:0
    ds_read_b128 v[84:87], v9 offset:1152
    ds_read_b128 v[88:91], v9 offset:2304
    ds_read_b128 v[92:95], v9 offset:3456
    ds_read_b128 v[96:99], v9 offset:4608
    ds_read_b128 v[100:103], v9 offset:5760
    ds_read_b128 v[104:107], v9 offset:6912
    ds_read_b128 v[108:111], v9 offset:8064
    s_waitcnt lgkmcnt(7)
    buffer_store_dwordx4 v[80:83], v6, s[60:63], s80 offen offset:0
    s_waitcnt lgkmcnt(6)
    buffer_store_dwordx4 v[84:87], v6, s[60:63], s80 offen offset:1024
    s_waitcnt lgkmcnt(5)
    buffer_store_dwordx4 v[88:91], v6, s[60:63], s81 offen offset:0
    s_waitcnt lgkmcnt(4)
    buffer_store_dwordx4 v[92:95], v6, s[60:63], s81 offen offset:1024
    s_waitcnt lgkmcnt(3)
    buffer_store_dwordx4 v[96:99], v6, s[60:63], s82 offen offset:0
    s_waitcnt lgkmcnt(2)
    buffer_store_dwordx4 v[100:103], v6, s[60:63], s82 offen offset:1024
    s_waitcnt lgkmcnt(1)
    buffer_store_dwordx4 v[104:107], v6, s[60:63], s83 offen offset:0
    s_waitcnt lgkmcnt(0)
    buffer_store_dwordx4 v[108:111], v6, s[60:63], s83 offen offset:1024
L_ka_ker_pskip2_31:
    s_nop 3
    v_add_f32_dpp v120, v120, v120 row_ror:8 row_mask:0xf bank_mask:0xf
    v_add_f32_dpp v121, v121, v121 row_ror:8 row_mask:0xf bank_mask:0xf
    v_add_f32_dpp v122, v122, v122 row_ror:8 row_mask:0xf bank_mask:0xf
    v_add_f32_dpp v123, v123, v123 row_ror:8 row_mask:0xf bank_mask:0xf
    v_add_f32_dpp v124, v124, v124 row_ror:8 row_mask:0xf bank_mask:0xf
    v_add_f32_dpp v125, v125, v125 row_ror:8 row_mask:0xf bank_mask:0xf
    v_add_f32_dpp v126, v126, v126 row_ror:8 row_mask:0xf bank_mask:0xf
    v_add_f32_dpp v127, v127, v127 row_ror:8 row_mask:0xf bank_mask:0xf
    v_mov_b32 v112, v120
    s_nop 1
    v_permlane16_swap_b32 v120, v112
    v_add_f32 v120, v120, v112
    v_mov_b32 v112, v120
    s_nop 1
    v_permlane32_swap_b32 v120, v112
    v_add_f32 v120, v120, v112
    v_mov_b32 v113, v121
    s_nop 1
    v_permlane16_swap_b32 v121, v113
    v_add_f32 v121, v121, v113
    v_mov_b32 v113, v121
    s_nop 1
    v_permlane32_swap_b32 v121, v113
    v_add_f32 v121, v121, v113
    v_mov_b32 v114, v122
    s_nop 1
    v_permlane16_swap_b32 v122, v114
    v_add_f32 v122, v122, v114
    v_mov_b32 v114, v122
    s_nop 1
    v_permlane32_swap_b32 v122, v114
    v_add_f32 v122, v122, v114
    v_mov_b32 v115, v123
    s_nop 1
    v_permlane16_swap_b32 v123, v115
    v_add_f32 v123, v123, v115
    v_mov_b32 v115, v123
    s_nop 1
    v_permlane32_swap_b32 v123, v115
    v_add_f32 v123, v123, v115
    v_mov_b32 v112, v124
    s_nop 1
    v_permlane16_swap_b32 v124, v112
    v_add_f32 v124, v124, v112
    v_mov_b32 v112, v124
    s_nop 1
    v_permlane32_swap_b32 v124, v112
    v_add_f32 v124, v124, v112
    v_mov_b32 v113, v125
    s_nop 1
    v_permlane16_swap_b32 v125, v113
    v_add_f32 v125, v125, v113
    v_mov_b32 v113, v125
    s_nop 1
    v_permlane32_swap_b32 v125, v113
    v_add_f32 v125, v125, v113
    v_mov_b32 v114, v126
    s_nop 1
    v_permlane16_swap_b32 v126, v114
    v_add_f32 v126, v126, v114
    v_mov_b32 v114, v126
    s_nop 1
    v_permlane32_swap_b32 v126, v114
    v_add_f32 v126, v126, v114
    v_mov_b32 v115, v127
    s_nop 1
    v_permlane16_swap_b32 v127, v115
    v_add_f32 v127, v127, v115
    v_mov_b32 v115, v127
    s_nop 1
    v_permlane32_swap_b32 v127, v115
    v_add_f32 v127, v127, v115
    s_lshl_b32 s7, s6, 8
    v_lshlrev_b32 v7, 5, v4
    v_add_u32 v7, s7, v7
    s_mov_b64 exec, 0xff
    ds_write_b128 v7, v[120:123] offset:2048
    ds_write_b128 v7, v[124:127] offset:2064
    s_mov_b64 exec, -1
    s_waitcnt lgkmcnt(0)
    s_barrier
    s_cmp_lg_u32 s6, 2
    s_cbranch_scc1 L_ka_ker_pnx_33
    v_lshlrev_b32 v7, 2, v1
    ds_read_b32 v112, v7 offset:0
    ds_read_b32 v113, v7 offset:256
    ds_read_b32 v114, v7 offset:512
    ds_read_b32 v115, v7 offset:768
    ds_read_b32 v116, v7 offset:1024
    ds_read_b32 v117, v7 offset:1280
    ds_read_b32 v118, v7 offset:1536
    ds_read_b32 v119, v7 offset:1792
    s_waitcnt lgkmcnt(0)
    v_add_f32 v112, v112, v116
    v_add_f32 v113, v113, v117
    v_add_f32 v114, v114, v118
    v_add_f32 v115, v115, v119
    v_add_f32 v112, v112, v113
    v_add_f32 v114, v114, v115
    v_add_f32 v112, v112, v114
    s_lshl_b32 s7, s4, 8
    v_add_u32 v7, s7, v7
    buffer_store_dword v112, v7, s[52:55], 0 offen
L_ka_ker_pnx_33:
    s_cmp_lg_u32 s6, 3
    s_cbranch_scc1 L_ka_ker_pnx_34
    v_lshlrev_b32 v7, 2, v1
    ds_read_b32 v112, v7 offset:2048
    ds_read_b32 v113, v7 offset:2304
    ds_read_b32 v114, v7 offset:2560
    ds_read_b32 v115, v7 offset:2816
    ds_read_b32 v116, v7 offset:3072
    ds_read_b32 v117, v7 offset:3328
    ds_read_b32 v118, v7 offset:3584
    ds_read_b32 v119, v7 offset:3840
    s_waitcnt lgkmcnt(0)
    v_add_f32 v112, v112, v116
    v_add_f32 v113, v113, v117
    v_add_f32 v114, v114, v118
    v_add_f32 v115, v115, v119
    v_add_f32 v112, v112, v113
    v_add_f32 v114, v114, v115
    v_add_f32 v112, v112, v114
    s_lshl_b32 s7, s10, 8
    v_add_u32 v7, s7, v7
    buffer_store_dword v112, v7, s[76:79], 0 offen
L_ka_ker_pnx_34:
L_ka_ker_pend_32:
    s_endpgm
L_ka_ker_qst_2:
    s_sub_u32 s3, s2, 225
    v_lshrrev_b32 v2, 3, v0
    v_and_b32 v4, 7, v0
    s_waitcnt lgkmcnt(0)
    s_mov_b32 s44, s16
    s_mov_b32 s45, s17
    s_mov_b32 s46, 2359296
    s_mov_b32 s47, 0x20000
    s_add_u32 s48, s42, 40378368
    s_addc_u32 s49, s43, 0
    s_mov_b32 s50, 65536
    s_mov_b32 s51, 0x20000
    v_lshlrev_b32 v6, 8, v0
    s_lshl_b32 s7, s3, 17
    v_add_u32 v6, s7, v6
    v_mov_b32 v7, 0
    buffer_store_dword v7, v6, s[48:51], 0 offen
    s_add_u32 s48, s42, 2359296
    s_addc_u32 s49, s43, 0
    s_mov_b32 s50, 16384
    s_mov_b32 s51, 0x20000
    s_lshl_b32 s7, s3, 8
    v_add_u32 v2, s7, v2
    s_movk_i32 s7, 1152
    v_mul_lo_u32 v5, v2, s7
    v_lshl_add_u32 v5, v4, 4, v5
    s_mov_b32 s14, 0x3f803f80
    s_mov_b32 s8, 73728
    s_mov_b32 s9, 147456
    s_mov_b32 s10, 221184
    buffer_load_dwordx4 v[16:19], v5, s[44:47], 0 offen offset:0
    buffer_load_dwordx4 v[20:23], v5, s[44:47], 0 offen offset:128
    buffer_load_dwordx4 v[24:27], v5, s[44:47], 0 offen offset:256
    buffer_load_dwordx4 v[28:31], v5, s[44:47], 0 offen offset:384
    buffer_load_dwordx4 v[32:35], v5, s[44:47], 0 offen offset:512
    buffer_load_dwordx4 v[36:39], v5, s[44:47], 0 offen offset:640
    buffer_load_dwordx4 v[40:43], v5, s[44:47], 0 offen offset:768
    buffer_load_dwordx4 v[44:47], v5, s[44:47], 0 offen offset:896
    buffer_load_dwordx4 v[48:51], v5, s[44:47], 0 offen offset:1024
    buffer_load_dwordx4 v[52:55], v5, s[44:47], s8 offen offset:0
    buffer_load_dwordx4 v[56:59], v5, s[44:47], s8 offen offset:128
    buffer_load_dwordx4 v[60:63], v5, s[44:47], s8 offen offset:256
    buffer_load_dwordx4 v[64:67], v5, s[44:47], s8 offen offset:384
    buffer_load_dwordx4 v[68:71], v5, s[44:47], s8 offen offset:512
    buffer_load_dwordx4 v[72:75], v5, s[44:47], s8 offen offset:640
    buffer_load_dwordx4 v[76:79], v5, s[44:47], s8 offen offset:768
    buffer_load_dwordx4 v[80:83], v5, s[44:47], s8 offen offset:896
    buffer_load_dwordx4 v[84:87], v5, s[44:47], s8 offen offset:1024
    s_waitcnt vmcnt(9)
    v_mov_b32 v100, 0
    v_mov_b32 v101, 0
    v_mov_b32 v102, 0
    v_mov_b32 v103, 0
    v_dot2_f32_bf16 v100, v16, s14, v100
    v_dot2_f32_bf16 v102, v16, v16, v102
    v_dot2_f32_bf16 v101, v17, s14, v101
    v_dot2_f32_bf16 v103, v17, v17, v103
    v_dot2_f32_bf16 v100, v18, s14, v100
    v_dot2_f32_bf16 v102, v18, v18, v102
    v_dot2_f32_bf16 v101, v19, s14, v101
    v_dot2_f32_bf16 v103, v19, v19, v103
    v_dot2_f32_bf16 v100, v20, s14, v100
    v_dot2_f32_bf16 v102, v20, v20, v102
    v_dot2_f32_bf16 v101, v21, s14, v101
    v_dot2_f32_bf16 v103, v21, v21, v103
    v_dot2_f32_bf16 v100, v22, s14, v100
    v_dot2_f32_bf16 v102, v22, v22, v102
    v_dot2_f32_bf16 v101, v23, s14, v101
    v_dot2_f32_bf16 v103, v23, v23, v103
    v_dot2_f32_bf16 v100, v24, s14, v100
    v_dot2_f32_bf16 v102, v24, v24, v102
    v_dot2_f32_bf16 v101, v25, s14, v101
    v_dot2_f32_bf16 v103, v25, v25, v103
    v_dot2_f32_bf16 v100, v26, s14, v100
    v_dot2_f32_bf16 v102, v26, v26, v102
    v_dot2_f32_bf16 v101, v27, s14, v101
    v_dot2_f32_bf16 v103, v27, v27, v103
    v_dot2_f32_bf16 v100, v28, s14, v100
    v_dot2_f32_bf16 v102, v28, v28, v102
    v_dot2_f32_bf16 v101, v29, s14, v101
    v_dot2_f32_bf16 v103, v29, v29, v103
    v_dot2_f32_bf16 v100, v30, s14, v100
    v_dot2_f32_bf16 v102, v30, v30, v102
    v_dot2_f32_bf16 v101, v31, s14, v101
    v_dot2_f32_bf16 v103, v31, v31, v103
    v_dot2_f32_bf16 v100, v32, s14, v100
    v_dot2_f32_bf16 v102, v32, v32, v102
    v_dot2_f32_bf16 v101, v33, s14, v101
    v_dot2_f32_bf16 v103, v33, v33, v103
    v_dot2_f32_bf16 v100, v34, s14, v100
    v_dot2_f32_bf16 v102, v34, v34, v102
    v_dot2_f32_bf16 v101, v35, s14, v101
    v_dot2_f32_bf16 v103, v35, v35, v103
    v_dot2_f32_bf16 v100, v36, s14, v100
    v_dot2_f32_bf16 v102, v36, v36, v102
    v_dot2_f32_bf16 v101, v37, s14, v101
    v_dot2_f32_bf16 v103, v37, v37, v103
    v_dot2_f32_bf16 v100, v38, s14, v100
    v_dot2_f32_bf16 v102, v38, v38, v102
    v_dot2_f32_bf16 v101, v39, s14, v101
    v_dot2_f32_bf16 v103, v39, v39, v103
    v_dot2_f32_bf16 v100, v40, s14, v100
    v_dot2_f32_bf16 v102, v40, v40, v102
    v_dot2_f32_bf16 v101, v41, s14, v101
    v_dot2_f32_bf16 v103, v41, v41, v103
    v_dot2_f32_bf16 v100, v42, s14, v100
    v_dot2_f32_bf16 v102, v42, v42, v102
    v_dot2_f32_bf16 v101, v43, s14, v101
    v_dot2_f32_bf16 v103, v43, v43, v103
    v_dot2_f32_bf16 v100, v44, s14, v100
    v_dot2_f32_bf16 v102, v44, v44, v102
    v_dot2_f32_bf16 v101, v45, s14, v101
    v_dot2_f32_bf16 v103, v45, v45, v103
    v_dot2_f32_bf16 v100, v46, s14, v100
    v_dot2_f32_bf16 v102, v46, v46, v102
    v_dot2_f32_bf16 v101, v47, s14, v101
    v_dot2_f32_bf16 v103, v47, v47, v103
    v_dot2_f32_bf16 v100, v48, s14, v100
    v_dot2_f32_bf16 v102, v48, v48, v102
    v_dot2_f32_bf16 v101, v49, s14, v101
    v_dot2_f32_bf16 v103, v49, v49, v103
    v_dot2_f32_bf16 v100, v50, s14, v100
    v_dot2_f32_bf16 v102, v50, v50, v102
    v_dot2_f32_bf16 v101, v51, s14, v101
    v_dot2_f32_bf16 v103, v51, v51, v103
    s_nop 1
    v_add_f32 v100, v100, v101
    v_add_f32 v102, v102, v103
    s_nop 0
    v_add_f32_dpp v100, v100, v100 quad_perm:[1,0,3,2] row_mask:0xf bank_mask:0xf
    v_add_f32_dpp v102, v102, v102 quad_perm:[1,0,3,2] row_mask:0xf bank_mask:0xf
    s_nop 0
    v_add_f32_dpp v100, v100, v100 quad_perm:[2,3,0,1] row_mask:0xf bank_mask:0xf
    v_add_f32_dpp v102, v102, v102 quad_perm:[2,3,0,1] row_mask:0xf bank_mask:0xf
    s_nop 0
    v_add_f32_dpp v100, v100, v100 row_half_mirror row_mask:0xf bank_mask:0xf
    v_add_f32_dpp v102, v102, v102 row_half_mirror row_mask:0xf bank_mask:0xf
    v_mul_f32 v104, 0x3ae38e39, v100
    v_mul_f32 v105, 0x3ae38e39, v102
    v_fma_f32 v105, -v104, v104, v105
    v_mov_b32 v106, v104
    v_cvt_pk_bf16_f32 v108, v106, v106
    v_lshlrev_b32 v106, 16, v108
    v_max_f32 v107, 0, v105
    v_cvt_pk_bf16_f32 v108, v107, v107
    v_lshlrev_b32 v107, 16, v108
    v_add_f32 v107, 0x3727c5ac, v107
    v_cvt_pk_bf16_f32 v108, v107, v107
    v_lshlrev_b32 v107, 16, v108
    v_sqrt_f32 v107, v107
    s_nop 0
    v_cvt_pk_bf16_f32 v108, v107, v107
    v_lshlrev_b32 v107, 16, v108
    v_rcp_f32 v107, v107
    v_lshlrev_b32 v6, 3, v2
    v_cmp_eq_u32 vcc, 0, v4
    s_nop 0
    s_and_saveexec_b64 s[12:13], vcc
    buffer_store_dwordx2 v[106:107], v6, s[48:51], 0 offen offset:0
    s_mov_b64 exec, s[12:13]
    s_waitcnt vmcnt(0)
    v_mov_b32 v100, 0
    v_mov_b32 v101, 0
    v_mov_b32 v102, 0
    v_mov_b32 v103, 0
    v_dot2_f32_bf16 v100, v52, s14, v100
    v_dot2_f32_bf16 v102, v52, v52, v102
    v_dot2_f32_bf16 v101, v53, s14, v101
    v_dot2_f32_bf16 v103, v53, v53, v103
    v_dot2_f32_bf16 v100, v54, s14, v100
    v_dot2_f32_bf16 v102, v54, v54, v102
    v_dot2_f32_bf16 v101, v55, s14, v101
    v_dot2_f32_bf16 v103, v55, v55, v103
    v_dot2_f32_bf16 v100, v56, s14, v100
    v_dot2_f32_bf16 v102, v56, v56, v102
    v_dot2_f32_bf16 v101, v57, s14, v101
    v_dot2_f32_bf16 v103, v57, v57, v103
    v_dot2_f32_bf16 v100, v58, s14, v100
    v_dot2_f32_bf16 v102, v58, v58, v102
    v_dot2_f32_bf16 v101, v59, s14, v101
    v_dot2_f32_bf16 v103, v59, v59, v103
    v_dot2_f32_bf16 v100, v60, s14, v100
    v_dot2_f32_bf16 v102, v60, v60, v102
    v_dot2_f32_bf16 v101, v61, s14, v101
    v_dot2_f32_bf16 v103, v61, v61, v103
    v_dot2_f32_bf16 v100, v62, s14, v100
    v_dot2_f32_bf16 v102, v62, v62, v102
    v_dot2_f32_bf16 v101, v63, s14, v101
    v_dot2_f32_bf16 v103, v63, v63, v103
    v_dot2_f32_bf16 v100, v64, s14, v100
    v_dot2_f32_bf16 v102, v64, v64, v102
    v_dot2_f32_bf16 v101, v65, s14, v101
    v_dot2_f32_bf16 v103, v65, v65, v103
    v_dot2_f32_bf16 v100, v66, s14, v100
    v_dot2_f32_bf16 v102, v66, v66, v102
    v_dot2_f32_bf16 v101, v67, s14, v101
    v_dot2_f32_bf16 v103, v67, v67, v103
    v_dot2_f32_bf16 v100, v68, s14, v100
    v_dot2_f32_bf16 v102, v68, v68, v102
    v_dot2_f32_bf16 v101, v69, s14, v101
    v_dot2_f32_bf16 v103, v69, v69, v103
    v_dot2_f32_bf16 v100, v70, s14, v100
    v_dot2_f32_bf16 v102, v70, v70, v102
    v_dot2_f32_bf16 v101, v71, s14, v101
    v_dot2_f32_bf16 v103, v71, v71, v103
    v_dot2_f32_bf16 v100, v72, s14, v100
    v_dot2_f32_bf16 v102, v72, v72, v102
    v_dot2_f32_bf16 v101, v73, s14, v101
    v_dot2_f32_bf16 v103, v73, v73, v103
    v_dot2_f32_bf16 v100, v74, s14, v100
    v_dot2_f32_bf16 v102, v74, v74, v102
    v_dot2_f32_bf16 v101, v75, s14, v101
    v_dot2_f32_bf16 v103, v75, v75, v103
    v_dot2_f32_bf16 v100, v76, s14, v100
    v_dot2_f32_bf16 v102, v76, v76, v102
    v_dot2_f32_bf16 v101, v77, s14, v101
    v_dot2_f32_bf16 v103, v77, v77, v103
    v_dot2_f32_bf16 v100, v78, s14, v100
    v_dot2_f32_bf16 v102, v78, v78, v102
    v_dot2_f32_bf16 v101, v79, s14, v101
    v_dot2_f32_bf16 v103, v79, v79, v103
    v_dot2_f32_bf16 v100, v80, s14, v100
    v_dot2_f32_bf16 v102, v80, v80, v102
    v_dot2_f32_bf16 v101, v81, s14, v101
    v_dot2_f32_bf16 v103, v81, v81, v103
    v_dot2_f32_bf16 v100, v82, s14, v100
    v_dot2_f32_bf16 v102, v82, v82, v102
    v_dot2_f32_bf16 v101, v83, s14, v101
    v_dot2_f32_bf16 v103, v83, v83, v103
    v_dot2_f32_bf16 v100, v84, s14, v100
    v_dot2_f32_bf16 v102, v84, v84, v102
    v_dot2_f32_bf16 v101, v85, s14, v101
    v_dot2_f32_bf16 v103, v85, v85, v103
    v_dot2_f32_bf16 v100, v86, s14, v100
    v_dot2_f32_bf16 v102, v86, v86, v102
    v_dot2_f32_bf16 v101, v87, s14, v101
    v_dot2_f32_bf16 v103, v87, v87, v103
    s_nop 1
    v_add_f32 v100, v100, v101
    v_add_f32 v102, v102, v103
    s_nop 0
    v_add_f32_dpp v100, v100, v100 quad_perm:[1,0,3,2] row_mask:0xf bank_mask:0xf
    v_add_f32_dpp v102, v102, v102 quad_perm:[1,0,3,2] row_mask:0xf bank_mask:0xf
    s_nop 0
    v_add_f32_dpp v100, v100, v100 quad_perm:[2,3,0,1] row_mask:0xf bank_mask:0xf
    v_add_f32_dpp v102, v102, v102 quad_perm:[2,3,0,1] row_mask:0xf bank_mask:0xf
    s_nop 0
    v_add_f32_dpp v100, v100, v100 row_half_mirror row_mask:0xf bank_mask:0xf
    v_add_f32_dpp v102, v102, v102 row_half_mirror row_mask:0xf bank_mask:0xf
    v_mul_f32 v104, 0x3ae38e39, v100
    v_mul_f32 v105, 0x3ae38e39, v102
    v_fma_f32 v105, -v104, v104, v105
    v_mov_b32 v106, v104
    v_cvt_pk_bf16_f32 v108, v106, v106
    v_lshlrev_b32 v106, 16, v108
    v_max_f32 v107, 0, v105
    v_cvt_pk_bf16_f32 v108, v107, v107
    v_lshlrev_b32 v107, 16, v108
    v_add_f32 v107, 0x3727c5ac, v107
    v_cvt_pk_bf16_f32 v108, v107, v107
    v_lshlrev_b32 v107, 16, v108
    v_sqrt_f32 v107, v107
    s_nop 0
    v_cvt_pk_bf16_f32 v108, v107, v107
    v_lshlrev_b32 v107, 16, v108
    v_rcp_f32 v107, v107
    v_lshlrev_b32 v6, 3, v2
    v_cmp_eq_u32 vcc, 0, v4
    s_nop 0
    s_and_saveexec_b64 s[12:13], vcc
    buffer_store_dwordx2 v[106:107], v6, s[48:51], 0 offen offset:512
    s_mov_b64 exec, s[12:13]
    buffer_load_dwordx4 v[16:19], v5, s[44:47], s9 offen offset:0
    buffer_load_dwordx4 v[20:23], v5, s[44:47], s9 offen offset:128
    buffer_load_dwordx4 v[24:27], v5, s[44:47], s9 offen offset:256
    buffer_load_dwordx4 v[28:31], v5, s[44:47], s9 offen offset:384
    buffer_load_dwordx4 v[32:35], v5, s[44:47], s9 offen offset:512
    buffer_load_dwordx4 v[36:39], v5, s[44:47], s9 offen offset:640
    buffer_load_dwordx4 v[40:43], v5, s[44:47], s9 offen offset:768
    buffer_load_dwordx4 v[44:47], v5, s[44:47], s9 offen offset:896
    buffer_load_dwordx4 v[48:51], v5, s[44:47], s9 offen offset:1024
    buffer_load_dwordx4 v[52:55], v5, s[44:47], s10 offen offset:0
    buffer_load_dwordx4 v[56:59], v5, s[44:47], s10 offen offset:128
    buffer_load_dwordx4 v[60:63], v5, s[44:47], s10 offen offset:256
    buffer_load_dwordx4 v[64:67], v5, s[44:47], s10 offen offset:384
    buffer_load_dwordx4 v[68:71], v5, s[44:47], s10 offen offset:512
    buffer_load_dwordx4 v[72:75], v5, s[44:47], s10 offen offset:640
    buffer_load_dwordx4 v[76:79], v5, s[44:47], s10 offen offset:768
    buffer_load_dwordx4 v[80:83], v5, s[44:47], s10 offen offset:896
    buffer_load_dwordx4 v[84:87], v5, s[44:47], s10 offen offset:1024
    s_waitcnt vmcnt(9)
    v_mov_b32 v100, 0
    v_mov_b32 v101, 0
    v_mov_b32 v102, 0
    v_mov_b32 v103, 0
    v_dot2_f32_bf16 v100, v16, s14, v100
    v_dot2_f32_bf16 v102, v16, v16, v102
    v_dot2_f32_bf16 v101, v17, s14, v101
    v_dot2_f32_bf16 v103, v17, v17, v103
    v_dot2_f32_bf16 v100, v18, s14, v100
    v_dot2_f32_bf16 v102, v18, v18, v102
    v_dot2_f32_bf16 v101, v19, s14, v101
    v_dot2_f32_bf16 v103, v19, v19, v103
    v_dot2_f32_bf16 v100, v20, s14, v100
    v_dot2_f32_bf16 v102, v20, v20, v102
    v_dot2_f32_bf16 v101, v21, s14, v101
    v_dot2_f32_bf16 v103, v21, v21, v103
    v_dot2_f32_bf16 v100, v22, s14, v100
    v_dot2_f32_bf16 v102, v22, v22, v102
    v_dot2_f32_bf16 v101, v23, s14, v101
    v_dot2_f32_bf16 v103, v23, v23, v103
    v_dot2_f32_bf16 v100, v24, s14, v100
    v_dot2_f32_bf16 v102, v24, v24, v102
    v_dot2_f32_bf16 v101, v25, s14, v101
    v_dot2_f32_bf16 v103, v25, v25, v103
    v_dot2_f32_bf16 v100, v26, s14, v100
    v_dot2_f32_bf16 v102, v26, v26, v102
    v_dot2_f32_bf16 v101, v27, s14, v101
    v_dot2_f32_bf16 v103, v27, v27, v103
    v_dot2_f32_bf16 v100, v28, s14, v100
    v_dot2_f32_bf16 v102, v28, v28, v102
    v_dot2_f32_bf16 v101, v29, s14, v101
    v_dot2_f32_bf16 v103, v29, v29, v103
    v_dot2_f32_bf16 v100, v30, s14, v100
    v_dot2_f32_bf16 v102, v30, v30, v102
    v_dot2_f32_bf16 v101, v31, s14, v101
    v_dot2_f32_bf16 v103, v31, v31, v103
    v_dot2_f32_bf16 v100, v32, s14, v100
    v_dot2_f32_bf16 v102, v32, v32, v102
    v_dot2_f32_bf16 v101, v33, s14, v101
    v_dot2_f32_bf16 v103, v33, v33, v103
    v_dot2_f32_bf16 v100, v34, s14, v100
    v_dot2_f32_bf16 v102, v34, v34, v102
    v_dot2_f32_bf16 v101, v35, s14, v101
    v_dot2_f32_bf16 v103, v35, v35, v103
    v_dot2_f32_bf16 v100, v36, s14, v100
    v_dot2_f32_bf16 v102, v36, v36, v102
    v_dot2_f32_bf16 v101, v37, s14, v101
    v_dot2_f32_bf16 v103, v37, v37, v103
    v_dot2_f32_bf16 v100, v38, s14, v100
    v_dot2_f32_bf16 v102, v38, v38, v102
    v_dot2_f32_bf16 v101, v39, s14, v101
    v_dot2_f32_bf16 v103, v39, v39, v103
    v_dot2_f32_bf16 v100, v40, s14, v100
    v_dot2_f32_bf16 v102, v40, v40, v102
    v_dot2_f32_bf16 v101, v41, s14, v101
    v_dot2_f32_bf16 v103, v41, v41, v103
    v_dot2_f32_bf16 v100, v42, s14, v100
    v_dot2_f32_bf16 v102, v42, v42, v102
    v_dot2_f32_bf16 v101, v43, s14, v101
    v_dot2_f32_bf16 v103, v43, v43, v103
    v_dot2_f32_bf16 v100, v44, s14, v100
    v_dot2_f32_bf16 v102, v44, v44, v102
    v_dot2_f32_bf16 v101, v45, s14, v101
    v_dot2_f32_bf16 v103, v45, v45, v103
    v_dot2_f32_bf16 v100, v46, s14, v100
    v_dot2_f32_bf16 v102, v46, v46, v102
    v_dot2_f32_bf16 v101, v47, s14, v101
    v_dot2_f32_bf16 v103, v47, v47, v103
    v_dot2_f32_bf16 v100, v48, s14, v100
    v_dot2_f32_bf16 v102, v48, v48, v102
    v_dot2_f32_bf16 v101, v49, s14, v101
    v_dot2_f32_bf16 v103, v49, v49, v103
    v_dot2_f32_bf16 v100, v50, s14, v100
    v_dot2_f32_bf16 v102, v50, v50, v102
    v_dot2_f32_bf16 v101, v51, s14, v101
    v_dot2_f32_bf16 v103, v51, v51, v103
    s_nop 1
    v_add_f32 v100, v100, v101
    v_add_f32 v102, v102, v103
    s_nop 0
    v_add_f32_dpp v100, v100, v100 quad_perm:[1,0,3,2] row_mask:0xf bank_mask:0xf
    v_add_f32_dpp v102, v102, v102 quad_perm:[1,0,3,2] row_mask:0xf bank_mask:0xf
    s_nop 0
    v_add_f32_dpp v100, v100, v100 quad_perm:[2,3,0,1] row_mask:0xf bank_mask:0xf
    v_add_f32_dpp v102, v102, v102 quad_perm:[2,3,0,1] row_mask:0xf bank_mask:0xf
    s_nop 0
    v_add_f32_dpp v100, v100, v100 row_half_mirror row_mask:0xf bank_mask:0xf
    v_add_f32_dpp v102, v102, v102 row_half_mirror row_mask:0xf bank_mask:0xf
    v_mul_f32 v104, 0x3ae38e39, v100
    v_mul_f32 v105, 0x3ae38e39, v102
    v_fma_f32 v105, -v104, v104, v105
    v_mov_b32 v106, v104
    v_cvt_pk_bf16_f32 v108, v106, v106
    v_lshlrev_b32 v106, 16, v108
    v_max_f32 v107, 0, v105
    v_cvt_pk_bf16_f32 v108, v107, v107
    v_lshlrev_b32 v107, 16, v108
    v_add_f32 v107, 0x3727c5ac, v107
    v_cvt_pk_bf16_f32 v108, v107, v107
    v_lshlrev_b32 v107, 16, v108
    v_sqrt_f32 v107, v107
    s_nop 0
    v_cvt_pk_bf16_f32 v108, v107, v107
    v_lshlrev_b32 v107, 16, v108
    v_rcp_f32 v107, v107
    v_lshlrev_b32 v6, 3, v2
    v_cmp_eq_u32 vcc, 0, v4
    s_nop 0
    s_and_saveexec_b64 s[12:13], vcc
    buffer_store_dwordx2 v[106:107], v6, s[48:51], 0 offen offset:1024
    s_mov_b64 exec, s[12:13]
    s_waitcnt vmcnt(0)
    v_mov_b32 v100, 0
    v_mov_b32 v101, 0
    v_mov_b32 v102, 0
    v_mov_b32 v103, 0
    v_dot2_f32_bf16 v100, v52, s14, v100
    v_dot2_f32_bf16 v102, v52, v52, v102
    v_dot2_f32_bf16 v101, v53, s14, v101
    v_dot2_f32_bf16 v103, v53, v53, v103
    v_dot2_f32_bf16 v100, v54, s14, v100
    v_dot2_f32_bf16 v102, v54, v54, v102
    v_dot2_f32_bf16 v101, v55, s14, v101
    v_dot2_f32_bf16 v103, v55, v55, v103
    v_dot2_f32_bf16 v100, v56, s14, v100
    v_dot2_f32_bf16 v102, v56, v56, v102
    v_dot2_f32_bf16 v101, v57, s14, v101
    v_dot2_f32_bf16 v103, v57, v57, v103
    v_dot2_f32_bf16 v100, v58, s14, v100
    v_dot2_f32_bf16 v102, v58, v58, v102
    v_dot2_f32_bf16 v101, v59, s14, v101
    v_dot2_f32_bf16 v103, v59, v59, v103
    v_dot2_f32_bf16 v100, v60, s14, v100
    v_dot2_f32_bf16 v102, v60, v60, v102
    v_dot2_f32_bf16 v101, v61, s14, v101
    v_dot2_f32_bf16 v103, v61, v61, v103
    v_dot2_f32_bf16 v100, v62, s14, v100
    v_dot2_f32_bf16 v102, v62, v62, v102
    v_dot2_f32_bf16 v101, v63, s14, v101
    v_dot2_f32_bf16 v103, v63, v63, v103
    v_dot2_f32_bf16 v100, v64, s14, v100
    v_dot2_f32_bf16 v102, v64, v64, v102
    v_dot2_f32_bf16 v101, v65, s14, v101
    v_dot2_f32_bf16 v103, v65, v65, v103
    v_dot2_f32_bf16 v100, v66, s14, v100
    v_dot2_f32_bf16 v102, v66, v66, v102
    v_dot2_f32_bf16 v101, v67, s14, v101
    v_dot2_f32_bf16 v103, v67, v67, v103
    v_dot2_f32_bf16 v100, v68, s14, v100
    v_dot2_f32_bf16 v102, v68, v68, v102
    v_dot2_f32_bf16 v101, v69, s14, v101
    v_dot2_f32_bf16 v103, v69, v69, v103
    v_dot2_f32_bf16 v100, v70, s14, v100
    v_dot2_f32_bf16 v102, v70, v70, v102
    v_dot2_f32_bf16 v101, v71, s14, v101
    v_dot2_f32_bf16 v103, v71, v71, v103
    v_dot2_f32_bf16 v100, v72, s14, v100
    v_dot2_f32_bf16 v102, v72, v72, v102
    v_dot2_f32_bf16 v101, v73, s14, v101
    v_dot2_f32_bf16 v103, v73, v73, v103
    v_dot2_f32_bf16 v100, v74, s14, v100
    v_dot2_f32_bf16 v102, v74, v74, v102
    v_dot2_f32_bf16 v101, v75, s14, v101
    v_dot2_f32_bf16 v103, v75, v75, v103
    v_dot2_f32_bf16 v100, v76, s14, v100
    v_dot2_f32_bf16 v102, v76, v76, v102
    v_dot2_f32_bf16 v101, v77, s14, v101
    v_dot2_f32_bf16 v103, v77, v77, v103
    v_dot2_f32_bf16 v100, v78, s14, v100
    v_dot2_f32_bf16 v102, v78, v78, v102
    v_dot2_f32_bf16 v101, v79, s14, v101
    v_dot2_f32_bf16 v103, v79, v79, v103
    v_dot2_f32_bf16 v100, v80, s14, v100
    v_dot2_f32_bf16 v102, v80, v80, v102
    v_dot2_f32_bf16 v101, v81, s14, v101
    v_dot2_f32_bf16 v103, v81, v81, v103
    v_dot2_f32_bf16 v100, v82, s14, v100
    v_dot2_f32_bf16 v102, v82, v82, v102
    v_dot2_f32_bf16 v101, v83, s14, v101
    v_dot2_f32_bf16 v103, v83, v83, v103
    v_dot2_f32_bf16 v100, v84, s14, v100
    v_dot2_f32_bf16 v102, v84, v84, v102
    v_dot2_f32_bf16 v101, v85, s14, v101
    v_dot2_f32_bf16 v103, v85, v85, v103
    v_dot2_f32_bf16 v100, v86, s14, v100
    v_dot2_f32_bf16 v102, v86, v86, v102
    v_dot2_f32_bf16 v101, v87, s14, v101
    v_dot2_f32_bf16 v103, v87, v87, v103
    s_nop 1
    v_add_f32 v100, v100, v101
    v_add_f32 v102, v102, v103
    s_nop 0
    v_add_f32_dpp v100, v100, v100 quad_perm:[1,0,3,2] row_mask:0xf bank_mask:0xf
    v_add_f32_dpp v102, v102, v102 quad_perm:[1,0,3,2] row_mask:0xf bank_mask:0xf
    s_nop 0
    v_add_f32_dpp v100, v100, v100 quad_perm:[2,3,0,1] row_mask:0xf bank_mask:0xf
    v_add_f32_dpp v102, v102, v102 quad_perm:[2,3,0,1] row_mask:0xf bank_mask:0xf
    s_nop 0
    v_add_f32_dpp v100, v100, v100 row_half_mirror row_mask:0xf bank_mask:0xf
    v_add_f32_dpp v102, v102, v102 row_half_mirror row_mask:0xf bank_mask:0xf
    v_mul_f32 v104, 0x3ae38e39, v100
    v_mul_f32 v105, 0x3ae38e39, v102
    v_fma_f32 v105, -v104, v104, v105
    v_mov_b32 v106, v104
    v_cvt_pk_bf16_f32 v108, v106, v106
    v_lshlrev_b32 v106, 16, v108
    v_max_f32 v107, 0, v105
    v_cvt_pk_bf16_f32 v108, v107, v107
    v_lshlrev_b32 v107, 16, v108
    v_add_f32 v107, 0x3727c5ac, v107
    v_cvt_pk_bf16_f32 v108, v107, v107
    v_lshlrev_b32 v107, 16, v108
    v_sqrt_f32 v107, v107
    s_nop 0
    v_cvt_pk_bf16_f32 v108, v107, v107
    v_lshlrev_b32 v107, 16, v108
    v_rcp_f32 v107, v107
    v_lshlrev_b32 v6, 3, v2
    v_cmp_eq_u32 vcc, 0, v4
    s_nop 0
    s_and_saveexec_b64 s[12:13], vcc
    buffer_store_dwordx2 v[106:107], v6, s[48:51], 0 offen offset:1536
    s_mov_b64 exec, s[12:13]
    s_endpgm
L_ka_ker_exit_3:
    s_endpgm

.globl kg_kernel
.p2align 8
.type kg_kernel,@function
kg_kernel:
    s_load_dwordx16 s[16:31], s[0:1], 0
    s_load_dwordx8 s[32:39], s[0:1], 64
    s_load_dwordx4 s[40:43], s[0:1], 96
    s_cmp_ge_u32 s2, 256
    s_cbranch_scc1 L_kg_ker_exit_1
    s_and_b32 s7, s2, 7
    s_lshr_b32 s8, s2, 3
    s_and_b32 s3, s7, 3
    s_lshl_b32 s3, s3, 1
    s_and_b32 s9, s8, 1
    s_add_u32 s3, s3, s9
    s_lshr_b32 s4, s7, 2
    s_lshl_b32 s4, s4, 4
    s_lshr_b32 s9, s8, 1
    s_add_u32 s4, s4, s9
    s_mul_hi_u32 s5, s4, 477218589
    s_mul_i32 s5, s5, 9
    s_sub_u32 s5, s4, s5
    v_lshrrev_b32 v2, 6, v0
    v_and_b32 v1, 63, v0
    v_readfirstlane_b32 s6, v2
    v_lshlrev_b32 v2, 4, v1
    v_and_b32 v3, 15, v1
    v_lshrrev_b32 v4, 4, v1
    s_waitcnt lgkmcnt(0)
    s_lshl_b32 s68, s4, 1
    s_lshr_b32 s7, s3, 2
    s_add_u32 s68, s68, s7
    s_and_b32 s69, s3, 3
    s_and_b32 s70, s6, 1
    s_lshr_b32 s71, s6, 1
    s_add_u32 s44, s42, 9535488
    s_addc_u32 s45, s43, 0
    s_mov_b32 s46, 663552
    s_mov_b32 s47, 0x20000
    s_mov_b32 s48, s16
    s_mov_b32 s49, s17
    s_mov_b32 s50, 2359296
    s_mov_b32 s51, 0x20000
    s_mov_b32 s52, s42
    s_mov_b32 s53, s43
    s_mov_b32 s54, 2359296
    s_mov_b32 s55, 0x20000
    s_add_u32 s56, s42, 2359296
    s_addc_u32 s57, s43, 0
    s_mov_b32 s58, 16384
    s_mov_b32 s59, 0x20000
    s_add_u32 s60, s42, 2375680
    s_addc_u32 s61, s43, 0
    s_mov_b32 s62, 2359296
    s_mov_b32 s63, 0x20000
    s_add_u32 s64, s42, 4751360
    s_addc_u32 s65, s43, 0
    s_mov_b32 s66, 2359296
    s_mov_b32 s67, 0x20000
    s_add_u32 s72, s42, 10862592
    s_addc_u32 s73, s43, 0
    s_mov_b32 s74, 2304
    s_mov_b32 s75, 0x20000
    s_add_u32 s76, s42, 40378368
    s_addc_u32 s77, s43, 0
    s_lshl_b32 s7, s68, 5
    v_add_u32 v5, s7, v3
    s_lshl_b32 s7, s70, 4
    v_add_u32 v6, s7, v5
    v_lshlrev_b32 v7, 3, v6
    buffer_load_dwordx2 v[148:149], v7, s[56:59], 0 offen
    s_movk_i32 s15, 1152
    v_mul_lo_u32 v8, v6, s15
    v_lshl_add_u32 v8, v4, 4, v8
    s_mul_i32 s7, s71, 576
    v_add_u32 v8, s7, v8
    v_lshl_add_u32 v9, v4, 15, v7
    s_mul_i32 s7, s71, 1179648
    v_add_u32 v9, s7, v9
    v_add_u32 v10, 16384, v9
    s_mov_b32 s8, 0
    buffer_load_dwordx4 v[76:79], v8, s[48:51], 0 offen offset:0
    buffer_load_dwordx2 v[112:113], v9, s[52:55], s8 offen
    buffer_load_dwordx2 v[114:115], v10, s[52:55], s8 offen
    s_add_u32 s8, s8, 131072
    buffer_load_dwordx4 v[80:83], v8, s[48:51], 0 offen offset:64
    buffer_load_dwordx2 v[116:117], v9, s[52:55], s8 offen
    buffer_load_dwordx2 v[118:119], v10, s[52:55], s8 offen
    s_add_u32 s8, s8, 131072
    buffer_load_dwordx4 v[84:87], v8, s[48:51], 0 offen offset:128
    buffer_load_dwordx2 v[120:121], v9, s[52:55], s8 offen
    buffer_load_dwordx2 v[122:123], v10, s[52:55], s8 offen
    s_add_u32 s8, s8, 131072
    buffer_load_dwordx4 v[88:91], v8, s[48:51], 0 offen offset:192
    buffer_load_dwordx2 v[124:125], v9, s[52:55], s8 offen
    buffer_load_dwordx2 v[126:127], v10, s[52:55], s8 offen
    s_add_u32 s8, s8, 131072
    buffer_load_dwordx4 v[92:95], v8, s[48:51], 0 offen offset:256
    buffer_load_dwordx2 v[128:129], v9, s[52:55], s8 offen
    buffer_load_dwordx2 v[130:131], v10, s[52:55], s8 offen
    s_add_u32 s8, s8, 131072
    buffer_load_dwordx4 v[96:99], v8, s[48:51], 0 offen offset:320
    buffer_load_dwordx2 v[132:133], v9, s[52:55], s8 offen
    buffer_load_dwordx2 v[134:135], v10, s[52:55], s8 offen
    s_add_u32 s8, s8, 131072
    buffer_load_dwordx4 v[100:103], v8, s[48:51], 0 offen offset:384
    buffer_load_dwordx2 v[136:137], v9, s[52:55], s8 offen
    buffer_load_dwordx2 v[138:139], v10, s[52:55], s8 offen
    s_add_u32 s8, s8, 131072
    buffer_load_dwordx4 v[104:107], v8, s[48:51], 0 offen offset:448
    buffer_load_dwordx2 v[140:141], v9, s[52:55], s8 offen
    buffer_load_dwordx2 v[142:143], v10, s[52:55], s8 offen
    s_add_u32 s8, s8, 131072
    buffer_load_dwordx4 v[108:111], v8, s[48:51], 0 offen offset:512
    buffer_load_dwordx2 v[144:145], v9, s[52:55], s8 offen
    buffer_load_dwordx2 v[146:147], v10, s[52:55], s8 offen
    s_mul_i32 s9, s69, 9
    s_add_u32 s9, s9, s6
    s_mul_i32 s10, s9, 18432
    s_lshl_b32 s7, s9, 6
    v_lshlrev_b32 v11, 4, v4
    v_add_u32 v11, s7, v11
    buffer_load_dwordx4 v[152:155], v11, s[72:75], 0 offen offset:0
    buffer_load_dwordx4 v[156:159], v11, s[72:75], 0 offen offset:256
    buffer_load_dwordx4 v[160:163], v11, s[72:75], 0 offen offset:512
    s_mov_b32 s12, 0x3f803f80
    s_mov_b32 s13, 0x00003f80
    s_mov_b32 s14, 0x3f800000
    s_mov_b32 s78, 0xffff0000
    s_mul_i32 s7, s70, 18432
    s_mul_i32 s8, s71, 9216
    s_add_u32 s7, s7, s8
    v_add_u32 v7, s7, v2
    s_mul_i32 s79, s71, 9
    s_waitcnt vmcnt(27)
    v_xor_b32 v148, 0x80000000, v148
    v_dot2_f32_bf16 v20, v76, s13, v148
    v_dot2_f32_bf16 v21, v76, s14, v148
    v_dot2_f32_bf16 v22, v77, s13, v148
    v_dot2_f32_bf16 v23, v77, s14, v148
    v_dot2_f32_bf16 v24, v78, s13, v148
    v_dot2_f32_bf16 v25, v78, s14, v148
    v_dot2_f32_bf16 v26, v79, s13, v148
    v_dot2_f32_bf16 v27, v79, s14, v148
    v_and_b32 v12, 0xffff, v112
    v_and_b32 v13, s78, v112
    v_and_b32 v14, 0xffff, v113
    v_and_b32 v15, s78, v113
    v_and_b32 v16, 0xffff, v114
    v_and_b32 v17, s78, v114
    v_and_b32 v18, 0xffff, v115
    v_and_b32 v19, s78, v115
    s_add_u32 s11, s10, 0
    buffer_load_dwordx4 a[0:3], v2, s[44:47], s11 offen offset:0
    v_cvt_pk_bf16_f32 v28, v20, v21
    v_lshlrev_b32 v20, 16, v28
    v_and_b32 v21, 0xffff0000, v28
    v_cvt_pk_bf16_f32 v29, v22, v23
    v_lshlrev_b32 v22, 16, v29
    v_and_b32 v23, 0xffff0000, v29
    v_cvt_pk_bf16_f32 v30, v24, v25
    v_lshlrev_b32 v24, 16, v30
    v_and_b32 v25, 0xffff0000, v30
    v_cvt_pk_bf16_f32 v31, v26, v27
    v_lshlrev_b32 v26, 16, v31
    v_and_b32 v27, 0xffff0000, v31
    v_mul_f32 v20, v20, v149
    v_mul_f32 v21, v21, v149
    v_mul_f32 v22, v22, v149
    v_mul_f32 v23, v23, v149
    buffer_load_dwordx4 a[4:7], v2, s[44:47], s11 offen offset:1024
    v_mul_f32 v24, v24, v149
    v_mul_f32 v25, v25, v149
    v_mul_f32 v26, v26, v149
    v_mul_f32 v27, v27, v149
    v_cvt_pk_bf16_f32 v28, v20, v21
    v_cvt_pk_bf16_f32 v29, v22, v23
    v_cvt_pk_bf16_f32 v30, v24, v25
    v_cvt_pk_bf16_f32 v31, v26, v27
    v_dot2_f32_bf16 v20, v28, v12, 0
    v_dot2_f32_bf16 v21, v28, v13, 0
    v_dot2_f32_bf16 v22, v29, v14, 0
    v_dot2_f32_bf16 v23, v29, v15, 0
    v_dot2_f32_bf16 v24, v30, v16, 0
    v_dot2_f32_bf16 v25, v30, v17, 0
    v_dot2_f32_bf16 v26, v31, v18, 0
    v_dot2_f32_bf16 v27, v31, v19, 0
    buffer_load_dwordx4 a[8:11], v2, s[44:47], s11 offen offset:2048
    v_lshlrev_b32 v12, 16, v76
    v_and_b32 v13, 0xffff0000, v76
    v_lshlrev_b32 v14, 16, v77
    v_and_b32 v15, 0xffff0000, v77
    v_lshlrev_b32 v16, 16, v78
    v_and_b32 v17, 0xffff0000, v78
    v_lshlrev_b32 v18, 16, v79
    v_and_b32 v19, 0xffff0000, v79
    v_cvt_pk_bf16_f32 v28, v20, v21
    v_cvt_pk_bf16_f32 v29, v22, v23
    v_cvt_pk_bf16_f32 v30, v24, v25
    v_cvt_pk_bf16_f32 v31, v26, v27
    v_dot2_f32_bf16 v20, v28, s13, v12
    v_dot2_f32_bf16 v21, v28, s14, v13
    v_dot2_f32_bf16 v22, v29, s13, v14
    v_dot2_f32_bf16 v23, v29, s14, v15
    buffer_load_dwordx4 a[12:15], v2, s[44:47], s11 offen offset:3072
    v_dot2_f32_bf16 v24, v30, s13, v16
    v_dot2_f32_bf16 v25, v30, s14, v17
    v_dot2_f32_bf16 v26, v31, s13, v18
    v_dot2_f32_bf16 v27, v31, s14, v19
    v_cvt_pk_bf16_f32 v76, v20, v21
    v_cvt_pk_bf16_f32 v77, v22, v23
    v_cvt_pk_bf16_f32 v78, v24, v25
    v_cvt_pk_bf16_f32 v79, v26, v27
    ds_write_b128 v7, v[76:79] offset:0
    v_dot2_f32_bf16 v32, v76, s12, 0
    v_dot2_f32_bf16 v33, v76, v76, 0
    v_dot2_f32_bf16 v32, v77, s12, v32
    v_dot2_f32_bf16 v33, v77, v77, v33
    v_dot2_f32_bf16 v32, v78, s12, v32
    v_dot2_f32_bf16 v33, v78, v78, v33
    v_dot2_f32_bf16 v32, v79, s12, v32
    v_dot2_f32_bf16 v33, v79, v79, v33
    s_waitcnt vmcnt(28)
    v_dot2_f32_bf16 v20, v80, s13, v148
    v_dot2_f32_bf16 v21, v80, s14, v148
    v_dot2_f32_bf16 v22, v81, s13, v148
    v_dot2_f32_bf16 v23, v81, s14, v148
    v_dot2_f32_bf16 v24, v82, s13, v148
    v_dot2_f32_bf16 v25, v82, s14, v148
    v_dot2_f32_bf16 v26, v83, s13, v148
    v_dot2_f32_bf16 v27, v83, s14, v148
    v_and_b32 v12, 0xffff, v116
    v_and_b32 v13, s78, v116
    v_and_b32 v14, 0xffff, v117
    v_and_b32 v15, s78, v117
    v_and_b32 v16, 0xffff, v118
    v_and_b32 v17, s78, v118
    v_and_b32 v18, 0xffff, v119
    v_and_b32 v19, s78, v119
    s_add_u32 s11, s10, 4096
    buffer_load_dwordx4 a[16:19], v2, s[44:47], s11 offen offset:0
    v_cvt_pk_bf16_f32 v28, v20, v21
    v_lshlrev_b32 v20, 16, v28
    v_and_b32 v21, 0xffff0000, v28
    v_cvt_pk_bf16_f32 v29, v22, v23
    v_lshlrev_b32 v22, 16, v29
    v_and_b32 v23, 0xffff0000, v29
    v_cvt_pk_bf16_f32 v30, v24, v25
    v_lshlrev_b32 v24, 16, v30
    v_and_b32 v25, 0xffff0000, v30
    v_cvt_pk_bf16_f32 v31, v26, v27
    v_lshlrev_b32 v26, 16, v31
    v_and_b32 v27, 0xffff0000, v31
    v_mul_f32 v20, v20, v149
    v_mul_f32 v21, v21, v149
    v_mul_f32 v22, v22, v149
    v_mul_f32 v23, v23, v149
    buffer_load_dwordx4 a[20:23], v2, s[44:47], s11 offen offset:1024
    v_mul_f32 v24, v24, v149
    v_mul_f32 v25, v25, v149
    v_mul_f32 v26, v26, v149
    v_mul_f32 v27, v27, v149
    v_cvt_pk_bf16_f32 v28, v20, v21
    v_cvt_pk_bf16_f32 v29, v22, v23
    v_cvt_pk_bf16_f32 v30, v24, v25
    v_cvt_pk_bf16_f32 v31, v26, v27
    v_dot2_f32_bf16 v20, v28, v12, 0
    v_dot2_f32_bf16 v21, v28, v13, 0
    v_dot2_f32_bf16 v22, v29, v14, 0
    v_dot2_f32_bf16 v23, v29, v15, 0
    v_dot2_f32_bf16 v24, v30, v16, 0
    v_dot2_f32_bf16 v25, v30, v17, 0
    v_dot2_f32_bf16 v26, v31, v18, 0
    v_dot2_f32_bf16 v27, v31, v19, 0
    buffer_load_dwordx4 a[24:27], v2, s[44:47], s11 offen offset:2048
    v_lshlrev_b32 v12, 16, v80
    v_and_b32 v13, 0xffff0000, v80
    v_lshlrev_b32 v14, 16, v81
    v_and_b32 v15, 0xffff0000, v81
    v_lshlrev_b32 v16, 16, v82
    v_and_b32 v17, 0xffff0000, v82
    v_lshlrev_b32 v18, 16, v83
    v_and_b32 v19, 0xffff0000, v83
    v_cvt_pk_bf16_f32 v28, v20, v21
    v_cvt_pk_bf16_f32 v29, v22, v23
    v_cvt_pk_bf16_f32 v30, v24, v25
    v_cvt_pk_bf16_f32 v31, v26, v27
    v_dot2_f32_bf16 v20, v28, s13, v12
    v_dot2_f32_bf16 v21, v28, s14, v13
    v_dot2_f32_bf16 v22, v29, s13, v14
    v_dot2_f32_bf16 v23, v29, s14, v15
    buffer_load_dwordx4 a[28:31], v2, s[44:47], s11 offen offset:3072
    v_dot2_f32_bf16 v24, v30, s13, v16
    v_dot2_f32_bf16 v25, v30, s14, v17
    v_dot2_f32_bf16 v26, v31, s13, v18
    v_dot2_f32_bf16 v27, v31, s14, v19
    v_cvt_pk_bf16_f32 v80, v20, v21
    v_cvt_pk_bf16_f32 v81, v22, v23
    v_cvt_pk_bf16_f32 v82, v24, v25
    v_cvt_pk_bf16_f32 v83, v26, v27
    ds_write_b128 v7, v[80:83] offset:1024
    v_dot2_f32_bf16 v32, v80, s12, v32
    v_dot2_f32_bf16 v33, v80, v80, v33
    v_dot2_f32_bf16 v32, v81, s12, v32
    v_dot2_f32_bf16 v33, v81, v81, v33
    v_dot2_f32_bf16 v32, v82, s12, v32
    v_dot2_f32_bf16 v33, v82, v82, v33
    v_dot2_f32_bf16 v32, v83, s12, v32
    v_dot2_f32_bf16 v33, v83, v83, v33
    s_waitcnt vmcnt(29)
    v_dot2_f32_bf16 v20, v84, s13, v148
    v_dot2_f32_bf16 v21, v84, s14, v148
    v_dot2_f32_bf16 v22, v85, s13, v148
    v_dot2_f32_bf16 v23, v85, s14, v148
    v_dot2_f32_bf16 v24, v86, s13, v148
    v_dot2_f32_bf16 v25, v86, s14, v148
    v_dot2_f32_bf16 v26, v87, s13, v148
    v_dot2_f32_bf16 v27, v87, s14, v148
    v_and_b32 v12, 0xffff, v120
    v_and_b32 v13, s78, v120
    v_and_b32 v14, 0xffff, v121
    v_and_b32 v15, s78, v121
    v_and_b32 v16, 0xffff, v122
    v_and_b32 v17, s78, v122
    v_and_b32 v18, 0xffff, v123
    v_and_b32 v19, s78, v123
    s_add_u32 s11, s10, 8192
    buffer_load_dwordx4 a[32:35], v2, s[44:47], s11 offen offset:0
    v_cvt_pk_bf16_f32 v28, v20, v21
    v_lshlrev_b32 v20, 16, v28
    v_and_b32 v21, 0xffff0000, v28
    v_cvt_pk_bf16_f32 v29, v22, v23
    v_lshlrev_b32 v22, 16, v29
    v_and_b32 v23, 0xffff0000, v29
    v_cvt_pk_bf16_f32 v30, v24, v25
    v_lshlrev_b32 v24, 16, v30
    v_and_b32 v25, 0xffff0000, v30
    v_cvt_pk_bf16_f32 v31, v26, v27
    v_lshlrev_b32 v26, 16, v31
    v_and_b32 v27, 0xffff0000, v31
    v_mul_f32 v20, v20, v149
    v_mul_f32 v21, v21, v149
    v_mul_f32 v22, v22, v149
    v_mul_f32 v23, v23, v149
    buffer_load_dwordx4 a[36:39], v2, s[44:47], s11 offen offset:1024
    v_mul_f32 v24, v24, v149
    v_mul_f32 v25, v25, v149
    v_mul_f32 v26, v26, v149
    v_mul_f32 v27, v27, v149
    v_cvt_pk_bf16_f32 v28, v20, v21
    v_cvt_pk_bf16_f32 v29, v22, v23
    v_cvt_pk_bf16_f32 v30, v24, v25
    v_cvt_pk_bf16_f32 v31, v26, v27
    v_dot2_f32_bf16 v20, v28, v12, 0
    v_dot2_f32_bf16 v21, v28, v13, 0
    v_dot2_f32_bf16 v22, v29, v14, 0
    v_dot2_f32_bf16 v23, v29, v15, 0
    v_dot2_f32_bf16 v24, v30, v16, 0
    v_dot2_f32_bf16 v25, v30, v17, 0
    v_dot2_f32_bf16 v26, v31, v18, 0
    v_dot2_f32_bf16 v27, v31, v19, 0
    buffer_load_dwordx4 a[40:43], v2, s[44:47], s11 offen offset:2048
    v_lshlrev_b32 v12, 16, v84
    v_and_b32 v13, 0xffff0000, v84
    v_lshlrev_b32 v14, 16, v85
    v_and_b32 v15, 0xffff0000, v85
    v_lshlrev_b32 v16, 16, v86
    v_and_b32 v17, 0xffff0000, v86
    v_lshlrev_b32 v18, 16, v87
    v_and_b32 v19, 0xffff0000, v87
    v_cvt_pk_bf16_f32 v28, v20, v21
    v_cvt_pk_bf16_f32 v29, v22, v23
    v_cvt_pk_bf16_f32 v30, v24, v25
    v_cvt_pk_bf16_f32 v31, v26, v27
    v_dot2_f32_bf16 v20, v28, s13, v12
    v_dot2_f32_bf16 v21, v28, s14, v13
    v_dot2_f32_bf16 v22, v29, s13, v14
    v_dot2_f32_bf16 v23, v29, s14, v15
    buffer_load_dwordx4 a[44:47], v2, s[44:47], s11 offen offset:3072
    v_dot2_f32_bf16 v24, v30, s13, v16
    v_dot2_f32_bf16 v25, v30, s14, v17
    v_dot2_f32_bf16 v26, v31, s13, v18
    v_dot2_f32_bf16 v27, v31, s14, v19
    v_cvt_pk_bf16_f32 v84, v20, v21
    v_cvt_pk_bf16_f32 v85, v22, v23
    v_cvt_pk_bf16_f32 v86, v24, v25
    v_cvt_pk_bf16_f32 v87, v26, v27
    ds_write_b128 v7, v[84:87] offset:2048
    v_dot2_f32_bf16 v32, v84, s12, v32
    v_dot2_f32_bf16 v33, v84, v84, v33
    v_dot2_f32_bf16 v32, v85, s12, v32
    v_dot2_f32_bf16 v33, v85, v85, v33
    v_dot2_f32_bf16 v32, v86, s12, v32
    v_dot2_f32_bf16 v33, v86, v86, v33
    v_dot2_f32_bf16 v32, v87, s12, v32
    v_dot2_f32_bf16 v33, v87, v87, v33
    s_waitcnt vmcnt(30)
    v_dot2_f32_bf16 v20, v88, s13, v148
    v_dot2_f32_bf16 v21, v88, s14, v148
    v_dot2_f32_bf16 v22, v89, s13, v148
    v_dot2_f32_bf16 v23, v89, s14, v148
    v_dot2_f32_bf16 v24, v90, s13, v148
    v_dot2_f32_bf16 v25, v90, s14, v148
    v_dot2_f32_bf16 v26, v91, s13, v148
    v_dot2_f32_bf16 v27, v91, s14, v148
    v_and_b32 v12, 0xffff, v124
    v_and_b32 v13, s78, v124
    v_and_b32 v14, 0xffff, v125
    v_and_b32 v15, s78, v125
    v_and_b32 v16, 0xffff, v126
    v_and_b32 v17, s78, v126
    v_and_b32 v18, 0xffff, v127
    v_and_b32 v19, s78, v127
    s_add_u32 s11, s10, 12288
    buffer_load_dwordx4 a[48:51], v2, s[44:47], s11 offen offset:0
    v_cvt_pk_bf16_f32 v28, v20, v21
    v_lshlrev_b32 v20, 16, v28
    v_and_b32 v21, 0xffff0000, v28
    v_cvt_pk_bf16_f32 v29, v22, v23
    v_lshlrev_b32 v22, 16, v29
    v_and_b32 v23, 0xffff0000, v29
    v_cvt_pk_bf16_f32 v30, v24, v25
    v_lshlrev_b32 v24, 16, v30
    v_and_b32 v25, 0xffff0000, v30
    v_cvt_pk_bf16_f32 v31, v26, v27
    v_lshlrev_b32 v26, 16, v31
    v_and_b32 v27, 0xffff0000, v31
    v_mul_f32 v20, v20, v149
    v_mul_f32 v21, v21, v149
    v_mul_f32 v22, v22, v149
    v_mul_f32 v23, v23, v149
    buffer_load_dwordx4 a[52:55], v2, s[44:47], s11 offen offset:1024
    v_mul_f32 v24, v24, v149
    v_mul_f32 v25, v25, v149
    v_mul_f32 v26, v26, v149
    v_mul_f32 v27, v27, v149
    v_cvt_pk_bf16_f32 v28, v20, v21
    v_cvt_pk_bf16_f32 v29, v22, v23
    v_cvt_pk_bf16_f32 v30, v24, v25
    v_cvt_pk_bf16_f32 v31, v26, v27
    v_dot2_f32_bf16 v20, v28, v12, 0
    v_dot2_f32_bf16 v21, v28, v13, 0
    v_dot2_f32_bf16 v22, v29, v14, 0
    v_dot2_f32_bf16 v23, v29, v15, 0
    v_dot2_f32_bf16 v24, v30, v16, 0
    v_dot2_f32_bf16 v25, v30, v17, 0
    v_dot2_f32_bf16 v26, v31, v18, 0
    v_dot2_f32_bf16 v27, v31, v19, 0
    buffer_load_dwordx4 a[56:59], v2, s[44:47], s11 offen offset:2048
    v_lshlrev_b32 v12, 16, v88
    v_and_b32 v13, 0xffff0000, v88
    v_lshlrev_b32 v14, 16, v89
    v_and_b32 v15, 0xffff0000, v89
    v_lshlrev_b32 v16, 16, v90
    v_and_b32 v17, 0xffff0000, v90
    v_lshlrev_b32 v18, 16, v91
    v_and_b32 v19, 0xffff0000, v91
    v_cvt_pk_bf16_f32 v28, v20, v21
    v_cvt_pk_bf16_f32 v29, v22, v23
    v_cvt_pk_bf16_f32 v30, v24, v25
    v_cvt_pk_bf16_f32 v31, v26, v27
    v_dot2_f32_bf16 v20, v28, s13, v12
    v_dot2_f32_bf16 v21, v28, s14, v13
    v_dot2_f32_bf16 v22, v29, s13, v14
    v_dot2_f32_bf16 v23, v29, s14, v15
    buffer_load_dwordx4 a[60:63], v2, s[44:47], s11 offen offset:3072
    v_dot2_f32_bf16 v24, v30, s13, v16
    v_dot2_f32_bf16 v25, v30, s14, v17
    v_dot2_f32_bf16 v26, v31, s13, v18
    v_dot2_f32_bf16 v27, v31, s14, v19
    v_cvt_pk_bf16_f32 v88, v20, v21
    v_cvt_pk_bf16_f32 v89, v22, v23
    v_cvt_pk_bf16_f32 v90, v24, v25
    v_cvt_pk_bf16_f32 v91, v26, v27
    ds_write_b128 v7, v[88:91] offset:3072
    v_dot2_f32_bf16 v32, v88, s12, v32
    v_dot2_f32_bf16 v33, v88, v88, v33
    v_dot2_f32_bf16 v32, v89, s12, v32
    v_dot2_f32_bf16 v33, v89, v89, v33
    v_dot2_f32_bf16 v32, v90, s12, v32
    v_dot2_f32_bf16 v33, v90, v90, v33
    v_dot2_f32_bf16 v32, v91, s12, v32
    v_dot2_f32_bf16 v33, v91, v91, v33
    s_waitcnt vmcnt(31)
    v_dot2_f32_bf16 v20, v92, s13, v148
    v_dot2_f32_bf16 v21, v92, s14, v148
    v_dot2_f32_bf16 v22, v93, s13, v148
    v_dot2_f32_bf16 v23, v93, s14, v148
    v_dot2_f32_bf16 v24, v94, s13, v148
    v_dot2_f32_bf16 v25, v94, s14, v148
    v_dot2_f32_bf16 v26, v95, s13, v148
    v_dot2_f32_bf16 v27, v95, s14, v148
    v_and_b32 v12, 0xffff, v128
    v_and_b32 v13, s78, v128
    v_and_b32 v14, 0xffff, v129
    v_and_b32 v15, s78, v129
    v_and_b32 v16, 0xffff, v130
    v_and_b32 v17, s78, v130
    v_and_b32 v18, 0xffff, v131
    v_and_b32 v19, s78, v131
    s_add_u32 s11, s10, 16384
    buffer_load_dwordx4 a[64:67], v2, s[44:47], s11 offen offset:0
    v_cvt_pk_bf16_f32 v28, v20, v21
    v_lshlrev_b32 v20, 16, v28
    v_and_b32 v21, 0xffff0000, v28
    v_cvt_pk_bf16_f32 v29, v22, v23
    v_lshlrev_b32 v22, 16, v29
    v_and_b32 v23, 0xffff0000, v29
    v_cvt_pk_bf16_f32 v30, v24, v25
    v_lshlrev_b32 v24, 16, v30
    v_and_b32 v25, 0xffff0000, v30
    v_cvt_pk_bf16_f32 v31, v26, v27
    v_lshlrev_b32 v26, 16, v31
    v_and_b32 v27, 0xffff0000, v31
    v_mul_f32 v20, v20, v149
    v_mul_f32 v21, v21, v149
    v_mul_f32 v22, v22, v149
    v_mul_f32 v23, v23, v149
    buffer_load_dwordx4 a[68:71], v2, s[44:47], s11 offen offset:1024
    v_mul_f32 v24, v24, v149
    v_mul_f32 v25, v25, v149
    v_mul_f32 v26, v26, v149
    v_mul_f32 v27, v27, v149
    v_cvt_pk_bf16_f32 v28, v20, v21
    v_cvt_pk_bf16_f32 v29, v22, v23
    v_cvt_pk_bf16_f32 v30, v24, v25
    v_cvt_pk_bf16_f32 v31, v26, v27
    v_dot2_f32_bf16 v20, v28, v12, 0
    v_dot2_f32_bf16 v21, v28, v13, 0
    v_dot2_f32_bf16 v22, v29, v14, 0
    v_dot2_f32_bf16 v23, v29, v15, 0
    v_dot2_f32_bf16 v24, v30, v16, 0
    v_dot2_f32_bf16 v25, v30, v17, 0
    v_dot2_f32_bf16 v26, v31, v18, 0
    v_dot2_f32_bf16 v27, v31, v19, 0
    s_add_u32 s11, s10, 73728
    buffer_load_dwordx4 a[72:75], v2, s[44:47], s11 offen offset:0
    v_lshlrev_b32 v12, 16, v92
    v_and_b32 v13, 0xffff0000, v92
    v_lshlrev_b32 v14, 16, v93
    v_and_b32 v15, 0xffff0000, v93
    v_lshlrev_b32 v16, 16, v94
    v_and_b32 v17, 0xffff0000, v94
    v_lshlrev_b32 v18, 16, v95
    v_and_b32 v19, 0xffff0000, v95
    v_cvt_pk_bf16_f32 v28, v20, v21
    v_cvt_pk_bf16_f32 v29, v22, v23
    v_cvt_pk_bf16_f32 v30, v24, v25
    v_cvt_pk_bf16_f32 v31, v26, v27
    v_dot2_f32_bf16 v20, v28, s13, v12
    v_dot2_f32_bf16 v21, v28, s14, v13
    v_dot2_f32_bf16 v22, v29, s13, v14
    v_dot2_f32_bf16 v23, v29, s14, v15
    buffer_load_dwordx4 a[76:79], v2, s[44:47], s11 offen offset:1024
    v_dot2_f32_bf16 v24, v30, s13, v16
    v_dot2_f32_bf16 v25, v30, s14, v17
    v_dot2_f32_bf16 v26, v31, s13, v18
    v_dot2_f32_bf16 v27, v31, s14, v19
    v_cvt_pk_bf16_f32 v92, v20, v21
    v_cvt_pk_bf16_f32 v93, v22, v23
    v_cvt_pk_bf16_f32 v94, v24, v25
    v_cvt_pk_bf16_f32 v95, v26, v27
    ds_write_b128 v7, v[92:95] offset:4096
    v_dot2_f32_bf16 v32, v92, s12, v32
    v_dot2_f32_bf16 v33, v92, v92, v33
    v_dot2_f32_bf16 v32, v93, s12, v32
    v_dot2_f32_bf16 v33, v93, v93, v33
    v_dot2_f32_bf16 v32, v94, s12, v32
    v_dot2_f32_bf16 v33, v94, v94, v33
    v_dot2_f32_bf16 v32, v95, s12, v32
    v_dot2_f32_bf16 v33, v95, v95, v33
    s_waitcnt vmcnt(32)
    v_dot2_f32_bf16 v20, v96, s13, v148
    v_dot2_f32_bf16 v21, v96, s14, v148
    v_dot2_f32_bf16 v22, v97, s13, v148
    v_dot2_f32_bf16 v23, v97, s14, v148
    v_dot2_f32_bf16 v24, v98, s13, v148
    v_dot2_f32_bf16 v25, v98, s14, v148
    v_dot2_f32_bf16 v26, v99, s13, v148
    v_dot2_f32_bf16 v27, v99, s14, v148
    v_and_b32 v12, 0xffff, v132
    v_and_b32 v13, s78, v132
    v_and_b32 v14, 0xffff, v133
    v_and_b32 v15, s78, v133
    v_and_b32 v16, 0xffff, v134
    v_and_b32 v17, s78, v134
    v_and_b32 v18, 0xffff, v135
    v_and_b32 v19, s78, v135
    buffer_load_dwordx4 a[80:83], v2, s[44:47], s11 offen offset:2048
    v_cvt_pk_bf16_f32 v28, v20, v21
    v_lshlrev_b32 v20, 16, v28
    v_and_b32 v21, 0xffff0000, v28
    v_cvt_pk_bf16_f32 v29, v22, v23
    v_lshlrev_b32 v22, 16, v29
    v_and_b32 v23, 0xffff0000, v29
    v_cvt_pk_bf16_f32 v30, v24, v25
    v_lshlrev_b32 v24, 16, v30
    v_and_b32 v25, 0xffff0000, v30
    v_cvt_pk_bf16_f32 v31, v26, v27
    v_lshlrev_b32 v26, 16, v31
    v_and_b32 v27, 0xffff0000, v31
    v_mul_f32 v20, v20, v149
    v_mul_f32 v21, v21, v149
    v_mul_f32 v22, v22, v149
    v_mul_f32 v23, v23, v149
    buffer_load_dwordx4 a[84:87], v2, s[44:47], s11 offen offset:3072
    v_mul_f32 v24, v24, v149
    v_mul_f32 v25, v25, v149
    v_mul_f32 v26, v26, v149
    v_mul_f32 v27, v27, v149
    v_cvt_pk_bf16_f32 v28, v20, v21
    v_cvt_pk_bf16_f32 v29, v22, v23
    v_cvt_pk_bf16_f32 v30, v24, v25
    v_cvt_pk_bf16_f32 v31, v26, v27
    v_dot2_f32_bf16 v20, v28, v12, 0
    v_dot2_f32_bf16 v21, v28, v13, 0
    v_dot2_f32_bf16 v22, v29, v14, 0
    v_dot2_f32_bf16 v23, v29, v15, 0
    v_dot2_f32_bf16 v24, v30, v16, 0
    v_dot2_f32_bf16 v25, v30, v17, 0
    v_dot2_f32_bf16 v26, v31, v18, 0
    v_dot2_f32_bf16 v27, v31, v19, 0
    s_add_u32 s11, s10, 77824
    buffer_load_dwordx4 a[88:91], v2, s[44:47], s11 offen offset:0
    v_lshlrev_b32 v12, 16, v96
    v_and_b32 v13, 0xffff0000, v96
    v_lshlrev_b32 v14, 16, v97
    v_and_b32 v15, 0xffff0000, v97
    v_lshlrev_b32 v16, 16, v98
    v_and_b32 v17, 0xffff0000, v98
    v_lshlrev_b32 v18, 16, v99
    v_and_b32 v19, 0xffff0000, v99
    v_cvt_pk_bf16_f32 v28, v20, v21
    v_cvt_pk_bf16_f32 v29, v22, v23
    v_cvt_pk_bf16_f32 v30, v24, v25
    v_cvt_pk_bf16_f32 v31, v26, v27
    v_dot2_f32_bf16 v20, v28, s13, v12
    v_dot2_f32_bf16 v21, v28, s14, v13
    v_dot2_f32_bf16 v22, v29, s13, v14
    v_dot2_f32_bf16 v23, v29, s14, v15
    buffer_load_dwordx4 a[92:95], v2, s[44:47], s11 offen offset:1024
    v_dot2_f32_bf16 v24, v30, s13, v16
    v_dot2_f32_bf16 v25, v30, s14, v17
    v_dot2_f32_bf16 v26, v31, s13, v18
    v_dot2_f32_bf16 v27, v31, s14, v19
    v_cvt_pk_bf16_f32 v96, v20, v21
    v_cvt_pk_bf16_f32 v97, v22, v23
    v_cvt_pk_bf16_f32 v98, v24, v25
    v_cvt_pk_bf16_f32 v99, v26, v27
    ds_write_b128 v7, v[96:99] offset:5120
    v_dot2_f32_bf16 v32, v96, s12, v32
    v_dot2_f32_bf16 v33, v96, v96, v33
    v_dot2_f32_bf16 v32, v97, s12, v32
    v_dot2_f32_bf16 v33, v97, v97, v33
    v_dot2_f32_bf16 v32, v98, s12, v32
    v_dot2_f32_bf16 v33, v98, v98, v33
    v_dot2_f32_bf16 v32, v99, s12, v32
    v_dot2_f32_bf16 v33, v99, v99, v33
    s_waitcnt vmcnt(33)
    v_dot2_f32_bf16 v20, v100, s13, v148
    v_dot2_f32_bf16 v21, v100, s14, v148
    v_dot2_f32_bf16 v22, v101, s13, v148
    v_dot2_f32_bf16 v23, v101, s14, v148
    v_dot2_f32_bf16 v24, v102, s13, v148
    v_dot2_f32_bf16 v25, v102, s14, v148
    v_dot2_f32_bf16 v26, v103, s13, v148
    v_dot2_f32_bf16 v27, v103, s14, v148
    v_and_b32 v12, 0xffff, v136
    v_and_b32 v13, s78, v136
    v_and_b32 v14, 0xffff, v137
    v_and_b32 v15, s78, v137
    v_and_b32 v16, 0xffff, v138
    v_and_b32 v17, s78, v138
    v_and_b32 v18, 0xffff, v139
    v_and_b32 v19, s78, v139
    buffer_load_dwordx4 a[96:99], v2, s[44:47], s11 offen offset:2048
    v_cvt_pk_bf16_f32 v28, v20, v21
    v_lshlrev_b32 v20, 16, v28
    v_and_b32 v21, 0xffff0000, v28
    v_cvt_pk_bf16_f32 v29, v22, v23
    v_lshlrev_b32 v22, 16, v29
    v_and_b32 v23, 0xffff0000, v29
    v_cvt_pk_bf16_f32 v30, v24, v25
    v_lshlrev_b32 v24, 16, v30
    v_and_b32 v25, 0xffff0000, v30
    v_cvt_pk_bf16_f32 v31, v26, v27
    v_lshlrev_b32 v26, 16, v31
    v_and_b32 v27, 0xffff0000, v31
    v_mul_f32 v20, v20, v149
    v_mul_f32 v21, v21, v149
    v_mul_f32 v22, v22, v149
    v_mul_f32 v23, v23, v149
    buffer_load_dwordx4 a[100:103], v2, s[44:47], s11 offen offset:3072
    v_mul_f32 v24, v24, v149
    v_mul_f32 v25, v25, v149
    v_mul_f32 v26, v26, v149
    v_mul_f32 v27, v27, v149
    v_cvt_pk_bf16_f32 v28, v20, v21
    v_cvt_pk_bf16_f32 v29, v22, v23
    v_cvt_pk_bf16_f32 v30, v24, v25
    v_cvt_pk_bf16_f32 v31, v26, v27
    v_dot2_f32_bf16 v20, v28, v12, 0
    v_dot2_f32_bf16 v21, v28, v13, 0
    v_dot2_f32_bf16 v22, v29, v14, 0
    v_dot2_f32_bf16 v23, v29, v15, 0
    v_dot2_f32_bf16 v24, v30, v16, 0
    v_dot2_f32_bf16 v25, v30, v17, 0
    v_dot2_f32_bf16 v26, v31, v18, 0
    v_dot2_f32_bf16 v27, v31, v19, 0
    s_add_u32 s11, s10, 81920
    buffer_load_dwordx4 a[104:107], v2, s[44:47], s11 offen offset:0
    v_lshlrev_b32 v12, 16, v100
    v_and_b32 v13, 0xffff0000, v100
    v_lshlrev_b32 v14, 16, v101
    v_and_b32 v15, 0xffff0000, v101
    v_lshlrev_b32 v16, 16, v102
    v_and_b32 v17, 0xffff0000, v102
    v_lshlrev_b32 v18, 16, v103
    v_and_b32 v19, 0xffff0000, v103
    v_cvt_pk_bf16_f32 v28, v20, v21
    v_cvt_pk_bf16_f32 v29, v22, v23
    v_cvt_pk_bf16_f32 v30, v24, v25
    v_cvt_pk_bf16_f32 v31, v26, v27
    v_dot2_f32_bf16 v20, v28, s13, v12
    v_dot2_f32_bf16 v21, v28, s14, v13
    v_dot2_f32_bf16 v22, v29, s13, v14
    v_dot2_f32_bf16 v23, v29, s14, v15
    buffer_load_dwordx4 a[108:111], v2, s[44:47], s11 offen offset:1024
    v_dot2_f32_bf16 v24, v30, s13, v16
    v_dot2_f32_bf16 v25, v30, s14, v17
    v_dot2_f32_bf16 v26, v31, s13, v18
    v_dot2_f32_bf16 v27, v31, s14, v19
    v_cvt_pk_bf16_f32 v100, v20, v21
    v_cvt_pk_bf16_f32 v101, v22, v23
    v_cvt_pk_bf16_f32 v102, v24, v25
    v_cvt_pk_bf16_f32 v103, v26, v27
    ds_write_b128 v7, v[100:103] offset:6144
    v_dot2_f32_bf16 v32, v100, s12, v32
    v_dot2_f32_bf16 v33, v100, v100, v33
    v_dot2_f32_bf16 v32, v101, s12, v32
    v_dot2_f32_bf16 v33, v101, v101, v33
    v_dot2_f32_bf16 v32, v102, s12, v32
    v_dot2_f32_bf16 v33, v102, v102, v33
    v_dot2_f32_bf16 v32, v103, s12, v32
    v_dot2_f32_bf16 v33, v103, v103, v33
    s_waitcnt vmcnt(34)
    v_dot2_f32_bf16 v20, v104, s13, v148
    v_dot2_f32_bf16 v21, v104, s14, v148
    v_dot2_f32_bf16 v22, v105, s13, v148
    v_dot2_f32_bf16 v23, v105, s14, v148
    v_dot2_f32_bf16 v24, v106, s13, v148
    v_dot2_f32_bf16 v25, v106, s14, v148
    v_dot2_f32_bf16 v26, v107, s13, v148
    v_dot2_f32_bf16 v27, v107, s14, v148
    v_and_b32 v12, 0xffff, v140
    v_and_b32 v13, s78, v140
    v_and_b32 v14, 0xffff, v141
    v_and_b32 v15, s78, v141
    v_and_b32 v16, 0xffff, v142
    v_and_b32 v17, s78, v142
    v_and_b32 v18, 0xffff, v143
    v_and_b32 v19, s78, v143
    buffer_load_dwordx4 a[112:115], v2, s[44:47], s11 offen offset:2048
    v_cvt_pk_bf16_f32 v28, v20, v21
    v_lshlrev_b32 v20, 16, v28
    v_and_b32 v21, 0xffff0000, v28
    v_cvt_pk_bf16_f32 v29, v22, v23
    v_lshlrev_b32 v22, 16, v29
    v_and_b32 v23, 0xffff0000, v29
    v_cvt_pk_bf16_f32 v30, v24, v25
    v_lshlrev_b32 v24, 16, v30
    v_and_b32 v25, 0xffff0000, v30
    v_cvt_pk_bf16_f32 v31, v26, v27
    v_lshlrev_b32 v26, 16, v31
    v_and_b32 v27, 0xffff0000, v31
    v_mul_f32 v20, v20, v149
    v_mul_f32 v21, v21, v149
    v_mul_f32 v22, v22, v149
    v_mul_f32 v23, v23, v149
    buffer_load_dwordx4 a[116:119], v2, s[44:47], s11 offen offset:3072
    v_mul_f32 v24, v24, v149
    v_mul_f32 v25, v25, v149
    v_mul_f32 v26, v26, v149
    v_mul_f32 v27, v27, v149
    v_cvt_pk_bf16_f32 v28, v20, v21
    v_cvt_pk_bf16_f32 v29, v22, v23
    v_cvt_pk_bf16_f32 v30, v24, v25
    v_cvt_pk_bf16_f32 v31, v26, v27
    v_dot2_f32_bf16 v20, v28, v12, 0
    v_dot2_f32_bf16 v21, v28, v13, 0
    v_dot2_f32_bf16 v22, v29, v14, 0
    v_dot2_f32_bf16 v23, v29, v15, 0
    v_dot2_f32_bf16 v24, v30, v16, 0
    v_dot2_f32_bf16 v25, v30, v17, 0
    v_dot2_f32_bf16 v26, v31, v18, 0
    v_dot2_f32_bf16 v27, v31, v19, 0
    s_add_u32 s11, s10, 86016
    buffer_load_dwordx4 a[120:123], v2, s[44:47], s11 offen offset:0
    v_lshlrev_b32 v12, 16, v104
    v_and_b32 v13, 0xffff0000, v104
    v_lshlrev_b32 v14, 16, v105
    v_and_b32 v15, 0xffff0000, v105
    v_lshlrev_b32 v16, 16, v106
    v_and_b32 v17, 0xffff0000, v106
    v_lshlrev_b32 v18, 16, v107
    v_and_b32 v19, 0xffff0000, v107
    v_cvt_pk_bf16_f32 v28, v20, v21
    v_cvt_pk_bf16_f32 v29, v22, v23
    v_cvt_pk_bf16_f32 v30, v24, v25
    v_cvt_pk_bf16_f32 v31, v26, v27
    v_dot2_f32_bf16 v20, v28, s13, v12
    v_dot2_f32_bf16 v21, v28, s14, v13
    v_dot2_f32_bf16 v22, v29, s13, v14
    v_dot2_f32_bf16 v23, v29, s14, v15
    buffer_load_dwordx4 a[124:127], v2, s[44:47], s11 offen offset:1024
    v_dot2_f32_bf16 v24, v30, s13, v16
    v_dot2_f32_bf16 v25, v30, s14, v17
    v_dot2_f32_bf16 v26, v31, s13, v18
    v_dot2_f32_bf16 v27, v31, s14, v19
    v_cvt_pk_bf16_f32 v104, v20, v21
    v_cvt_pk_bf16_f32 v105, v22, v23
    v_cvt_pk_bf16_f32 v106, v24, v25
    v_cvt_pk_bf16_f32 v107, v26, v27
    ds_write_b128 v7, v[104:107] offset:7168
    v_dot2_f32_bf16 v32, v104, s12, v32
    v_dot2_f32_bf16 v33, v104, v104, v33
    v_dot2_f32_bf16 v32, v105, s12, v32
    v_dot2_f32_bf16 v33, v105, v105, v33
    v_dot2_f32_bf16 v32, v106, s12, v32
    v_dot2_f32_bf16 v33, v106, v106, v33
    v_dot2_f32_bf16 v32, v107, s12, v32
    v_dot2_f32_bf16 v33, v107, v107, v33
    s_waitcnt vmcnt(35)
    v_dot2_f32_bf16 v20, v108, s13, v148
    v_dot2_f32_bf16 v21, v108, s14, v148
    v_dot2_f32_bf16 v22, v109, s13, v148
    v_dot2_f32_bf16 v23, v109, s14, v148
    v_dot2_f32_bf16 v24, v110, s13, v148
    v_dot2_f32_bf16 v25, v110, s14, v148
    v_dot2_f32_bf16 v26, v111, s13, v148
    v_dot2_f32_bf16 v27, v111, s14, v148
    v_and_b32 v12, 0xffff, v144
    v_and_b32 v13, s78, v144
    v_and_b32 v14, 0xffff, v145
    v_and_b32 v15, s78, v145
    v_and_b32 v16, 0xffff, v146
    v_and_b32 v17, s78, v146
    v_and_b32 v18, 0xffff, v147
    v_and_b32 v19, s78, v147
    buffer_load_dwordx4 a[128:131], v2, s[44:47], s11 offen offset:2048
    v_cvt_pk_bf16_f32 v28, v20, v21
    v_lshlrev_b32 v20, 16, v28
    v_and_b32 v21, 0xffff0000, v28
    v_cvt_pk_bf16_f32 v29, v22, v23
    v_lshlrev_b32 v22, 16, v29
    v_and_b32 v23, 0xffff0000, v29
    v_cvt_pk_bf16_f32 v30, v24, v25
    v_lshlrev_b32 v24, 16, v30
    v_and_b32 v25, 0xffff0000, v30
    v_cvt_pk_bf16_f32 v31, v26, v27
    v_lshlrev_b32 v26, 16, v31
    v_and_b32 v27, 0xffff0000, v31
    v_mul_f32 v20, v20, v149
    v_mul_f32 v21, v21, v149
    v_mul_f32 v22, v22, v149
    v_mul_f32 v23, v23, v149
    buffer_load_dwordx4 a[132:135], v2, s[44:47], s11 offen offset:3072
    v_mul_f32 v24, v24, v149
    v_mul_f32 v25, v25, v149
    v_mul_f32 v26, v26, v149
    v_mul_f32 v27, v27, v149
    v_cvt_pk_bf16_f32 v28, v20, v21
    v_cvt_pk_bf16_f32 v29, v22, v23
    v_cvt_pk_bf16_f32 v30, v24, v25
    v_cvt_pk_bf16_f32 v31, v26, v27
    v_dot2_f32_bf16 v20, v28, v12, 0
    v_dot2_f32_bf16 v21, v28, v13, 0
    v_dot2_f32_bf16 v22, v29, v14, 0
    v_dot2_f32_bf16 v23, v29, v15, 0
    v_dot2_f32_bf16 v24, v30, v16, 0
    v_dot2_f32_bf16 v25, v30, v17, 0
    v_dot2_f32_bf16 v26, v31, v18, 0
    v_dot2_f32_bf16 v27, v31, v19, 0
    s_add_u32 s11, s10, 90112
    buffer_load_dwordx4 a[136:139], v2, s[44:47], s11 offen offset:0
    v_lshlrev_b32 v12, 16, v108
    v_and_b32 v13, 0xffff0000, v108
    v_lshlrev_b32 v14, 16, v109
    v_and_b32 v15, 0xffff0000, v109
    v_lshlrev_b32 v16, 16, v110
    v_and_b32 v17, 0xffff0000, v110
    v_lshlrev_b32 v18, 16, v111
    v_and_b32 v19, 0xffff0000, v111
    v_cvt_pk_bf16_f32 v28, v20, v21
    v_cvt_pk_bf16_f32 v29, v22, v23
    v_cvt_pk_bf16_f32 v30, v24, v25
    v_cvt_pk_bf16_f32 v31, v26, v27
    v_dot2_f32_bf16 v20, v28, s13, v12
    v_dot2_f32_bf16 v21, v28, s14, v13
    v_dot2_f32_bf16 v22, v29, s13, v14
    v_dot2_f32_bf16 v23, v29, s14, v15
    buffer_load_dwordx4 a[140:143], v2, s[44:47], s11 offen offset:1024
    v_dot2_f32_bf16 v24, v30, s13, v16
    v_dot2_f32_bf16 v25, v30, s14, v17
    v_dot2_f32_bf16 v26, v31, s13, v18
    v_dot2_f32_bf16 v27, v31, s14, v19
    v_cvt_pk_bf16_f32 v108, v20, v21
    v_cvt_pk_bf16_f32 v109, v22, v23
    v_cvt_pk_bf16_f32 v110, v24, v25
    v_cvt_pk_bf16_f32 v111, v26, v27
    ds_write_b128 v7, v[108:111] offset:8192
    v_dot2_f32_bf16 v32, v108, s12, v32
    v_dot2_f32_bf16 v33, v108, v108, v33
    v_dot2_f32_bf16 v32, v109, s12, v32
    v_dot2_f32_bf16 v33, v109, v109, v33
    v_dot2_f32_bf16 v32, v110, s12, v32
    v_dot2_f32_bf16 v33, v110, v110, v33
    v_dot2_f32_bf16 v32, v111, s12, v32
    v_dot2_f32_bf16 v33, v111, v111, v33
    s_cmp_lg_u32 s6, 0
    s_cbranch_scc1 L_kg_ker_s2_2
    s_add_u32 s11, s10, 147456
    buffer_load_dwordx4 a[144:147], v2, s[44:47], s11 offen offset:0
    buffer_load_dwordx4 a[148:151], v2, s[44:47], s11 offen offset:1024
    buffer_load_dwordx4 a[152:155], v2, s[44:47], s11 offen offset:2048
    buffer_load_dwordx4 a[156:159], v2, s[44:47], s11 offen offset:3072
    s_add_u32 s11, s10, 151552
    buffer_load_dwordx4 a[160:163], v2, s[44:47], s11 offen offset:0
    buffer_load_dwordx4 a[164:167], v2, s[44:47], s11 offen offset:1024
    buffer_load_dwordx4 a[168:171], v2, s[44:47], s11 offen offset:2048
    buffer_load_dwordx4 a[172:175], v2, s[44:47], s11 offen offset:3072
    s_add_u32 s11, s10, 155648
    buffer_load_dwordx4 a[176:179], v2, s[44:47], s11 offen offset:0
    buffer_load_dwordx4 a[180:183], v2, s[44:47], s11 offen offset:1024
    buffer_load_dwordx4 a[184:187], v2, s[44:47], s11 offen offset:2048
    buffer_load_dwordx4 a[188:191], v2, s[44:47], s11 offen offset:3072
    s_add_u32 s11, s10, 159744
    buffer_load_dwordx4 a[192:195], v2, s[44:47], s11 offen offset:0
    buffer_load_dwordx4 a[196:199], v2, s[44:47], s11 offen offset:1024
    buffer_load_dwordx4 a[200:203], v2, s[44:47], s11 offen offset:2048
    buffer_load_dwordx4 a[204:207], v2, s[44:47], s11 offen offset:3072
    s_add_u32 s11, s10, 163840
    buffer_load_dwordx4 a[208:211], v2, s[44:47], s11 offen offset:0
    buffer_load_dwordx4 a[212:215], v2, s[44:47], s11 offen offset:1024
L_kg_ker_s2_2:
    s_add_u32 s7, s79, 0
    s_and_b32 s7, s7, 3
    s_cmp_lg_u32 s7, s69
    s_cbranch_scc1 L_kg_ker_hs_3
    buffer_store_dwordx4 v[76:79], v8, s[60:63], 0 offen offset:0 sc1
L_kg_ker_hs_3:
    s_add_u32 s7, s79, 1
    s_and_b32 s7, s7, 3
    s_cmp_lg_u32 s7, s69
    s_cbranch_scc1 L_kg_ker_hs_4
    buffer_store_dwordx4 v[80:83], v8, s[60:63], 0 offen offset:64 sc1
L_kg_ker_hs_4:
    s_add_u32 s7, s79, 2
    s_and_b32 s7, s7, 3
    s_cmp_lg_u32 s7, s69
    s_cbranch_scc1 L_kg_ker_hs_5
    buffer_store_dwordx4 v[84:87], v8, s[60:63], 0 offen offset:128 sc1
L_kg_ker_hs_5:
    s_add_u32 s7, s79, 3
    s_and_b32 s7, s7, 3
    s_cmp_lg_u32 s7, s69
    s_cbranch_scc1 L_kg_ker_hs_6
    buffer_store_dwordx4 v[88:91], v8, s[60:63], 0 offen offset:192 sc1
L_kg_ker_hs_6:
    s_add_u32 s7, s79, 4
    s_and_b32 s7, s7, 3
    s_cmp_lg_u32 s7, s69
    s_cbranch_scc1 L_kg_ker_hs_7
    buffer_store_dwordx4 v[92:95], v8, s[60:63], 0 offen offset:256 sc1
L_kg_ker_hs_7:
    s_add_u32 s7, s79, 5
    s_and_b32 s7, s7, 3
    s_cmp_lg_u32 s7, s69
    s_cbranch_scc1 L_kg_ker_hs_8
    buffer_store_dwordx4 v[96:99], v8, s[60:63], 0 offen offset:320 sc1
L_kg_ker_hs_8:
    s_add_u32 s7, s79, 6
    s_and_b32 s7, s7, 3
    s_cmp_lg_u32 s7, s69
    s_cbranch_scc1 L_kg_ker_hs_9
    buffer_store_dwordx4 v[100:103], v8, s[60:63], 0 offen offset:384 sc1
L_kg_ker_hs_9:
    s_add_u32 s7, s79, 7
    s_and_b32 s7, s7, 3
    s_cmp_lg_u32 s7, s69
    s_cbranch_scc1 L_kg_ker_hs_10
    buffer_store_dwordx4 v[104:107], v8, s[60:63], 0 offen offset:448 sc1
L_kg_ker_hs_10:
    s_add_u32 s7, s79, 8
    s_and_b32 s7, s7, 3
    s_cmp_lg_u32 s7, s69
    s_cbranch_scc1 L_kg_ker_hs_11
    buffer_store_dwordx4 v[108:111], v8, s[60:63], 0 offen offset:512 sc1
L_kg_ker_hs_11:
    s_nop 3
    v_mov_b32 v28, v32
    s_nop 1
    v_permlane16_swap_b32 v32, v28
    v_add_f32 v32, v32, v28
    v_mov_b32 v28, v32
    s_nop 1
    v_permlane32_swap_b32 v32, v28
    v_add_f32 v32, v32, v28
    v_mov_b32 v29, v33
    s_nop 1
    v_permlane16_swap_b32 v33, v29
    v_add_f32 v33, v33, v29
    v_mov_b32 v29, v33
    s_nop 1
    v_permlane32_swap_b32 v33, v29
    v_add_f32 v33, v33, v29
    v_lshlrev_b32 v9, 3, v3
    v_add_u32 v9, 73728, v9
    s_lshl_b32 s7, s6, 7
    v_add_u32 v10, s7, v9
    s_mov_b64 exec, 0xffff
    ds_write_b64 v10, v[32:33]
    s_mov_b64 exec, -1
    s_waitcnt lgkmcnt(0)
    s_barrier
    ds_read_b64 v[12:13], v9 offset:0
    ds_read_b64 v[14:15], v9 offset:128
    ds_read_b64 v[16:17], v9 offset:256
    ds_read_b64 v[18:19], v9 offset:384
    s_waitcnt lgkmcnt(0)
    v_add_f32 v12, v12, v16
    v_add_f32 v13, v13, v17
    v_add_f32 v14, v14, v18
    v_add_f32 v15, v15, v19
    v_mul_f32 v172, 0x3ae38e39, v12
    v_mul_f32 v173, 0x3ae38e39, v13
    v_fma_f32 v173, -v172, v172, v173
    v_mov_b32 v168, v172
    v_cvt_pk_bf16_f32 v174, v168, v168
    v_lshlrev_b32 v168, 16, v174
    v_max_f32 v169, 0, v173
    v_cvt_pk_bf16_f32 v174, v169, v169
    v_lshlrev_b32 v169, 16, v174
    v_add_f32 v169, 0x3727c5ac, v169
    v_cvt_pk_bf16_f32 v174, v169, v169
    v_lshlrev_b32 v169, 16, v174
    v_sqrt_f32 v169, v169
    s_nop 0
    v_cvt_pk_bf16_f32 v174, v169, v169
    v_lshlrev_b32 v169, 16, v174
    v_rcp_f32 v169, v169
    v_sub_f32 v172, v172, v168
    v_mul_f32 v172, v172, v169
    v_mul_f32 v173, v173, v169
    v_mul_f32 v173, v173, v169
    v_mov_b32 v175, v172
    v_cvt_pk_bf16_f32 v174, v175, v175
    v_lshlrev_b32 v175, 16, v174
    v_max_f32 v176, 0, v173
    v_cvt_pk_bf16_f32 v174, v176, v176
    v_lshlrev_b32 v176, 16, v174
    v_add_f32 v176, 0x3727c5ac, v176
    v_cvt_pk_bf16_f32 v174, v176, v176
    v_lshlrev_b32 v176, 16, v174
    v_sqrt_f32 v176, v176
    s_nop 0
    v_cvt_pk_bf16_f32 v174, v176, v176
    v_lshlrev_b32 v176, 16, v174
    v_rcp_f32 v176, v176
    s_nop 0
    v_mul_f32 v164, v169, v176
    v_mul_f32 v165, v175, v176
    v_fmac_f32 v165, v168, v164
    v_mul_f32 v172, 0x3ae38e39, v14
    v_mul_f32 v173, 0x3ae38e39, v15
    v_fma_f32 v173, -v172, v172, v173
    v_mov_b32 v170, v172
    v_cvt_pk_bf16_f32 v174, v170, v170
    v_lshlrev_b32 v170, 16, v174
    v_max_f32 v171, 0, v173
    v_cvt_pk_bf16_f32 v174, v171, v171
    v_lshlrev_b32 v171, 16, v174
    v_add_f32 v171, 0x3727c5ac, v171
    v_cvt_pk_bf16_f32 v174, v171, v171
    v_lshlrev_b32 v171, 16, v174
    v_sqrt_f32 v171, v171
    s_nop 0
    v_cvt_pk_bf16_f32 v174, v171, v171
    v_lshlrev_b32 v171, 16, v174
    v_rcp_f32 v171, v171
    v_sub_f32 v172, v172, v170
    v_mul_f32 v172, v172, v171
    v_mul_f32 v173, v173, v171
    v_mul_f32 v173, v173, v171
    v_mov_b32 v175, v172
    v_cvt_pk_bf16_f32 v174, v175, v175
    v_lshlrev_b32 v175, 16, v174
    v_max_f32 v176, 0, v173
    v_cvt_pk_bf16_f32 v174, v176, v176
    v_lshlrev_b32 v176, 16, v174
    v_add_f32 v176, 0x3727c5ac, v176
    v_cvt_pk_bf16_f32 v174, v176, v176
    v_lshlrev_b32 v176, 16, v174
    v_sqrt_f32 v176, v176
    s_nop 0
    v_cvt_pk_bf16_f32 v174, v176, v176
    v_lshlrev_b32 v176, 16, v174
    v_rcp_f32 v176, v176
    s_nop 0
    v_mul_f32 v166, v171, v176
    v_mul_f32 v167, v175, v176
    v_fmac_f32 v167, v170, v166
    v_add_u32 v11, 36864, v2
    s_waitcnt vmcnt(0)
    s_cmp_eq_u32 s6, 0
    s_cbranch_scc1 L_kg_ker_g0_12
    ds_read_b128 v[44:47], v2 offset:0
    ds_read_b128 v[48:51], v2 offset:18432
    ds_read_b128 v[52:55], v2 offset:1024
    ds_read_b128 v[56:59], v2 offset:19456
    ds_read_b128 v[60:63], v2 offset:2048
    ds_read_b128 v[64:67], v2 offset:20480
    ds_read_b128 v[68:71], v2 offset:3072
    s_waitcnt lgkmcnt(6)
    v_mfma_f32_16x16x32_bf16 v[180:183], a[0:3], v[44:47], 0
    v_mfma_f32_16x16x32_bf16 v[188:191], a[72:75], v[44:47], 0
    ds_read_b128 v[72:75], v2 offset:21504
    s_waitcnt lgkmcnt(6)
    v_mfma_f32_16x16x32_bf16 v[184:187], a[0:3], v[48:51], 0
    v_mfma_f32_16x16x32_bf16 v[192:195], a[72:75], v[48:51], 0
    ds_read_b128 v[44:47], v2 offset:4096
    s_waitcnt lgkmcnt(6)
    v_mfma_f32_16x16x32_bf16 v[180:183], a[4:7], v[52:55], v[180:183]
    v_mfma_f32_16x16x32_bf16 v[188:191], a[76:79], v[52:55], v[188:191]
    ds_read_b128 v[48:51], v2 offset:22528
    s_waitcnt lgkmcnt(6)
    v_mfma_f32_16x16x32_bf16 v[184:187], a[4:7], v[56:59], v[184:187]
    v_mfma_f32_16x16x32_bf16 v[192:195], a[76:79], v[56:59], v[192:195]
    ds_read_b128 v[52:55], v2 offset:5120
    s_waitcnt lgkmcnt(6)
    v_mfma_f32_16x16x32_bf16 v[180:183], a[8:11], v[60:63], v[180:183]
    v_mfma_f32_16x16x32_bf16 v[188:191], a[80:83], v[60:63], v[188:191]
    ds_read_b128 v[56:59], v2 offset:23552
    s_waitcnt lgkmcnt(6)
    v_mfma_f32_16x16x32_bf16 v[184:187], a[8:11], v[64:67], v[184:187]
    v_mfma_f32_16x16x32_bf16 v[192:195], a[80:83], v[64:67], v[192:195]
    ds_read_b128 v[60:63], v2 offset:6144
    s_waitcnt lgkmcnt(6)
    v_mfma_f32_16x16x32_bf16 v[180:183], a[12:15], v[68:71], v[180:183]
    v_mfma_f32_16x16x32_bf16 v[188:191], a[84:87], v[68:71], v[188:191]
    ds_read_b128 v[64:67], v2 offset:24576
    s_waitcnt lgkmcnt(6)
    v_mfma_f32_16x16x32_bf16 v[184:187], a[12:15], v[72:75], v[184:187]
    v_mfma_f32_16x16x32_bf16 v[192:195], a[84:87], v[72:75], v[192:195]
    ds_read_b128 v[68:71], v2 offset:7168
    s_waitcnt lgkmcnt(6)
    v_mfma_f32_16x16x32_bf16 v[180:183], a[16:19], v[44:47], v[180:183]
    v_mfma_f32_16x16x32_bf16 v[188:191], a[88:91], v[44:47], v[188:191]
    ds_read_b128 v[72:75], v2 offset:25600
    s_waitcnt lgkmcnt(6)
    v_mfma_f32_16x16x32_bf16 v[184:187], a[16:19], v[48:51], v[184:187]
    v_mfma_f32_16x16x32_bf16 v[192:195], a[88:91], v[48:51], v[192:195]
    ds_read_b128 v[44:47], v2 offset:8192
    s_waitcnt lgkmcnt(6)
    v_mfma_f32_16x16x32_bf16 v[180:183], a[20:23], v[52:55], v[180:183]
    v_mfma_f32_16x16x32_bf16 v[188:191], a[92:95], v[52:55], v[188:191]
    ds_read_b128 v[48:51], v2 offset:26624
    s_waitcnt lgkmcnt(6)
    v_mfma_f32_16x16x32_bf16 v[184:187], a[20:23], v[56:59], v[184:187]
    v_mfma_f32_16x16x32_bf16 v[192:195], a[92:95], v[56:59], v[192:195]
    ds_read_b128 v[52:55], v2 offset:9216
    s_waitcnt lgkmcnt(6)
    v_mfma_f32_16x16x32_bf16 v[180:183], a[24:27], v[60:63], v[180:183]
    v_mfma_f32_16x16x32_bf16 v[188:191], a[96:99], v[60:63], v[188:191]
    ds_read_b128 v[56:59], v2 offset:27648
    s_waitcnt lgkmcnt(6)
    v_mfma_f32_16x16x32_bf16 v[184:187], a[24:27], v[64:67], v[184:187]
    v_mfma_f32_16x16x32_bf16 v[192:195], a[96:99], v[64:67], v[192:195]
    ds_read_b128 v[60:63], v2 offset:10240
    s_waitcnt lgkmcnt(6)
    v_mfma_f32_16x16x32_bf16 v[180:183], a[28:31], v[68:71], v[180:183]
    v_mfma_f32_16x16x32_bf16 v[188:191], a[100:103], v[68:71], v[188:191]
    ds_read_b128 v[64:67], v2 offset:28672
    s_waitcnt lgkmcnt(6)
    v_mfma_f32_16x16x32_bf16 v[184:187], a[28:31], v[72:75], v[184:187]
    v_mfma_f32_16x16x32_bf16 v[192:195], a[100:103], v[72:75], v[192:195]
    ds_read_b128 v[68:71], v2 offset:11264
    s_waitcnt lgkmcnt(6)
    v_mfma_f32_16x16x32_bf16 v[180:183], a[32:35], v[44:47], v[180:183]
    v_mfma_f32_16x16x32_bf16 v[188:191], a[104:107], v[44:47], v[188:191]
    ds_read_b128 v[72:75], v2 offset:29696
    s_waitcnt lgkmcnt(6)
    v_mfma_f32_16x16x32_bf16 v[184:187], a[32:35], v[48:51], v[184:187]
    v_mfma_f32_16x16x32_bf16 v[192:195], a[104:107], v[48:51], v[192:195]
    ds_read_b128 v[44:47], v2 offset:12288
    s_waitcnt lgkmcnt(6)
    v_mfma_f32_16x16x32_bf16 v[180:183], a[36:39], v[52:55], v[180:183]
    v_mfma_f32_16x16x32_bf16 v[188:191], a[108:111], v[52:55], v[188:191]
    ds_read_b128 v[48:51], v2 offset:30720
    s_waitcnt lgkmcnt(6)
    v_mfma_f32_16x16x32_bf16 v[184:187], a[36:39], v[56:59], v[184:187]
    v_mfma_f32_16x16x32_bf16 v[192:195], a[108:111], v[56:59], v[192:195]
    ds_read_b128 v[52:55], v2 offset:13312
    s_waitcnt lgkmcnt(6)
    v_mfma_f32_16x16x32_bf16 v[180:183], a[40:43], v[60:63], v[180:183]
    v_mfma_f32_16x16x32_bf16 v[188:191], a[112:115], v[60:63], v[188:191]
    ds_read_b128 v[56:59], v2 offset:31744
    s_waitcnt lgkmcnt(6)
    v_mfma_f32_16x16x32_bf16 v[184:187], a[40:43], v[64:67], v[184:187]
    v_mfma_f32_16x16x32_bf16 v[192:195], a[112:115], v[64:67], v[192:195]
    ds_read_b128 v[60:63], v2 offset:14336
    s_waitcnt lgkmcnt(6)
    v_mfma_f32_16x16x32_bf16 v[180:183], a[44:47], v[68:71], v[180:183]
    v_mfma_f32_16x16x32_bf16 v[188:191], a[116:119], v[68:71], v[188:191]
    ds_read_b128 v[64:67], v2 offset:32768
    s_waitcnt lgkmcnt(6)
    v_mfma_f32_16x16x32_bf16 v[184:187], a[44:47], v[72:75], v[184:187]
    v_mfma_f32_16x16x32_bf16 v[192:195], a[116:119], v[72:75], v[192:195]
    ds_read_b128 v[68:71], v2 offset:15360
    s_waitcnt lgkmcnt(6)
    v_mfma_f32_16x16x32_bf16 v[180:183], a[48:51], v[44:47], v[180:183]
    v_mfma_f32_16x16x32_bf16 v[188:191], a[120:123], v[44:47], v[188:191]
    ds_read_b128 v[72:75], v2 offset:33792
    s_waitcnt lgkmcnt(6)
    v_mfma_f32_16x16x32_bf16 v[184:187], a[48:51], v[48:51], v[184:187]
    v_mfma_f32_16x16x32_bf16 v[192:195], a[120:123], v[48:51], v[192:195]
    ds_read_b128 v[44:47], v2 offset:16384
    s_waitcnt lgkmcnt(6)
    v_mfma_f32_16x16x32_bf16 v[180:183], a[52:55], v[52:55], v[180:183]
    v_mfma_f32_16x16x32_bf16 v[188:191], a[124:127], v[52:55], v[188:191]
    ds_read_b128 v[48:51], v2 offset:34816
    s_waitcnt lgkmcnt(6)
    v_mfma_f32_16x16x32_bf16 v[184:187], a[52:55], v[56:59], v[184:187]
    v_mfma_f32_16x16x32_bf16 v[192:195], a[124:127], v[56:59], v[192:195]
    ds_read_b128 v[52:55], v2 offset:17408
    s_waitcnt lgkmcnt(6)
    v_mfma_f32_16x16x32_bf16 v[180:183], a[56:59], v[60:63], v[180:183]
    v_mfma_f32_16x16x32_bf16 v[188:191], a[128:131], v[60:63], v[188:191]
    ds_read_b128 v[56:59], v2 offset:35840
    s_waitcnt lgkmcnt(6)
    v_mfma_f32_16x16x32_bf16 v[184:187], a[56:59], v[64:67], v[184:187]
    v_mfma_f32_16x16x32_bf16 v[192:195], a[128:131], v[64:67], v[192:195]
    s_waitcnt lgkmcnt(5)
    v_mfma_f32_16x16x32_bf16 v[180:183], a[60:63], v[68:71], v[180:183]
    v_mfma_f32_16x16x32_bf16 v[188:191], a[132:135], v[68:71], v[188:191]
    s_waitcnt lgkmcnt(4)
    v_mfma_f32_16x16x32_bf16 v[184:187], a[60:63], v[72:75], v[184:187]
    v_mfma_f32_16x16x32_bf16 v[192:195], a[132:135], v[72:75], v[192:195]
    s_waitcnt lgkmcnt(3)
    v_mfma_f32_16x16x32_bf16 v[180:183], a[64:67], v[44:47], v[180:183]
    v_mfma_f32_16x16x32_bf16 v[188:191], a[136:139], v[44:47], v[188:191]
    s_waitcnt lgkmcnt(2)
    v_mfma_f32_16x16x32_bf16 v[184:187], a[64:67], v[48:51], v[184:187]
    v_mfma_f32_16x16x32_bf16 v[192:195], a[136:139], v[48:51], v[192:195]
    s_waitcnt lgkmcnt(1)
    v_mfma_f32_16x16x32_bf16 v[180:183], a[68:71], v[52:55], v[180:183]
    v_mfma_f32_16x16x32_bf16 v[188:191], a[140:143], v[52:55], v[188:191]
    s_waitcnt lgkmcnt(0)
    v_mfma_f32_16x16x32_bf16 v[184:187], a[68:71], v[56:59], v[184:187]
    v_mfma_f32_16x16x32_bf16 v[192:195], a[140:143], v[56:59], v[192:195]
    s_nop 7
    s_branch L_kg_ker_ge_13
L_kg_ker_g0_12:
    ds_read_b128 v[44:47], v2 offset:0
    ds_read_b128 v[48:51], v2 offset:18432
    ds_read_b128 v[52:55], v2 offset:1024
    ds_read_b128 v[56:59], v2 offset:19456
    ds_read_b128 v[60:63], v2 offset:2048
    ds_read_b128 v[64:67], v2 offset:20480
    ds_read_b128 v[68:71], v2 offset:3072
    s_waitcnt lgkmcnt(6)
    v_mfma_f32_16x16x32_bf16 v[180:183], a[0:3], v[44:47], 0
    v_mfma_f32_16x16x32_bf16 v[188:191], a[72:75], v[44:47], 0
    v_mfma_f32_16x16x32_bf16 v[196:199], a[144:147], v[44:47], 0
    ds_read_b128 v[72:75], v2 offset:21504
    s_waitcnt lgkmcnt(6)
    v_mfma_f32_16x16x32_bf16 v[184:187], a[0:3], v[48:51], 0
    v_mfma_f32_16x16x32_bf16 v[192:195], a[72:75], v[48:51], 0
    v_mfma_f32_16x16x32_bf16 v[200:203], a[144:147], v[48:51], 0
    ds_read_b128 v[44:47], v2 offset:4096
    s_waitcnt lgkmcnt(6)
    v_mfma_f32_16x16x32_bf16 v[180:183], a[4:7], v[52:55], v[180:183]
    v_mfma_f32_16x16x32_bf16 v[188:191], a[76:79], v[52:55], v[188:191]
    v_mfma_f32_16x16x32_bf16 v[196:199], a[148:151], v[52:55], v[196:199]
    ds_read_b128 v[48:51], v2 offset:22528
    s_waitcnt lgkmcnt(6)
    v_mfma_f32_16x16x32_bf16 v[184:187], a[4:7], v[56:59], v[184:187]
    v_mfma_f32_16x16x32_bf16 v[192:195], a[76:79], v[56:59], v[192:195]
    v_mfma_f32_16x16x32_bf16 v[200:203], a[148:151], v[56:59], v[200:203]
    ds_read_b128 v[52:55], v2 offset:5120
    s_waitcnt lgkmcnt(6)
    v_mfma_f32_16x16x32_bf16 v[180:183], a[8:11], v[60:63], v[180:183]
    v_mfma_f32_16x16x32_bf16 v[188:191], a[80:83], v[60:63], v[188:191]
    v_mfma_f32_16x16x32_bf16 v[196:199], a[152:155], v[60:63], v[196:199]
    ds_read_b128 v[56:59], v2 offset:23552
    s_waitcnt lgkmcnt(6)
    v_mfma_f32_16x16x32_bf16 v[184:187], a[8:11], v[64:67], v[184:187]
    v_mfma_f32_16x16x32_bf16 v[192:195], a[80:83], v[64:67], v[192:195]
    v_mfma_f32_16x16x32_bf16 v[200:203], a[152:155], v[64:67], v[200:203]
    ds_read_b128 v[60:63], v2 offset:6144
    s_waitcnt lgkmcnt(6)
    v_mfma_f32_16x16x32_bf16 v[180:183], a[12:15], v[68:71], v[180:183]
    v_mfma_f32_16x16x32_bf16 v[188:191], a[84:87], v[68:71], v[188:191]
    v_mfma_f32_16x16x32_bf16 v[196:199], a[156:159], v[68:71], v[196:199]
    ds_read_b128 v[64:67], v2 offset:24576
    s_waitcnt lgkmcnt(6)
    v_mfma_f32_16x16x32_bf16 v[184:187], a[12:15], v[72:75], v[184:187]
    v_mfma_f32_16x16x32_bf16 v[192:195], a[84:87], v[72:75], v[192:195]
    v_mfma_f32_16x16x32_bf16 v[200:203], a[156:159], v[72:75], v[200:203]
    ds_read_b128 v[68:71], v2 offset:7168
    s_waitcnt lgkmcnt(6)
    v_mfma_f32_16x16x32_bf16 v[180:183], a[16:19], v[44:47], v[180:183]
    v_mfma_f32_16x16x32_bf16 v[188:191], a[88:91], v[44:47], v[188:191]
    v_mfma_f32_16x16x32_bf16 v[196:199], a[160:163], v[44:47], v[196:199]
    ds_read_b128 v[72:75], v2 offset:25600
    s_waitcnt lgkmcnt(6)
    v_mfma_f32_16x16x32_bf16 v[184:187], a[16:19], v[48:51], v[184:187]
    v_mfma_f32_16x16x32_bf16 v[192:195], a[88:91], v[48:51], v[192:195]
    v_mfma_f32_16x16x32_bf16 v[200:203], a[160:163], v[48:51], v[200:203]
    ds_read_b128 v[44:47], v2 offset:8192
    s_waitcnt lgkmcnt(6)
    v_mfma_f32_16x16x32_bf16 v[180:183], a[20:23], v[52:55], v[180:183]
    v_mfma_f32_16x16x32_bf16 v[188:191], a[92:95], v[52:55], v[188:191]
    v_mfma_f32_16x16x32_bf16 v[196:199], a[164:167], v[52:55], v[196:199]
    ds_read_b128 v[48:51], v2 offset:26624
    s_waitcnt lgkmcnt(6)
    v_mfma_f32_16x16x32_bf16 v[184:187], a[20:23], v[56:59], v[184:187]
    v_mfma_f32_16x16x32_bf16 v[192:195], a[92:95], v[56:59], v[192:195]
    v_mfma_f32_16x16x32_bf16 v[200:203], a[164:167], v[56:59], v[200:203]
    ds_read_b128 v[52:55], v2 offset:9216
    s_waitcnt lgkmcnt(6)
    v_mfma_f32_16x16x32_bf16 v[180:183], a[24:27], v[60:63], v[180:183]
    v_mfma_f32_16x16x32_bf16 v[188:191], a[96:99], v[60:63], v[188:191]
    v_mfma_f32_16x16x32_bf16 v[196:199], a[168:171], v[60:63], v[196:199]
    ds_read_b128 v[56:59], v2 offset:27648
    s_waitcnt lgkmcnt(6)
    v_mfma_f32_16x16x32_bf16 v[184:187], a[24:27], v[64:67], v[184:187]
    v_mfma_f32_16x16x32_bf16 v[192:195], a[96:99], v[64:67], v[192:195]
    v_mfma_f32_16x16x32_bf16 v[200:203], a[168:171], v[64:67], v[200:203]
    ds_read_b128 v[60:63], v2 offset:10240
    s_waitcnt lgkmcnt(6)
    v_mfma_f32_16x16x32_bf16 v[180:183], a[28:31], v[68:71], v[180:183]
    v_mfma_f32_16x16x32_bf16 v[188:191], a[100:103], v[68:71], v[188:191]
    v_mfma_f32_16x16x32_bf16 v[196:199], a[172:175], v[68:71], v[196:199]
    ds_read_b128 v[64:67], v2 offset:28672
    s_waitcnt lgkmcnt(6)
    v_mfma_f32_16x16x32_bf16 v[184:187], a[28:31], v[72:75], v[184:187]
    v_mfma_f32_16x16x32_bf16 v[192:195], a[100:103], v[72:75], v[192:195]
    v_mfma_f32_16x16x32_bf16 v[200:203], a[172:175], v[72:75], v[200:203]
    ds_read_b128 v[68:71], v2 offset:11264
    s_waitcnt lgkmcnt(6)
    v_mfma_f32_16x16x32_bf16 v[180:183], a[32:35], v[44:47], v[180:183]
    v_mfma_f32_16x16x32_bf16 v[188:191], a[104:107], v[44:47], v[188:191]
    v_mfma_f32_16x16x32_bf16 v[196:199], a[176:179], v[44:47], v[196:199]
    ds_read_b128 v[72:75], v2 offset:29696
    s_waitcnt lgkmcnt(6)
    v_mfma_f32_16x16x32_bf16 v[184:187], a[32:35], v[48:51], v[184:187]
    v_mfma_f32_16x16x32_bf16 v[192:195], a[104:107], v[48:51], v[192:195]
    v_mfma_f32_16x16x32_bf16 v[200:203], a[176:179], v[48:51], v[200:203]
    ds_read_b128 v[44:47], v2 offset:12288
    s_waitcnt lgkmcnt(6)
    v_mfma_f32_16x16x32_bf16 v[180:183], a[36:39], v[52:55], v[180:183]
    v_mfma_f32_16x16x32_bf16 v[188:191], a[108:111], v[52:55], v[188:191]
    v_mfma_f32_16x16x32_bf16 v[196:199], a[180:183], v[52:55], v[196:199]
    ds_read_b128 v[48:51], v2 offset:30720
    s_waitcnt lgkmcnt(6)
    v_mfma_f32_16x16x32_bf16 v[184:187], a[36:39], v[56:59], v[184:187]
    v_mfma_f32_16x16x32_bf16 v[192:195], a[108:111], v[56:59], v[192:195]
    v_mfma_f32_16x16x32_bf16 v[200:203], a[180:183], v[56:59], v[200:203]
    ds_read_b128 v[52:55], v2 offset:13312
    s_waitcnt lgkmcnt(6)
    v_mfma_f32_16x16x32_bf16 v[180:183], a[40:43], v[60:63], v[180:183]
    v_mfma_f32_16x16x32_bf16 v[188:191], a[112:115], v[60:63], v[188:191]
    v_mfma_f32_16x16x32_bf16 v[196:199], a[184:187], v[60:63], v[196:199]
    ds_read_b128 v[56:59], v2 offset:31744
    s_waitcnt lgkmcnt(6)
    v_mfma_f32_16x16x32_bf16 v[184:187], a[40:43], v[64:67], v[184:187]
    v_mfma_f32_16x16x32_bf16 v[192:195], a[112:115], v[64:67], v[192:195]
    v_mfma_f32_16x16x32_bf16 v[200:203], a[184:187], v[64:67], v[200:203]
    ds_read_b128 v[60:63], v2 offset:14336
    s_waitcnt lgkmcnt(6)
    v_mfma_f32_16x16x32_bf16 v[180:183], a[44:47], v[68:71], v[180:183]
    v_mfma_f32_16x16x32_bf16 v[188:191], a[116:119], v[68:71], v[188:191]
    v_mfma_f32_16x16x32_bf16 v[196:199], a[188:191], v[68:71], v[196:199]
    ds_read_b128 v[64:67], v2 offset:32768
    s_waitcnt lgkmcnt(6)
    v_mfma_f32_16x16x32_bf16 v[184:187], a[44:47], v[72:75], v[184:187]
    v_mfma_f32_16x16x32_bf16 v[192:195], a[116:119], v[72:75], v[192:195]
    v_mfma_f32_16x16x32_bf16 v[200:203], a[188:191], v[72:75], v[200:203]
    ds_read_b128 v[68:71], v2 offset:15360
    s_waitcnt lgkmcnt(6)
    v_mfma_f32_16x16x32_bf16 v[180:183], a[48:51], v[44:47], v[180:183]
    v_mfma_f32_16x16x32_bf16 v[188:191], a[120:123], v[44:47], v[188:191]
    v_mfma_f32_16x16x32_bf16 v[196:199], a[192:195], v[44:47], v[196:199]
    ds_read_b128 v[72:75], v2 offset:33792
    s_waitcnt lgkmcnt(6)
    v_mfma_f32_16x16x32_bf16 v[184:187], a[48:51], v[48:51], v[184:187]
    v_mfma_f32_16x16x32_bf16 v[192:195], a[120:123], v[48:51], v[192:195]
    v_mfma_f32_16x16x32_bf16 v[200:203], a[192:195], v[48:51], v[200:203]
    ds_read_b128 v[44:47], v2 offset:16384
    s_waitcnt lgkmcnt(6)
    v_mfma_f32_16x16x32_bf16 v[180:183], a[52:55], v[52:55], v[180:183]
    v_mfma_f32_16x16x32_bf16 v[188:191], a[124:127], v[52:55], v[188:191]
    v_mfma_f32_16x16x32_bf16 v[196:199], a[196:199], v[52:55], v[196:199]
    ds_read_b128 v[48:51], v2 offset:34816
    s_waitcnt lgkmcnt(6)
    v_mfma_f32_16x16x32_bf16 v[184:187], a[52:55], v[56:59], v[184:187]
    v_mfma_f32_16x16x32_bf16 v[192:195], a[124:127], v[56:59], v[192:195]
    v_mfma_f32_16x16x32_bf16 v[200:203], a[196:199], v[56:59], v[200:203]
    ds_read_b128 v[52:55], v2 offset:17408
    s_waitcnt lgkmcnt(6)
    v_mfma_f32_16x16x32_bf16 v[180:183], a[56:59], v[60:63], v[180:183]
    v_mfma_f32_16x16x32_bf16 v[188:191], a[128:131], v[60:63], v[188:191]
    v_mfma_f32_16x16x32_bf16 v[196:199], a[200:203], v[60:63], v[196:199]
    ds_read_b128 v[56:59], v2 offset:35840
    s_waitcnt lgkmcnt(6)
    v_mfma_f32_16x16x32_bf16 v[184:187], a[56:59], v[64:67], v[184:187]
    v_mfma_f32_16x16x32_bf16 v[192:195], a[128:131], v[64:67], v[192:195]
    v_mfma_f32_16x16x32_bf16 v[200:203], a[200:203], v[64:67], v[200:203]
    s_waitcnt lgkmcnt(5)
    v_mfma_f32_16x16x32_bf16 v[180:183], a[60:63], v[68:71], v[180:183]
    v_mfma_f32_16x16x32_bf16 v[188:191], a[132:135], v[68:71], v[188:191]
    v_mfma_f32_16x16x32_bf16 v[196:199], a[204:207], v[68:71], v[196:199]
    s_waitcnt lgkmcnt(4)
    v_mfma_f32_16x16x32_bf16 v[184:187], a[60:63], v[72:75], v[184:187]
    v_mfma_f32_16x16x32_bf16 v[192:195], a[132:135], v[72:75], v[192:195]
    v_mfma_f32_16x16x32_bf16 v[200:203], a[204:207], v[72:75], v[200:203]
    s_waitcnt lgkmcnt(3)
    v_mfma_f32_16x16x32_bf16 v[180:183], a[64:67], v[44:47], v[180:183]
    v_mfma_f32_16x16x32_bf16 v[188:191], a[136:139], v[44:47], v[188:191]
    v_mfma_f32_16x16x32_bf16 v[196:199], a[208:211], v[44:47], v[196:199]
    s_waitcnt lgkmcnt(2)
    v_mfma_f32_16x16x32_bf16 v[184:187], a[64:67], v[48:51], v[184:187]
    v_mfma_f32_16x16x32_bf16 v[192:195], a[136:139], v[48:51], v[192:195]
    v_mfma_f32_16x16x32_bf16 v[200:203], a[208:211], v[48:51], v[200:203]
    s_waitcnt lgkmcnt(1)
    v_mfma_f32_16x16x32_bf16 v[180:183], a[68:71], v[52:55], v[180:183]
    v_mfma_f32_16x16x32_bf16 v[188:191], a[140:143], v[52:55], v[188:191]
    v_mfma_f32_16x16x32_bf16 v[196:199], a[212:215], v[52:55], v[196:199]
    s_waitcnt lgkmcnt(0)
    v_mfma_f32_16x16x32_bf16 v[184:187], a[68:71], v[56:59], v[184:187]
    v_mfma_f32_16x16x32_bf16 v[192:195], a[140:143], v[56:59], v[192:195]
    v_mfma_f32_16x16x32_bf16 v[200:203], a[212:215], v[56:59], v[200:203]
    s_nop 7
L_kg_ker_ge_13:
    v_mov_b32 v13, 0xbdd2d3e8
    v_mul_lo_u32 v8, v5, s15
    v_lshl_add_u32 v8, v4, 3, v8
    s_lshl_b32 s7, s9, 5
    v_add_u32 v8, s7, v8
    s_movk_i32 s8, 18432
    v_mul_f32 v180, v180, v164
    v_fma_f32 v180, -v165, v152, v180
    v_mul_f32 v181, v181, v164
    v_fma_f32 v181, -v165, v153, v181
    v_mul_f32 v182, v182, v164
    v_fma_f32 v182, -v165, v154, v182
    v_mul_f32 v183, v183, v164
    v_fma_f32 v183, -v165, v155, v183
    v_cvt_pk_bf16_f32 v172, v180, v181
    v_lshlrev_b32 v180, 16, v172
    v_and_b32 v181, 0xffff0000, v172
    v_cvt_pk_bf16_f32 v173, v182, v183
    v_lshlrev_b32 v182, 16, v173
    v_and_b32 v183, 0xffff0000, v173
    v_mul_f32 v172, v180, v180
    v_mul_f32 v173, v181, v181
    v_mul_f32 v174, v182, v182
    v_mul_f32 v175, v183, v183
    v_fmaak_f32 v172, v13, v172, 0xc0135761
    v_fmaak_f32 v173, v13, v173, 0xc0135761
    v_fmaak_f32 v174, v13, v174, 0xc0135761
    v_fmaak_f32 v175, v13, v175, 0xc0135761
    v_mul_f32 v172, v180, v172
    v_mul_f32 v173, v181, v173
    v_mul_f32 v174, v182, v174
    v_mul_f32 v175, v183, v175
    v_exp_f32 v172, v172
    v_exp_f32 v173, v173
    v_exp_f32 v174, v174
    v_exp_f32 v175, v175
    v_add_f32 v172, 1.0, v172
    v_add_f32 v173, 1.0, v173
    v_add_f32 v174, 1.0, v174
    v_add_f32 v175, 1.0, v175
    v_rcp_f32 v172, v172
    v_rcp_f32 v173, v173
    v_rcp_f32 v174, v174
    v_rcp_f32 v175, v175
    v_mul_f32 v180, v180, v172
    v_mul_f32 v181, v181, v173
    v_mul_f32 v182, v182, v174
    v_mul_f32 v183, v183, v175
    v_cvt_pk_bf16_f32 v14, v180, v181
    v_cvt_pk_bf16_f32 v15, v182, v183
    buffer_store_dwordx2 v[14:15], v8, s[64:67], 0 offen offset:0 sc1
    v_mul_f32 v184, v184, v166
    v_fma_f32 v184, -v167, v152, v184
    v_mul_f32 v185, v185, v166
    v_fma_f32 v185, -v167, v153, v185
    v_mul_f32 v186, v186, v166
    v_fma_f32 v186, -v167, v154, v186
    v_mul_f32 v187, v187, v166
    v_fma_f32 v187, -v167, v155, v187
    v_cvt_pk_bf16_f32 v172, v184, v185
    v_lshlrev_b32 v184, 16, v172
    v_and_b32 v185, 0xffff0000, v172
    v_cvt_pk_bf16_f32 v173, v186, v187
    v_lshlrev_b32 v186, 16, v173
    v_and_b32 v187, 0xffff0000, v173
    v_mul_f32 v172, v184, v184
    v_mul_f32 v173, v185, v185
    v_mul_f32 v174, v186, v186
    v_mul_f32 v175, v187, v187
    v_fmaak_f32 v172, v13, v172, 0xc0135761
    v_fmaak_f32 v173, v13, v173, 0xc0135761
    v_fmaak_f32 v174, v13, v174, 0xc0135761
    v_fmaak_f32 v175, v13, v175, 0xc0135761
    v_mul_f32 v172, v184, v172
    v_mul_f32 v173, v185, v173
    v_mul_f32 v174, v186, v174
    v_mul_f32 v175, v187, v175
    v_exp_f32 v172, v172
    v_exp_f32 v173, v173
    v_exp_f32 v174, v174
    v_exp_f32 v175, v175
    v_add_f32 v172, 1.0, v172
    v_add_f32 v173, 1.0, v173
    v_add_f32 v174, 1.0, v174
    v_add_f32 v175, 1.0, v175
    v_rcp_f32 v172, v172
    v_rcp_f32 v173, v173
    v_rcp_f32 v174, v174
    v_rcp_f32 v175, v175
    v_mul_f32 v184, v184, v172
    v_mul_f32 v185, v185, v173
    v_mul_f32 v186, v186, v174
    v_mul_f32 v187, v187, v175
    v_cvt_pk_bf16_f32 v16, v184, v185
    v_cvt_pk_bf16_f32 v17, v186, v187
    buffer_store_dwordx2 v[16:17], v8, s[64:67], s8 offen offset:0 sc1
    v_mul_f32 v188, v188, v164
    v_fma_f32 v188, -v165, v156, v188
    v_mul_f32 v189, v189, v164
    v_fma_f32 v189, -v165, v157, v189
    v_mul_f32 v190, v190, v164
    v_fma_f32 v190, -v165, v158, v190
    v_mul_f32 v191, v191, v164
    v_fma_f32 v191, -v165, v159, v191
    v_cvt_pk_bf16_f32 v172, v188, v189
    v_lshlrev_b32 v188, 16, v172
    v_and_b32 v189, 0xffff0000, v172
    v_cvt_pk_bf16_f32 v173, v190, v191
    v_lshlrev_b32 v190, 16, v173
    v_and_b32 v191, 0xffff0000, v173
    v_mul_f32 v172, v188, v188
    v_mul_f32 v173, v189, v189
    v_mul_f32 v174, v190, v190
    v_mul_f32 v175, v191, v191
    v_fmaak_f32 v172, v13, v172, 0xc0135761
    v_fmaak_f32 v173, v13, v173, 0xc0135761
    v_fmaak_f32 v174, v13, v174, 0xc0135761
    v_fmaak_f32 v175, v13, v175, 0xc0135761
    v_mul_f32 v172, v188, v172
    v_mul_f32 v173, v189, v173
    v_mul_f32 v174, v190, v174
    v_mul_f32 v175, v191, v175
    v_exp_f32 v172, v172
    v_exp_f32 v173, v173
    v_exp_f32 v174, v174
    v_exp_f32 v175, v175
    v_add_f32 v172, 1.0, v172
    v_add_f32 v173, 1.0, v173
    v_add_f32 v174, 1.0, v174
    v_add_f32 v175, 1.0, v175
    v_rcp_f32 v172, v172
    v_rcp_f32 v173, v173
    v_rcp_f32 v174, v174
    v_rcp_f32 v175, v175
    v_mul_f32 v188, v188, v172
    v_mul_f32 v189, v189, v173
    v_mul_f32 v190, v190, v174
    v_mul_f32 v191, v191, v175
    v_cvt_pk_bf16_f32 v18, v188, v189
    v_cvt_pk_bf16_f32 v19, v190, v191
    buffer_store_dwordx2 v[18:19], v8, s[64:67], 0 offen offset:128 sc1
    v_mul_f32 v192, v192, v166
    v_fma_f32 v192, -v167, v156, v192
    v_mul_f32 v193, v193, v166
    v_fma_f32 v193, -v167, v157, v193
    v_mul_f32 v194, v194, v166
    v_fma_f32 v194, -v167, v158, v194
    v_mul_f32 v195, v195, v166
    v_fma_f32 v195, -v167, v159, v195
    v_cvt_pk_bf16_f32 v172, v192, v193
    v_lshlrev_b32 v192, 16, v172
    v_and_b32 v193, 0xffff0000, v172
    v_cvt_pk_bf16_f32 v173, v194, v195
    v_lshlrev_b32 v194, 16, v173
    v_and_b32 v195, 0xffff0000, v173
    v_mul_f32 v172, v192, v192
    v_mul_f32 v173, v193, v193
    v_mul_f32 v174, v194, v194
    v_mul_f32 v175, v195, v195
    v_fmaak_f32 v172, v13, v172, 0xc0135761
    v_fmaak_f32 v173, v13, v173, 0xc0135761
    v_fmaak_f32 v174, v13, v174, 0xc0135761
    v_fmaak_f32 v175, v13, v175, 0xc0135761
    v_mul_f32 v172, v192, v172
    v_mul_f32 v173, v193, v173
    v_mul_f32 v174, v194, v174
    v_mul_f32 v175, v195, v175
    v_exp_f32 v172, v172
    v_exp_f32 v173, v173
    v_exp_f32 v174, v174
    v_exp_f32 v175, v175
    v_add_f32 v172, 1.0, v172
    v_add_f32 v173, 1.0, v173
    v_add_f32 v174, 1.0, v174
    v_add_f32 v175, 1.0, v175
    v_rcp_f32 v172, v172
    v_rcp_f32 v173, v173
    v_rcp_f32 v174, v174
    v_rcp_f32 v175, v175
    v_mul_f32 v192, v192, v172
    v_mul_f32 v193, v193, v173
    v_mul_f32 v194, v194, v174
    v_mul_f32 v195, v195, v175
    v_cvt_pk_bf16_f32 v20, v192, v193
    v_cvt_pk_bf16_f32 v21, v194, v195
    buffer_store_dwordx2 v[20:21], v8, s[64:67], s8 offen offset:128 sc1
    s_cmp_lg_u32 s6, 0
    s_cbranch_scc1 L_kg_ker_s2_14
    v_mul_f32 v196, v196, v164
    v_fma_f32 v196, -v165, v160, v196
    v_mul_f32 v197, v197, v164
    v_fma_f32 v197, -v165, v161, v197
    v_mul_f32 v198, v198, v164
    v_fma_f32 v198, -v165, v162, v198
    v_mul_f32 v199, v199, v164
    v_fma_f32 v199, -v165, v163, v199
    v_cvt_pk_bf16_f32 v172, v196, v197
    v_lshlrev_b32 v196, 16, v172
    v_and_b32 v197, 0xffff0000, v172
    v_cvt_pk_bf16_f32 v173, v198, v199
    v_lshlrev_b32 v198, 16, v173
    v_and_b32 v199, 0xffff0000, v173
    v_mul_f32 v172, v196, v196
    v_mul_f32 v173, v197, v197
    v_mul_f32 v174, v198, v198
    v_mul_f32 v175, v199, v199
    v_fmaak_f32 v172, v13, v172, 0xc0135761
    v_fmaak_f32 v173, v13, v173, 0xc0135761
    v_fmaak_f32 v174, v13, v174, 0xc0135761
    v_fmaak_f32 v175, v13, v175, 0xc0135761
    v_mul_f32 v172, v196, v172
    v_mul_f32 v173, v197, v173
    v_mul_f32 v174, v198, v174
    v_mul_f32 v175, v199, v175
    v_exp_f32 v172, v172
    v_exp_f32 v173, v173
    v_exp_f32 v174, v174
    v_exp_f32 v175, v175
    v_add_f32 v172, 1.0, v172
    v_add_f32 v173, 1.0, v173
    v_add_f32 v174, 1.0, v174
    v_add_f32 v175, 1.0, v175
    v_rcp_f32 v172, v172
    v_rcp_f32 v173, v173
    v_rcp_f32 v174, v174
    v_rcp_f32 v175, v175
    v_mul_f32 v196, v196, v172
    v_mul_f32 v197, v197, v173
    v_mul_f32 v198, v198, v174
    v_mul_f32 v199, v199, v175
    v_cvt_pk_bf16_f32 v22, v196, v197
    v_cvt_pk_bf16_f32 v23, v198, v199
    buffer_store_dwordx2 v[22:23], v8, s[64:67], 0 offen offset:256 sc1
    v_mul_f32 v200, v200, v166
    v_fma_f32 v200, -v167, v160, v200
    v_mul_f32 v201, v201, v166
    v_fma_f32 v201, -v167, v161, v201
    v_mul_f32 v202, v202, v166
    v_fma_f32 v202, -v167, v162, v202
    v_mul_f32 v203, v203, v166
    v_fma_f32 v203, -v167, v163, v203
    v_cvt_pk_bf16_f32 v172, v200, v201
    v_lshlrev_b32 v200, 16, v172
    v_and_b32 v201, 0xffff0000, v172
    v_cvt_pk_bf16_f32 v173, v202, v203
    v_lshlrev_b32 v202, 16, v173
    v_and_b32 v203, 0xffff0000, v173
    v_mul_f32 v172, v200, v200
    v_mul_f32 v173, v201, v201
    v_mul_f32 v174, v202, v202
    v_mul_f32 v175, v203, v203
    v_fmaak_f32 v172, v13, v172, 0xc0135761
    v_fmaak_f32 v173, v13, v173, 0xc0135761
    v_fmaak_f32 v174, v13, v174, 0xc0135761
    v_fmaak_f32 v175, v13, v175, 0xc0135761
    v_mul_f32 v172, v200, v172
    v_mul_f32 v173, v201, v173
    v_mul_f32 v174, v202, v174
    v_mul_f32 v175, v203, v175
    v_exp_f32 v172, v172
    v_exp_f32 v173, v173
    v_exp_f32 v174, v174
    v_exp_f32 v175, v175
    v_add_f32 v172, 1.0, v172
    v_add_f32 v173, 1.0, v173
    v_add_f32 v174, 1.0, v174
    v_add_f32 v175, 1.0, v175
    v_rcp_f32 v172, v172
    v_rcp_f32 v173, v173
    v_rcp_f32 v174, v174
    v_rcp_f32 v175, v175
    v_mul_f32 v200, v200, v172
    v_mul_f32 v201, v201, v173
    v_mul_f32 v202, v202, v174
    v_mul_f32 v203, v203, v175
    v_cvt_pk_bf16_f32 v24, v200, v201
    v_cvt_pk_bf16_f32 v25, v202, v203
    buffer_store_dwordx2 v[24:25], v8, s[64:67], s8 offen offset:256 sc1
L_kg_ker_s2_14:
    s_waitcnt vmcnt(0)
    s_barrier
    s_cmp_lg_u32 s6, 0
    s_cbranch_scc1 L_kg_ker_sig_15
    s_lshl_b32 s7, s68, 8
    s_add_u32 s7, s7, 8192
    v_mov_b32 v9, s7
    v_mov_b32 v10, 1
    s_mov_b64 exec, 1
    global_atomic_add v9, v10, s[76:77]
    s_mov_b64 exec, -1
L_kg_ker_sig_15:
    s_add_u32 s44, s42, 10199040
    s_addc_u32 s45, s43, 0
    s_mov_b32 s46, 663552
    s_mov_b32 s47, 0x20000
    s_add_u32 s11, s10, 0
    buffer_load_dwordx4 a[0:3], v2, s[44:47], s11 offen offset:0
    buffer_load_dwordx4 a[4:7], v2, s[44:47], s11 offen offset:1024
    buffer_load_dwordx4 a[8:11], v2, s[44:47], s11 offen offset:2048
    buffer_load_dwordx4 a[12:15], v2, s[44:47], s11 offen offset:3072
    s_add_u32 s11, s10, 4096
    buffer_load_dwordx4 a[16:19], v2, s[44:47], s11 offen offset:0
    buffer_load_dwordx4 a[20:23], v2, s[44:47], s11 offen offset:1024
    buffer_load_dwordx4 a[24:27], v2, s[44:47], s11 offen offset:2048
    buffer_load_dwordx4 a[28:31], v2, s[44:47], s11 offen offset:3072
    s_add_u32 s11, s10, 8192
    buffer_load_dwordx4 a[32:35], v2, s[44:47], s11 offen offset:0
    buffer_load_dwordx4 a[36:39], v2, s[44:47], s11 offen offset:1024
    buffer_load_dwordx4 a[40:43], v2, s[44:47], s11 offen offset:2048
    buffer_load_dwordx4 a[44:47], v2, s[44:47], s11 offen offset:3072
    s_add_u32 s11, s10, 12288
    buffer_load_dwordx4 a[48:51], v2, s[44:47], s11 offen offset:0
    buffer_load_dwordx4 a[52:55], v2, s[44:47], s11 offen offset:1024
    buffer_load_dwordx4 a[56:59], v2, s[44:47], s11 offen offset:2048
    buffer_load_dwordx4 a[60:63], v2, s[44:47], s11 offen offset:3072
    s_add_u32 s11, s10, 16384
    buffer_load_dwordx4 a[64:67], v2, s[44:47], s11 offen offset:0
    buffer_load_dwordx4 a[68:71], v2, s[44:47], s11 offen offset:1024
    s_add_u32 s11, s10, 73728
    buffer_load_dwordx4 a[72:75], v2, s[44:47], s11 offen offset:0
    buffer_load_dwordx4 a[76:79], v2, s[44:47], s11 offen offset:1024
    buffer_load_dwordx4 a[80:83], v2, s[44:47], s11 offen offset:2048
    buffer_load_dwordx4 a[84:87], v2, s[44:47], s11 offen offset:3072
    s_add_u32 s11, s10, 77824
    buffer_load_dwordx4 a[88:91], v2, s[44:47], s11 offen offset:0
    buffer_load_dwordx4 a[92:95], v2, s[44:47], s11 offen offset:1024
    buffer_load_dwordx4 a[96:99], v2, s[44:47], s11 offen offset:2048
    buffer_load_dwordx4 a[100:103], v2, s[44:47], s11 offen offset:3072
    s_add_u32 s11, s10, 81920
    buffer_load_dwordx4 a[104:107], v2, s[44:47], s11 offen offset:0
    buffer_load_dwordx4 a[108:111], v2, s[44:47], s11 offen offset:1024
    buffer_load_dwordx4 a[112:115], v2, s[44:47], s11 offen offset:2048
    buffer_load_dwordx4 a[116:119], v2, s[44:47], s11 offen offset:3072
    s_add_u32 s11, s10, 86016
    buffer_load_dwordx4 a[120:123], v2, s[44:47], s11 offen offset:0
    buffer_load_dwordx4 a[124:127], v2, s[44:47], s11 offen offset:1024
    buffer_load_dwordx4 a[128:131], v2, s[44:47], s11 offen offset:2048
    buffer_load_dwordx4 a[132:135], v2, s[44:47], s11 offen offset:3072
    s_add_u32 s11, s10, 90112
    buffer_load_dwordx4 a[136:139], v2, s[44:47], s11 offen offset:0
    buffer_load_dwordx4 a[140:143], v2, s[44:47], s11 offen offset:1024
    s_cmp_lg_u32 s6, 0
    s_cbranch_scc1 L_kg_ker_s2_16
    s_add_u32 s11, s10, 147456
    buffer_load_dwordx4 a[144:147], v2, s[44:47], s11 offen offset:0
    buffer_load_dwordx4 a[148:151], v2, s[44:47], s11 offen offset:1024
    buffer_load_dwordx4 a[152:155], v2, s[44:47], s11 offen offset:2048
    buffer_load_dwordx4 a[156:159], v2, s[44:47], s11 offen offset:3072
    s_add_u32 s11, s10, 151552
    buffer_load_dwordx4 a[160:163], v2, s[44:47], s11 offen offset:0
    buffer_load_dwordx4 a[164:167], v2, s[44:47], s11 offen offset:1024
    buffer_load_dwordx4 a[168:171], v2, s[44:47], s11 offen offset:2048
    buffer_load_dwordx4 a[172:175], v2, s[44:47], s11 offen offset:3072
    s_add_u32 s11, s10, 155648
    buffer_load_dwordx4 a[176:179], v2, s[44:47], s11 offen offset:0
    buffer_load_dwordx4 a[180:183], v2, s[44:47], s11 offen offset:1024
    buffer_load_dwordx4 a[184:187], v2, s[44:47], s11 offen offset:2048
    buffer_load_dwordx4 a[188:191], v2, s[44:47], s11 offen offset:3072
    s_add_u32 s11, s10, 159744
    buffer_load_dwordx4 a[192:195], v2, s[44:47], s11 offen offset:0
    buffer_load_dwordx4 a[196:199], v2, s[44:47], s11 offen offset:1024
    buffer_load_dwordx4 a[200:203], v2, s[44:47], s11 offen offset:2048
    buffer_load_dwordx4 a[204:207], v2, s[44:47], s11 offen offset:3072
    s_add_u32 s11, s10, 163840
    buffer_load_dwordx4 a[208:211], v2, s[44:47], s11 offen offset:0
    buffer_load_dwordx4 a[212:215], v2, s[44:47], s11 offen offset:1024
L_kg_ker_s2_16:
    s_add_u32 s7, s79, 0
    s_lshl_b32 s7, s7, 2
    v_add_u32 v9, s7, v4
    v_mov_b32 v10, 2
    v_cmp_gt_u32 vcc, 54, v9
    s_nop 1
    v_cndmask_b32 v10, v10, -2, vcc
    v_cmp_gt_u32 vcc, 36, v9
    s_nop 1
    v_cndmask_b32 v10, v10, 1, vcc
    v_cmp_gt_u32 vcc, 18, v9
    s_nop 1
    v_cndmask_b32 v10, v10, -1, vcc
    v_add_u32 v10, v10, v6
    v_mul_lo_u32 v10, v10, s15
    v_lshl_add_u32 v112, v9, 4, v10
    s_add_u32 s7, s79, 1
    s_lshl_b32 s7, s7, 2
    v_add_u32 v9, s7, v4
    v_mov_b32 v10, 2
    v_cmp_gt_u32 vcc, 54, v9
    s_nop 1
    v_cndmask_b32 v10, v10, -2, vcc
    v_cmp_gt_u32 vcc, 36, v9
    s_nop 1
    v_cndmask_b32 v10, v10, 1, vcc
    v_cmp_gt_u32 vcc, 18, v9
    s_nop 1
    v_cndmask_b32 v10, v10, -1, vcc
    v_add_u32 v10, v10, v6
    v_mul_lo_u32 v10, v10, s15
    v_lshl_add_u32 v113, v9, 4, v10
    s_add_u32 s7, s79, 2
    s_lshl_b32 s7, s7, 2
    v_add_u32 v9, s7, v4
    v_mov_b32 v10, 2
    v_cmp_gt_u32 vcc, 54, v9
    s_nop 1
    v_cndmask_b32 v10, v10, -2, vcc
    v_cmp_gt_u32 vcc, 36, v9
    s_nop 1
    v_cndmask_b32 v10, v10, 1, vcc
    v_cmp_gt_u32 vcc, 18, v9
    s_nop 1
    v_cndmask_b32 v10, v10, -1, vcc
    v_add_u32 v10, v10, v6
    v_mul_lo_u32 v10, v10, s15
    v_lshl_add_u32 v114, v9, 4, v10
    s_add_u32 s7, s79, 3
    s_lshl_b32 s7, s7, 2
    v_add_u32 v9, s7, v4
    v_mov_b32 v10, 2
    v_cmp_gt_u32 vcc, 54, v9
    s_nop 1
    v_cndmask_b32 v10, v10, -2, vcc
    v_cmp_gt_u32 vcc, 36, v9
    s_nop 1
    v_cndmask_b32 v10, v10, 1, vcc
    v_cmp_gt_u32 vcc, 18, v9
    s_nop 1
    v_cndmask_b32 v10, v10, -1, vcc
    v_add_u32 v10, v10, v6
    v_mul_lo_u32 v10, v10, s15
    v_lshl_add_u32 v115, v9, 4, v10
    s_add_u32 s7, s79, 4
    s_lshl_b32 s7, s7, 2
    v_add_u32 v9, s7, v4
    v_mov_b32 v10, 2
    v_cmp_gt_u32 vcc, 54, v9
    s_nop 1
    v_cndmask_b32 v10, v10, -2, vcc
    v_cmp_gt_u32 vcc, 36, v9
    s_nop 1
    v_cndmask_b32 v10, v10, 1, vcc
    v_cmp_gt_u32 vcc, 18, v9
    s_nop 1
    v_cndmask_b32 v10, v10, -1, vcc
    v_add_u32 v10, v10, v6
    v_mul_lo_u32 v10, v10, s15
    v_lshl_add_u32 v116, v9, 4, v10
    s_add_u32 s7, s79, 5
    s_lshl_b32 s7, s7, 2
    v_add_u32 v9, s7, v4
    v_mov_b32 v10, 2
    v_cmp_gt_u32 vcc, 54, v9
    s_nop 1
    v_cndmask_b32 v10, v10, -2, vcc
    v_cmp_gt_u32 vcc, 36, v9
    s_nop 1
    v_cndmask_b32 v10, v10, 1, vcc
    v_cmp_gt_u32 vcc, 18, v9
    s_nop 1
    v_cndmask_b32 v10, v10, -1, vcc
    v_add_u32 v10, v10, v6
    v_mul_lo_u32 v10, v10, s15
    v_lshl_add_u32 v117, v9, 4, v10
    s_add_u32 s7, s79, 6
    s_lshl_b32 s7, s7, 2
    v_add_u32 v9, s7, v4
    v_mov_b32 v10, 2
    v_cmp_gt_u32 vcc, 54, v9
    s_nop 1
    v_cndmask_b32 v10, v10, -2, vcc
    v_cmp_gt_u32 vcc, 36, v9
    s_nop 1
    v_cndmask_b32 v10, v10, 1, vcc
    v_cmp_gt_u32 vcc, 18, v9
    s_nop 1
    v_cndmask_b32 v10, v10, -1, vcc
    v_add_u32 v10, v10, v6
    v_mul_lo_u32 v10, v10, s15
    v_lshl_add_u32 v118, v9, 4, v10
    s_add_u32 s7, s79, 7
    s_lshl_b32 s7, s7, 2
    v_add_u32 v9, s7, v4
    v_mov_b32 v10, 2
    v_cmp_gt_u32 vcc, 54, v9
    s_nop 1
    v_cndmask_b32 v10, v10, -2, vcc
    v_cmp_gt_u32 vcc, 36, v9
    s_nop 1
    v_cndmask_b32 v10, v10, 1, vcc
    v_cmp_gt_u32 vcc, 18, v9
    s_nop 1
    v_cndmask_b32 v10, v10, -1, vcc
    v_add_u32 v10, v10, v6
    v_mul_lo_u32 v10, v10, s15
    v_lshl_add_u32 v119, v9, 4, v10
    s_add_u32 s7, s79, 8
    s_lshl_b32 s7, s7, 2
    v_add_u32 v9, s7, v4
    v_mov_b32 v10, 2
    v_cmp_gt_u32 vcc, 54, v9
    s_nop 1
    v_cndmask_b32 v10, v10, -2, vcc
    v_cmp_gt_u32 vcc, 36, v9
    s_nop 1
    v_cndmask_b32 v10, v10, 1, vcc
    v_cmp_gt_u32 vcc, 18, v9
    s_nop 1
    v_cndmask_b32 v10, v10, -1, vcc
    v_add_u32 v10, v10, v6
    v_mul_lo_u32 v10, v10, s15
    v_lshl_add_u32 v120, v9, 4, v10
    v_lshrrev_b32 v8, 1, v4
    v_lshlrev_b32 v8, 8, v8
    v_lshl_add_u32 v8, v3, 4, v8
    v_and_b32 v9, 1, v4
    v_lshl_add_u32 v8, v9, 3, v8
    s_lshl_b32 s7, s9, 9
    v_add_u32 v8, s7, v8
    ds_read_b64 v[124:125], v8 offset:0
    ds_read_b64 v[126:127], v8 offset:18432
    ds_read_b64 v[128:129], v8 offset:2048
    ds_read_b64 v[130:131], v8 offset:20480
    ds_read_b64 v[132:133], v8 offset:4096
    ds_read_b64 v[134:135], v8 offset:22528
    s_waitcnt lgkmcnt(0)
    v_lshlrev_b32 v204, 16, v124
    v_and_b32 v205, 0xffff0000, v124
    v_lshlrev_b32 v206, 16, v125
    v_and_b32 v207, 0xffff0000, v125
    v_sub_f32 v204, v204, v168
    v_sub_f32 v205, v205, v168
    v_sub_f32 v206, v206, v168
    v_sub_f32 v207, v207, v168
    v_cvt_pk_bf16_f32 v172, v204, v205
    v_lshlrev_b32 v204, 16, v172
    v_and_b32 v205, 0xffff0000, v172
    v_cvt_pk_bf16_f32 v173, v206, v207
    v_lshlrev_b32 v206, 16, v173
    v_and_b32 v207, 0xffff0000, v173
    v_mul_f32 v204, v204, v169
    v_mul_f32 v205, v205, v169
    v_mul_f32 v206, v206, v169
    v_mul_f32 v207, v207, v169
    v_cvt_pk_bf16_f32 v172, v204, v205
    v_lshlrev_b32 v204, 16, v172
    v_and_b32 v205, 0xffff0000, v172
    v_cvt_pk_bf16_f32 v173, v206, v207
    v_lshlrev_b32 v206, 16, v173
    v_and_b32 v207, 0xffff0000, v173
    v_lshlrev_b32 v208, 16, v126
    v_and_b32 v209, 0xffff0000, v126
    v_lshlrev_b32 v210, 16, v127
    v_and_b32 v211, 0xffff0000, v127
    v_sub_f32 v208, v208, v170
    v_sub_f32 v209, v209, v170
    v_sub_f32 v210, v210, v170
    v_sub_f32 v211, v211, v170
    v_cvt_pk_bf16_f32 v172, v208, v209
    v_lshlrev_b32 v208, 16, v172
    v_and_b32 v209, 0xffff0000, v172
    v_cvt_pk_bf16_f32 v173, v210, v211
    v_lshlrev_b32 v210, 16, v173
    v_and_b32 v211, 0xffff0000, v173
    v_mul_f32 v208, v208, v171
    v_mul_f32 v209, v209, v171
    v_mul_f32 v210, v210, v171
    v_mul_f32 v211, v211, v171
    v_cvt_pk_bf16_f32 v172, v208, v209
    v_lshlrev_b32 v208, 16, v172
    v_and_b32 v209, 0xffff0000, v172
    v_cvt_pk_bf16_f32 v173, v210, v211
    v_lshlrev_b32 v210, 16, v173
    v_and_b32 v211, 0xffff0000, v173
    v_lshlrev_b32 v212, 16, v128
    v_and_b32 v213, 0xffff0000, v128
    v_lshlrev_b32 v214, 16, v129
    v_and_b32 v215, 0xffff0000, v129
    v_sub_f32 v212, v212, v168
    v_sub_f32 v213, v213, v168
    v_sub_f32 v214, v214, v168
    v_sub_f32 v215, v215, v168
    v_cvt_pk_bf16_f32 v172, v212, v213
    v_lshlrev_b32 v212, 16, v172
    v_and_b32 v213, 0xffff0000, v172
    v_cvt_pk_bf16_f32 v173, v214, v215
    v_lshlrev_b32 v214, 16, v173
    v_and_b32 v215, 0xffff0000, v173
    v_mul_f32 v212, v212, v169
    v_mul_f32 v213, v213, v169
    v_mul_f32 v214, v214, v169
    v_mul_f32 v215, v215, v169
    v_cvt_pk_bf16_f32 v172, v212, v213
    v_lshlrev_b32 v212, 16, v172
    v_and_b32 v213, 0xffff0000, v172
    v_cvt_pk_bf16_f32 v173, v214, v215
    v_lshlrev_b32 v214, 16, v173
    v_and_b32 v215, 0xffff0000, v173
    v_lshlrev_b32 v216, 16, v130
    v_and_b32 v217, 0xffff0000, v130
    v_lshlrev_b32 v218, 16, v131
    v_and_b32 v219, 0xffff0000, v131
    v_sub_f32 v216, v216, v170
    v_sub_f32 v217, v217, v170
    v_sub_f32 v218, v218, v170
    v_sub_f32 v219, v219, v170
    v_cvt_pk_bf16_f32 v172, v216, v217
    v_lshlrev_b32 v216, 16, v172
    v_and_b32 v217, 0xffff0000, v172
    v_cvt_pk_bf16_f32 v173, v218, v219
    v_lshlrev_b32 v218, 16, v173
    v_and_b32 v219, 0xffff0000, v173
    v_mul_f32 v216, v216, v171
    v_mul_f32 v217, v217, v171
    v_mul_f32 v218, v218, v171
    v_mul_f32 v219, v219, v171
    v_cvt_pk_bf16_f32 v172, v216, v217
    v_lshlrev_b32 v216, 16, v172
    v_and_b32 v217, 0xffff0000, v172
    v_cvt_pk_bf16_f32 v173, v218, v219
    v_lshlrev_b32 v218, 16, v173
    v_and_b32 v219, 0xffff0000, v173
    v_lshlrev_b32 v220, 16, v132
    v_and_b32 v221, 0xffff0000, v132
    v_lshlrev_b32 v222, 16, v133
    v_and_b32 v223, 0xffff0000, v133
    v_sub_f32 v220, v220, v168
    v_sub_f32 v221, v221, v168
    v_sub_f32 v222, v222, v168
    v_sub_f32 v223, v223, v168
    v_cvt_pk_bf16_f32 v172, v220, v221
    v_lshlrev_b32 v220, 16, v172
    v_and_b32 v221, 0xffff0000, v172
    v_cvt_pk_bf16_f32 v173, v222, v223
    v_lshlrev_b32 v222, 16, v173
    v_and_b32 v223, 0xffff0000, v173
    v_mul_f32 v220, v220, v169
    v_mul_f32 v221, v221, v169
    v_mul_f32 v222, v222, v169
    v_mul_f32 v223, v223, v169
    v_cvt_pk_bf16_f32 v172, v220, v221
    v_lshlrev_b32 v220, 16, v172
    v_and_b32 v221, 0xffff0000, v172
    v_cvt_pk_bf16_f32 v173, v222, v223
    v_lshlrev_b32 v222, 16, v173
    v_and_b32 v223, 0xffff0000, v173
    v_lshlrev_b32 v224, 16, v134
    v_and_b32 v225, 0xffff0000, v134
    v_lshlrev_b32 v226, 16, v135
    v_and_b32 v227, 0xffff0000, v135
    v_sub_f32 v224, v224, v170
    v_sub_f32 v225, v225, v170
    v_sub_f32 v226, v226, v170
    v_sub_f32 v227, v227, v170
    v_cvt_pk_bf16_f32 v172, v224, v225
    v_lshlrev_b32 v224, 16, v172
    v_and_b32 v225, 0xffff0000, v172
    v_cvt_pk_bf16_f32 v173, v226, v227
    v_lshlrev_b32 v226, 16, v173
    v_and_b32 v227, 0xffff0000, v173
    v_mul_f32 v224, v224, v171
    v_mul_f32 v225, v225, v171
    v_mul_f32 v226, v226, v171
    v_mul_f32 v227, v227, v171
    v_cvt_pk_bf16_f32 v172, v224, v225
    v_lshlrev_b32 v224, 16, v172
    v_and_b32 v225, 0xffff0000, v172
    v_cvt_pk_bf16_f32 v173, v226, v227
    v_lshlrev_b32 v226, 16, v173
    v_and_b32 v227, 0xffff0000, v173
    s_cmp_lg_u32 s6, 1
    s_cbranch_scc1 L_kg_ker_wait_17
    s_mov_b64 exec, 7
    v_add_u32 v9, s68, v1
    v_max_u32 v9, 1, v9
    v_min_u32 v9, 64, v9
    v_add_u32 v9, 31, v9
    v_lshlrev_b32 v9, 8, v9
    s_mov_b32 s7, 0
L_kg_ker_poll_18:
    global_load_dword v10, v9, s[76:77] sc1
    s_waitcnt vmcnt(0)
    v_cmp_gt_u32 vcc, 4, v10
    s_add_u32 s7, s7, 1
    s_cmp_eq_u64 vcc, 0
    s_cbranch_scc1 L_kg_ker_ok_19
    s_sleep 1
    s_cmp_lt_u32 s7, 0x20000
    s_cbranch_scc1 L_kg_ker_poll_18
L_kg_ker_ok_19:
    s_mov_b64 exec, -1
L_kg_ker_wait_17:
    s_barrier
    buffer_load_dwordx4 v[76:79], v112, s[64:67], 0 offen sc1
    buffer_load_dwordx4 v[80:83], v113, s[64:67], 0 offen sc1
    buffer_load_dwordx4 v[84:87], v114, s[64:67], 0 offen sc1
    buffer_load_dwordx4 v[88:91], v115, s[64:67], 0 offen sc1
    buffer_load_dwordx4 v[92:95], v116, s[64:67], 0 offen sc1
    buffer_load_dwordx4 v[96:99], v117, s[64:67], 0 offen sc1
    buffer_load_dwordx4 v[100:103], v118, s[64:67], 0 offen sc1
    buffer_load_dwordx4 v[104:107], v119, s[64:67], 0 offen sc1
    buffer_load_dwordx4 v[108:111], v120, s[64:67], 0 offen sc1
    s_add_u32 s52, s42, 7110656
    s_addc_u32 s53, s43, 0
    s_mov_b32 s54, 2359296
    s_mov_b32 s55, 0x20000
    s_add_u32 s56, s42, 9469952
    s_addc_u32 s57, s43, 0
    s_mov_b32 s58, 65536
    s_mov_b32 s59, 0x20000
    s_waitcnt vmcnt(8)
    ds_write_b128 v7, v[76:79] offset:36864
    s_waitcnt vmcnt(7)
    ds_write_b128 v7, v[80:83] offset:37888
    s_waitcnt vmcnt(6)
    ds_write_b128 v7, v[84:87] offset:38912
    s_waitcnt vmcnt(5)
    ds_write_b128 v7, v[88:91] offset:39936
    s_waitcnt vmcnt(4)
    ds_write_b128 v7, v[92:95] offset:40960
    s_waitcnt vmcnt(3)
    ds_write_b128 v7, v[96:99] offset:41984
    s_waitcnt vmcnt(2)
    ds_write_b128 v7, v[100:103] offset:43008
    s_waitcnt vmcnt(1)
    ds_write_b128 v7, v[104:107] offset:44032
    s_waitcnt vmcnt(0)
    ds_write_b128 v7, v[108:111] offset:45056
    s_waitcnt lgkmcnt(0)
    s_barrier
    s_cmp_eq_u32 s6, 0
    s_cbranch_scc1 L_kg_ker_g0_20
    ds_read_b128 v[44:47], v11 offset:0
    ds_read_b128 v[48:51], v11 offset:18432
    ds_read_b128 v[52:55], v11 offset:1024
    ds_read_b128 v[56:59], v11 offset:19456
    ds_read_b128 v[60:63], v11 offset:2048
    ds_read_b128 v[64:67], v11 offset:20480
    ds_read_b128 v[68:71], v11 offset:3072
    s_waitcnt lgkmcnt(6)
    v_mfma_f32_16x16x32_bf16 v[180:183], a[0:3], v[44:47], 0
    v_mfma_f32_16x16x32_bf16 v[188:191], a[72:75], v[44:47], 0
    ds_read_b128 v[72:75], v11 offset:21504
    s_waitcnt lgkmcnt(6)
    v_mfma_f32_16x16x32_bf16 v[184:187], a[0:3], v[48:51], 0
    v_mfma_f32_16x16x32_bf16 v[192:195], a[72:75], v[48:51], 0
    ds_read_b128 v[44:47], v11 offset:4096
    s_waitcnt lgkmcnt(6)
    v_mfma_f32_16x16x32_bf16 v[180:183], a[4:7], v[52:55], v[180:183]
    v_mfma_f32_16x16x32_bf16 v[188:191], a[76:79], v[52:55], v[188:191]
    ds_read_b128 v[48:51], v11 offset:22528
    s_waitcnt lgkmcnt(6)
    v_mfma_f32_16x16x32_bf16 v[184:187], a[4:7], v[56:59], v[184:187]
    v_mfma_f32_16x16x32_bf16 v[192:195], a[76:79], v[56:59], v[192:195]
    ds_read_b128 v[52:55], v11 offset:5120
    s_waitcnt lgkmcnt(6)
    v_mfma_f32_16x16x32_bf16 v[180:183], a[8:11], v[60:63], v[180:183]
    v_mfma_f32_16x16x32_bf16 v[188:191], a[80:83], v[60:63], v[188:191]
    ds_read_b128 v[56:59], v11 offset:23552
    s_waitcnt lgkmcnt(6)
    v_mfma_f32_16x16x32_bf16 v[184:187], a[8:11], v[64:67], v[184:187]
    v_mfma_f32_16x16x32_bf16 v[192:195], a[80:83], v[64:67], v[192:195]
    ds_read_b128 v[60:63], v11 offset:6144
    s_waitcnt lgkmcnt(6)
    v_mfma_f32_16x16x32_bf16 v[180:183], a[12:15], v[68:71], v[180:183]
    v_mfma_f32_16x16x32_bf16 v[188:191], a[84:87], v[68:71], v[188:191]
    ds_read_b128 v[64:67], v11 offset:24576
    s_waitcnt lgkmcnt(6)
    v_mfma_f32_16x16x32_bf16 v[184:187], a[12:15], v[72:75], v[184:187]
    v_mfma_f32_16x16x32_bf16 v[192:195], a[84:87], v[72:75], v[192:195]
    ds_read_b128 v[68:71], v11 offset:7168
    s_waitcnt lgkmcnt(6)
    v_mfma_f32_16x16x32_bf16 v[180:183], a[16:19], v[44:47], v[180:183]
    v_mfma_f32_16x16x32_bf16 v[188:191], a[88:91], v[44:47], v[188:191]
    ds_read_b128 v[72:75], v11 offset:25600
    s_waitcnt lgkmcnt(6)
    v_mfma_f32_16x16x32_bf16 v[184:187], a[16:19], v[48:51], v[184:187]
    v_mfma_f32_16x16x32_bf16 v[192:195], a[88:91], v[48:51], v[192:195]
    ds_read_b128 v[44:47], v11 offset:8192
    s_waitcnt lgkmcnt(6)
    v_mfma_f32_16x16x32_bf16 v[180:183], a[20:23], v[52:55], v[180:183]
    v_mfma_f32_16x16x32_bf16 v[188:191], a[92:95], v[52:55], v[188:191]
    ds_read_b128 v[48:51], v11 offset:26624
    s_waitcnt lgkmcnt(6)
    v_mfma_f32_16x16x32_bf16 v[184:187], a[20:23], v[56:59], v[184:187]
    v_mfma_f32_16x16x32_bf16 v[192:195], a[92:95], v[56:59], v[192:195]
    ds_read_b128 v[52:55], v11 offset:9216
    s_waitcnt lgkmcnt(6)
    v_mfma_f32_16x16x32_bf16 v[180:183], a[24:27], v[60:63], v[180:183]
    v_mfma_f32_16x16x32_bf16 v[188:191], a[96:99], v[60:63], v[188:191]
    ds_read_b128 v[56:59], v11 offset:27648
    s_waitcnt lgkmcnt(6)
    v_mfma_f32_16x16x32_bf16 v[184:187], a[24:27], v[64:67], v[184:187]
    v_mfma_f32_16x16x32_bf16 v[192:195], a[96:99], v[64:67], v[192:195]
    ds_read_b128 v[60:63], v11 offset:10240
    s_waitcnt lgkmcnt(6)
    v_mfma_f32_16x16x32_bf16 v[180:183], a[28:31], v[68:71], v[180:183]
    v_mfma_f32_16x16x32_bf16 v[188:191], a[100:103], v[68:71], v[188:191]
    ds_read_b128 v[64:67], v11 offset:28672
    s_waitcnt lgkmcnt(6)
    v_mfma_f32_16x16x32_bf16 v[184:187], a[28:31], v[72:75], v[184:187]
    v_mfma_f32_16x16x32_bf16 v[192:195], a[100:103], v[72:75], v[192:195]
    ds_read_b128 v[68:71], v11 offset:11264
    s_waitcnt lgkmcnt(6)
    v_mfma_f32_16x16x32_bf16 v[180:183], a[32:35], v[44:47], v[180:183]
    v_mfma_f32_16x16x32_bf16 v[188:191], a[104:107], v[44:47], v[188:191]
    ds_read_b128 v[72:75], v11 offset:29696
    s_waitcnt lgkmcnt(6)
    v_mfma_f32_16x16x32_bf16 v[184:187], a[32:35], v[48:51], v[184:187]
    v_mfma_f32_16x16x32_bf16 v[192:195], a[104:107], v[48:51], v[192:195]
    ds_read_b128 v[44:47], v11 offset:12288
    s_waitcnt lgkmcnt(6)
    v_mfma_f32_16x16x32_bf16 v[180:183], a[36:39], v[52:55], v[180:183]
    v_mfma_f32_16x16x32_bf16 v[188:191], a[108:111], v[52:55], v[188:191]
    ds_read_b128 v[48:51], v11 offset:30720
    s_waitcnt lgkmcnt(6)
    v_mfma_f32_16x16x32_bf16 v[184:187], a[36:39], v[56:59], v[184:187]
    v_mfma_f32_16x16x32_bf16 v[192:195], a[108:111], v[56:59], v[192:195]
    ds_read_b128 v[52:55], v11 offset:13312
    s_waitcnt lgkmcnt(6)
    v_mfma_f32_16x16x32_bf16 v[180:183], a[40:43], v[60:63], v[180:183]
    v_mfma_f32_16x16x32_bf16 v[188:191], a[112:115], v[60:63], v[188:191]
    ds_read_b128 v[56:59], v11 offset:31744
    s_waitcnt lgkmcnt(6)
    v_mfma_f32_16x16x32_bf16 v[184:187], a[40:43], v[64:67], v[184:187]
    v_mfma_f32_16x16x32_bf16 v[192:195], a[112:115], v[64:67], v[192:195]
    ds_read_b128 v[60:63], v11 offset:14336
    s_waitcnt lgkmcnt(6)
    v_mfma_f32_16x16x32_bf16 v[180:183], a[44:47], v[68:71], v[180:183]
    v_mfma_f32_16x16x32_bf16 v[188:191], a[116:119], v[68:71], v[188:191]
    ds_read_b128 v[64:67], v11 offset:32768
    s_waitcnt lgkmcnt(6)
    v_mfma_f32_16x16x32_bf16 v[184:187], a[44:47], v[72:75], v[184:187]
    v_mfma_f32_16x16x32_bf16 v[192:195], a[116:119], v[72:75], v[192:195]
    ds_read_b128 v[68:71], v11 offset:15360
    s_waitcnt lgkmcnt(6)
    v_mfma_f32_16x16x32_bf16 v[180:183], a[48:51], v[44:47], v[180:183]
    v_mfma_f32_16x16x32_bf16 v[188:191], a[120:123], v[44:47], v[188:191]
    ds_read_b128 v[72:75], v11 offset:33792
    s_waitcnt lgkmcnt(6)
    v_mfma_f32_16x16x32_bf16 v[184:187], a[48:51], v[48:51], v[184:187]
    v_mfma_f32_16x16x32_bf16 v[192:195], a[120:123], v[48:51], v[192:195]
    ds_read_b128 v[44:47], v11 offset:16384
    s_waitcnt lgkmcnt(6)
    v_mfma_f32_16x16x32_bf16 v[180:183], a[52:55], v[52:55], v[180:183]
    v_mfma_f32_16x16x32_bf16 v[188:191], a[124:127], v[52:55], v[188:191]
    ds_read_b128 v[48:51], v11 offset:34816
    s_waitcnt lgkmcnt(6)
    v_mfma_f32_16x16x32_bf16 v[184:187], a[52:55], v[56:59], v[184:187]
    v_mfma_f32_16x16x32_bf16 v[192:195], a[124:127], v[56:59], v[192:195]
    ds_read_b128 v[52:55], v11 offset:17408
    s_waitcnt lgkmcnt(6)
    v_mfma_f32_16x16x32_bf16 v[180:183], a[56:59], v[60:63], v[180:183]
    v_mfma_f32_16x16x32_bf16 v[188:191], a[128:131], v[60:63], v[188:191]
    ds_read_b128 v[56:59], v11 offset:35840
    s_waitcnt lgkmcnt(6)
    v_mfma_f32_16x16x32_bf16 v[184:187], a[56:59], v[64:67], v[184:187]
    v_mfma_f32_16x16x32_bf16 v[192:195], a[128:131], v[64:67], v[192:195]
    s_waitcnt lgkmcnt(5)
    v_mfma_f32_16x16x32_bf16 v[180:183], a[60:63], v[68:71], v[180:183]
    v_mfma_f32_16x16x32_bf16 v[188:191], a[132:135], v[68:71], v[188:191]
    s_waitcnt lgkmcnt(4)
    v_mfma_f32_16x16x32_bf16 v[184:187], a[60:63], v[72:75], v[184:187]
    v_mfma_f32_16x16x32_bf16 v[192:195], a[132:135], v[72:75], v[192:195]
    s_waitcnt lgkmcnt(3)
    v_mfma_f32_16x16x32_bf16 v[180:183], a[64:67], v[44:47], v[180:183]
    v_mfma_f32_16x16x32_bf16 v[188:191], a[136:139], v[44:47], v[188:191]
    s_waitcnt lgkmcnt(2)
    v_mfma_f32_16x16x32_bf16 v[184:187], a[64:67], v[48:51], v[184:187]
    v_mfma_f32_16x16x32_bf16 v[192:195], a[136:139], v[48:51], v[192:195]
    s_waitcnt lgkmcnt(1)
    v_mfma_f32_16x16x32_bf16 v[180:183], a[68:71], v[52:55], v[180:183]
    v_mfma_f32_16x16x32_bf16 v[188:191], a[140:143], v[52:55], v[188:191]
    s_waitcnt lgkmcnt(0)
    v_mfma_f32_16x16x32_bf16 v[184:187], a[68:71], v[56:59], v[184:187]
    v_mfma_f32_16x16x32_bf16 v[192:195], a[140:143], v[56:59], v[192:195]
    s_nop 7
    s_branch L_kg_ker_ge_21
L_kg_ker_g0_20:
    ds_read_b128 v[44:47], v11 offset:0
    ds_read_b128 v[48:51], v11 offset:18432
    ds_read_b128 v[52:55], v11 offset:1024
    ds_read_b128 v[56:59], v11 offset:19456
    ds_read_b128 v[60:63], v11 offset:2048
    ds_read_b128 v[64:67], v11 offset:20480
    ds_read_b128 v[68:71], v11 offset:3072
    s_waitcnt lgkmcnt(6)
    v_mfma_f32_16x16x32_bf16 v[180:183], a[0:3], v[44:47], 0
    v_mfma_f32_16x16x32_bf16 v[188:191], a[72:75], v[44:47], 0
    v_mfma_f32_16x16x32_bf16 v[196:199], a[144:147], v[44:47], 0
    ds_read_b128 v[72:75], v11 offset:21504
    s_waitcnt lgkmcnt(6)
    v_mfma_f32_16x16x32_bf16 v[184:187], a[0:3], v[48:51], 0
    v_mfma_f32_16x16x32_bf16 v[192:195], a[72:75], v[48:51], 0
    v_mfma_f32_16x16x32_bf16 v[200:203], a[144:147], v[48:51], 0
    ds_read_b128 v[44:47], v11 offset:4096
    s_waitcnt lgkmcnt(6)
    v_mfma_f32_16x16x32_bf16 v[180:183], a[4:7], v[52:55], v[180:183]
    v_mfma_f32_16x16x32_bf16 v[188:191], a[76:79], v[52:55], v[188:191]
    v_mfma_f32_16x16x32_bf16 v[196:199], a[148:151], v[52:55], v[196:199]
    ds_read_b128 v[48:51], v11 offset:22528
    s_waitcnt lgkmcnt(6)
    v_mfma_f32_16x16x32_bf16 v[184:187], a[4:7], v[56:59], v[184:187]
    v_mfma_f32_16x16x32_bf16 v[192:195], a[76:79], v[56:59], v[192:195]
    v_mfma_f32_16x16x32_bf16 v[200:203], a[148:151], v[56:59], v[200:203]
    ds_read_b128 v[52:55], v11 offset:5120
    s_waitcnt lgkmcnt(6)
    v_mfma_f32_16x16x32_bf16 v[180:183], a[8:11], v[60:63], v[180:183]
    v_mfma_f32_16x16x32_bf16 v[188:191], a[80:83], v[60:63], v[188:191]
    v_mfma_f32_16x16x32_bf16 v[196:199], a[152:155], v[60:63], v[196:199]
    ds_read_b128 v[56:59], v11 offset:23552
    s_waitcnt lgkmcnt(6)
    v_mfma_f32_16x16x32_bf16 v[184:187], a[8:11], v[64:67], v[184:187]
    v_mfma_f32_16x16x32_bf16 v[192:195], a[80:83], v[64:67], v[192:195]
    v_mfma_f32_16x16x32_bf16 v[200:203], a[152:155], v[64:67], v[200:203]
    ds_read_b128 v[60:63], v11 offset:6144
    s_waitcnt lgkmcnt(6)
    v_mfma_f32_16x16x32_bf16 v[180:183], a[12:15], v[68:71], v[180:183]
    v_mfma_f32_16x16x32_bf16 v[188:191], a[84:87], v[68:71], v[188:191]
    v_mfma_f32_16x16x32_bf16 v[196:199], a[156:159], v[68:71], v[196:199]
    ds_read_b128 v[64:67], v11 offset:24576
    s_waitcnt lgkmcnt(6)
    v_mfma_f32_16x16x32_bf16 v[184:187], a[12:15], v[72:75], v[184:187]
    v_mfma_f32_16x16x32_bf16 v[192:195], a[84:87], v[72:75], v[192:195]
    v_mfma_f32_16x16x32_bf16 v[200:203], a[156:159], v[72:75], v[200:203]
    ds_read_b128 v[68:71], v11 offset:7168
    s_waitcnt lgkmcnt(6)
    v_mfma_f32_16x16x32_bf16 v[180:183], a[16:19], v[44:47], v[180:183]
    v_mfma_f32_16x16x32_bf16 v[188:191], a[88:91], v[44:47], v[188:191]
    v_mfma_f32_16x16x32_bf16 v[196:199], a[160:163], v[44:47], v[196:199]
    ds_read_b128 v[72:75], v11 offset:25600
    s_waitcnt lgkmcnt(6)
    v_mfma_f32_16x16x32_bf16 v[184:187], a[16:19], v[48:51], v[184:187]
    v_mfma_f32_16x16x32_bf16 v[192:195], a[88:91], v[48:51], v[192:195]
    v_mfma_f32_16x16x32_bf16 v[200:203], a[160:163], v[48:51], v[200:203]
    ds_read_b128 v[44:47], v11 offset:8192
    s_waitcnt lgkmcnt(6)
    v_mfma_f32_16x16x32_bf16 v[180:183], a[20:23], v[52:55], v[180:183]
    v_mfma_f32_16x16x32_bf16 v[188:191], a[92:95], v[52:55], v[188:191]
    v_mfma_f32_16x16x32_bf16 v[196:199], a[164:167], v[52:55], v[196:199]
    ds_read_b128 v[48:51], v11 offset:26624
    s_waitcnt lgkmcnt(6)
    v_mfma_f32_16x16x32_bf16 v[184:187], a[20:23], v[56:59], v[184:187]
    v_mfma_f32_16x16x32_bf16 v[192:195], a[92:95], v[56:59], v[192:195]
    v_mfma_f32_16x16x32_bf16 v[200:203], a[164:167], v[56:59], v[200:203]
    ds_read_b128 v[52:55], v11 offset:9216
    s_waitcnt lgkmcnt(6)
    v_mfma_f32_16x16x32_bf16 v[180:183], a[24:27], v[60:63], v[180:183]
    v_mfma_f32_16x16x32_bf16 v[188:191], a[96:99], v[60:63], v[188:191]
    v_mfma_f32_16x16x32_bf16 v[196:199], a[168:171], v[60:63], v[196:199]
    ds_read_b128 v[56:59], v11 offset:27648
    s_waitcnt lgkmcnt(6)
    v_mfma_f32_16x16x32_bf16 v[184:187], a[24:27], v[64:67], v[184:187]
    v_mfma_f32_16x16x32_bf16 v[192:195], a[96:99], v[64:67], v[192:195]
    v_mfma_f32_16x16x32_bf16 v[200:203], a[168:171], v[64:67], v[200:203]
    ds_read_b128 v[60:63], v11 offset:10240
    s_waitcnt lgkmcnt(6)
    v_mfma_f32_16x16x32_bf16 v[180:183], a[28:31], v[68:71], v[180:183]
    v_mfma_f32_16x16x32_bf16 v[188:191], a[100:103], v[68:71], v[188:191]
    v_mfma_f32_16x16x32_bf16 v[196:199], a[172:175], v[68:71], v[196:199]
    ds_read_b128 v[64:67], v11 offset:28672
    s_waitcnt lgkmcnt(6)
    v_mfma_f32_16x16x32_bf16 v[184:187], a[28:31], v[72:75], v[184:187]
    v_mfma_f32_16x16x32_bf16 v[192:195], a[100:103], v[72:75], v[192:195]
    v_mfma_f32_16x16x32_bf16 v[200:203], a[172:175], v[72:75], v[200:203]
    ds_read_b128 v[68:71], v11 offset:11264
    s_waitcnt lgkmcnt(6)
    v_mfma_f32_16x16x32_bf16 v[180:183], a[32:35], v[44:47], v[180:183]
    v_mfma_f32_16x16x32_bf16 v[188:191], a[104:107], v[44:47], v[188:191]
    v_mfma_f32_16x16x32_bf16 v[196:199], a[176:179], v[44:47], v[196:199]
    ds_read_b128 v[72:75], v11 offset:29696
    s_waitcnt lgkmcnt(6)
    v_mfma_f32_16x16x32_bf16 v[184:187], a[32:35], v[48:51], v[184:187]
    v_mfma_f32_16x16x32_bf16 v[192:195], a[104:107], v[48:51], v[192:195]
    v_mfma_f32_16x16x32_bf16 v[200:203], a[176:179], v[48:51], v[200:203]
    ds_read_b128 v[44:47], v11 offset:12288
    s_waitcnt lgkmcnt(6)
    v_mfma_f32_16x16x32_bf16 v[180:183], a[36:39], v[52:55], v[180:183]
    v_mfma_f32_16x16x32_bf16 v[188:191], a[108:111], v[52:55], v[188:191]
    v_mfma_f32_16x16x32_bf16 v[196:199], a[180:183], v[52:55], v[196:199]
    ds_read_b128 v[48:51], v11 offset:30720
    s_waitcnt lgkmcnt(6)
    v_mfma_f32_16x16x32_bf16 v[184:187], a[36:39], v[56:59], v[184:187]
    v_mfma_f32_16x16x32_bf16 v[192:195], a[108:111], v[56:59], v[192:195]
    v_mfma_f32_16x16x32_bf16 v[200:203], a[180:183], v[56:59], v[200:203]
    ds_read_b128 v[52:55], v11 offset:13312
    s_waitcnt lgkmcnt(6)
    v_mfma_f32_16x16x32_bf16 v[180:183], a[40:43], v[60:63], v[180:183]
    v_mfma_f32_16x16x32_bf16 v[188:191], a[112:115], v[60:63], v[188:191]
    v_mfma_f32_16x16x32_bf16 v[196:199], a[184:187], v[60:63], v[196:199]
    ds_read_b128 v[56:59], v11 offset:31744
    s_waitcnt lgkmcnt(6)
    v_mfma_f32_16x16x32_bf16 v[184:187], a[40:43], v[64:67], v[184:187]
    v_mfma_f32_16x16x32_bf16 v[192:195], a[112:115], v[64:67], v[192:195]
    v_mfma_f32_16x16x32_bf16 v[200:203], a[184:187], v[64:67], v[200:203]
    ds_read_b128 v[60:63], v11 offset:14336
    s_waitcnt lgkmcnt(6)
    v_mfma_f32_16x16x32_bf16 v[180:183], a[44:47], v[68:71], v[180:183]
    v_mfma_f32_16x16x32_bf16 v[188:191], a[116:119], v[68:71], v[188:191]
    v_mfma_f32_16x16x32_bf16 v[196:199], a[188:191], v[68:71], v[196:199]
    ds_read_b128 v[64:67], v11 offset:32768
    s_waitcnt lgkmcnt(6)
    v_mfma_f32_16x16x32_bf16 v[184:187], a[44:47], v[72:75], v[184:187]
    v_mfma_f32_16x16x32_bf16 v[192:195], a[116:119], v[72:75], v[192:195]
    v_mfma_f32_16x16x32_bf16 v[200:203], a[188:191], v[72:75], v[200:203]
    ds_read_b128 v[68:71], v11 offset:15360
    s_waitcnt lgkmcnt(6)
    v_mfma_f32_16x16x32_bf16 v[180:183], a[48:51], v[44:47], v[180:183]
    v_mfma_f32_16x16x32_bf16 v[188:191], a[120:123], v[44:47], v[188:191]
    v_mfma_f32_16x16x32_bf16 v[196:199], a[192:195], v[44:47], v[196:199]
    ds_read_b128 v[72:75], v11 offset:33792
    s_waitcnt lgkmcnt(6)
    v_mfma_f32_16x16x32_bf16 v[184:187], a[48:51], v[48:51], v[184:187]
    v_mfma_f32_16x16x32_bf16 v[192:195], a[120:123], v[48:51], v[192:195]
    v_mfma_f32_16x16x32_bf16 v[200:203], a[192:195], v[48:51], v[200:203]
    ds_read_b128 v[44:47], v11 offset:16384
    s_waitcnt lgkmcnt(6)
    v_mfma_f32_16x16x32_bf16 v[180:183], a[52:55], v[52:55], v[180:183]
    v_mfma_f32_16x16x32_bf16 v[188:191], a[124:127], v[52:55], v[188:191]
    v_mfma_f32_16x16x32_bf16 v[196:199], a[196:199], v[52:55], v[196:199]
    ds_read_b128 v[48:51], v11 offset:34816
    s_waitcnt lgkmcnt(6)
    v_mfma_f32_16x16x32_bf16 v[184:187], a[52:55], v[56:59], v[184:187]
    v_mfma_f32_16x16x32_bf16 v[192:195], a[124:127], v[56:59], v[192:195]
    v_mfma_f32_16x16x32_bf16 v[200:203], a[196:199], v[56:59], v[200:203]
    ds_read_b128 v[52:55], v11 offset:17408
    s_waitcnt lgkmcnt(6)
    v_mfma_f32_16x16x32_bf16 v[180:183], a[56:59], v[60:63], v[180:183]
    v_mfma_f32_16x16x32_bf16 v[188:191], a[128:131], v[60:63], v[188:191]
    v_mfma_f32_16x16x32_bf16 v[196:199], a[200:203], v[60:63], v[196:199]
    ds_read_b128 v[56:59], v11 offset:35840
    s_waitcnt lgkmcnt(6)
    v_mfma_f32_16x16x32_bf16 v[184:187], a[56:59], v[64:67], v[184:187]
    v_mfma_f32_16x16x32_bf16 v[192:195], a[128:131], v[64:67], v[192:195]
    v_mfma_f32_16x16x32_bf16 v[200:203], a[200:203], v[64:67], v[200:203]
    s_waitcnt lgkmcnt(5)
    v_mfma_f32_16x16x32_bf16 v[180:183], a[60:63], v[68:71], v[180:183]
    v_mfma_f32_16x16x32_bf16 v[188:191], a[132:135], v[68:71], v[188:191]
    v_mfma_f32_16x16x32_bf16 v[196:199], a[204:207], v[68:71], v[196:199]
    s_waitcnt lgkmcnt(4)
    v_mfma_f32_16x16x32_bf16 v[184:187], a[60:63], v[72:75], v[184:187]
    v_mfma_f32_16x16x32_bf16 v[192:195], a[132:135], v[72:75], v[192:195]
    v_mfma_f32_16x16x32_bf16 v[200:203], a[204:207], v[72:75], v[200:203]
    s_waitcnt lgkmcnt(3)
    v_mfma_f32_16x16x32_bf16 v[180:183], a[64:67], v[44:47], v[180:183]
    v_mfma_f32_16x16x32_bf16 v[188:191], a[136:139], v[44:47], v[188:191]
    v_mfma_f32_16x16x32_bf16 v[196:199], a[208:211], v[44:47], v[196:199]
    s_waitcnt lgkmcnt(2)
    v_mfma_f32_16x16x32_bf16 v[184:187], a[64:67], v[48:51], v[184:187]
    v_mfma_f32_16x16x32_bf16 v[192:195], a[136:139], v[48:51], v[192:195]
    v_mfma_f32_16x16x32_bf16 v[200:203], a[208:211], v[48:51], v[200:203]
    s_waitcnt lgkmcnt(1)
    v_mfma_f32_16x16x32_bf16 v[180:183], a[68:71], v[52:55], v[180:183]
    v_mfma_f32_16x16x32_bf16 v[188:191], a[140:143], v[52:55], v[188:191]
    v_mfma_f32_16x16x32_bf16 v[196:199], a[212:215], v[52:55], v[196:199]
    s_waitcnt lgkmcnt(0)
    v_mfma_f32_16x16x32_bf16 v[184:187], a[68:71], v[56:59], v[184:187]
    v_mfma_f32_16x16x32_bf16 v[192:195], a[140:143], v[56:59], v[192:195]
    v_mfma_f32_16x16x32_bf16 v[200:203], a[212:215], v[56:59], v[200:203]
    s_nop 7
L_kg_ker_ge_21:
    s_mul_i32 s7, s68, 36864
    v_add_u32 v8, s7, v8
    v_mov_b32 v32, 0
    v_mov_b32 v33, 0
    v_mov_b32 v34, 0
    v_mov_b32 v35, 0
    v_add_u32 v9, 4096, v8
    v_cvt_pk_bf16_f32 v172, v180, v181
    v_lshlrev_b32 v180, 16, v172
    v_and_b32 v181, 0xffff0000, v172
    v_cvt_pk_bf16_f32 v173, v182, v183
    v_lshlrev_b32 v182, 16, v173
    v_and_b32 v183, 0xffff0000, v173
    v_add_f32 v204, v204, v180
    v_add_f32 v205, v205, v181
    v_add_f32 v206, v206, v182
    v_add_f32 v207, v207, v183
    v_cvt_pk_bf16_f32 v14, v204, v205
    v_cvt_pk_bf16_f32 v15, v206, v207
    buffer_store_dwordx2 v[14:15], v8, s[52:55], 0 offen offset:0 sc1
    v_dot2_f32_bf16 v32, v14, s12, v32
    v_dot2_f32_bf16 v33, v14, v14, v33
    v_dot2_f32_bf16 v32, v15, s12, v32
    v_dot2_f32_bf16 v33, v15, v15, v33
    v_cvt_pk_bf16_f32 v172, v184, v185
    v_lshlrev_b32 v184, 16, v172
    v_and_b32 v185, 0xffff0000, v172
    v_cvt_pk_bf16_f32 v173, v186, v187
    v_lshlrev_b32 v186, 16, v173
    v_and_b32 v187, 0xffff0000, v173
    v_add_f32 v208, v208, v184
    v_add_f32 v209, v209, v185
    v_add_f32 v210, v210, v186
    v_add_f32 v211, v211, v187
    v_cvt_pk_bf16_f32 v16, v208, v209
    v_cvt_pk_bf16_f32 v17, v210, v211
    buffer_store_dwordx2 v[16:17], v8, s[52:55], s8 offen offset:0 sc1
    v_dot2_f32_bf16 v34, v16, s12, v34
    v_dot2_f32_bf16 v35, v16, v16, v35
    v_dot2_f32_bf16 v34, v17, s12, v34
    v_dot2_f32_bf16 v35, v17, v17, v35
    v_cvt_pk_bf16_f32 v172, v188, v189
    v_lshlrev_b32 v188, 16, v172
    v_and_b32 v189, 0xffff0000, v172
    v_cvt_pk_bf16_f32 v173, v190, v191
    v_lshlrev_b32 v190, 16, v173
    v_and_b32 v191, 0xffff0000, v173
    v_add_f32 v212, v212, v188
    v_add_f32 v213, v213, v189
    v_add_f32 v214, v214, v190
    v_add_f32 v215, v215, v191
    v_cvt_pk_bf16_f32 v18, v212, v213
    v_cvt_pk_bf16_f32 v19, v214, v215
    buffer_store_dwordx2 v[18:19], v8, s[52:55], 0 offen offset:2048 sc1
    v_dot2_f32_bf16 v32, v18, s12, v32
    v_dot2_f32_bf16 v33, v18, v18, v33
    v_dot2_f32_bf16 v32, v19, s12, v32
    v_dot2_f32_bf16 v33, v19, v19, v33
    v_cvt_pk_bf16_f32 v172, v192, v193
    v_lshlrev_b32 v192, 16, v172
    v_and_b32 v193, 0xffff0000, v172
    v_cvt_pk_bf16_f32 v173, v194, v195
    v_lshlrev_b32 v194, 16, v173
    v_and_b32 v195, 0xffff0000, v173
    v_add_f32 v216, v216, v192
    v_add_f32 v217, v217, v193
    v_add_f32 v218, v218, v194
    v_add_f32 v219, v219, v195
    v_cvt_pk_bf16_f32 v20, v216, v217
    v_cvt_pk_bf16_f32 v21, v218, v219
    buffer_store_dwordx2 v[20:21], v8, s[52:55], s8 offen offset:2048 sc1
    v_dot2_f32_bf16 v34, v20, s12, v34
    v_dot2_f32_bf16 v35, v20, v20, v35
    v_dot2_f32_bf16 v34, v21, s12, v34
    v_dot2_f32_bf16 v35, v21, v21, v35
    s_cmp_lg_u32 s6, 0
    s_cbranch_scc1 L_kg_ker_s2_22
    v_cvt_pk_bf16_f32 v172, v196, v197
    v_lshlrev_b32 v196, 16, v172
    v_and_b32 v197, 0xffff0000, v172
    v_cvt_pk_bf16_f32 v173, v198, v199
    v_lshlrev_b32 v198, 16, v173
    v_and_b32 v199, 0xffff0000, v173
    v_add_f32 v220, v220, v196
    v_add_f32 v221, v221, v197
    v_add_f32 v222, v222, v198
    v_add_f32 v223, v223, v199
    v_cvt_pk_bf16_f32 v22, v220, v221
    v_cvt_pk_bf16_f32 v23, v222, v223
    buffer_store_dwordx2 v[22:23], v9, s[52:55], 0 offen sc1
    v_dot2_f32_bf16 v32, v22, s12, v32
    v_dot2_f32_bf16 v33, v22, v22, v33
    v_dot2_f32_bf16 v32, v23, s12, v32
    v_dot2_f32_bf16 v33, v23, v23, v33
    v_cvt_pk_bf16_f32 v172, v200, v201
    v_lshlrev_b32 v200, 16, v172
    v_and_b32 v201, 0xffff0000, v172
    v_cvt_pk_bf16_f32 v173, v202, v203
    v_lshlrev_b32 v202, 16, v173
    v_and_b32 v203, 0xffff0000, v173
    v_add_f32 v224, v224, v200
    v_add_f32 v225, v225, v201
    v_add_f32 v226, v226, v202
    v_add_f32 v227, v227, v203
    v_cvt_pk_bf16_f32 v24, v224, v225
    v_cvt_pk_bf16_f32 v25, v226, v227
    buffer_store_dwordx2 v[24:25], v9, s[52:55], s8 offen sc1
    v_dot2_f32_bf16 v34, v24, s12, v34
    v_dot2_f32_bf16 v35, v24, v24, v35
    v_dot2_f32_bf16 v34, v25, s12, v34
    v_dot2_f32_bf16 v35, v25, v25, v35
L_kg_ker_s2_22:
    s_nop 3
    v_mov_b32 v172, v32
    s_nop 1
    v_permlane16_swap_b32 v32, v172
    v_add_f32 v32, v32, v172
    v_mov_b32 v172, v32
    s_nop 1
    v_permlane32_swap_b32 v32, v172
    v_add_f32 v32, v32, v172
    v_mov_b32 v173, v33
    s_nop 1
    v_permlane16_swap_b32 v33, v173
    v_add_f32 v33, v33, v173
    v_mov_b32 v173, v33
    s_nop 1
    v_permlane32_swap_b32 v33, v173
    v_add_f32 v33, v33, v173
    v_mov_b32 v174, v34
    s_nop 1
    v_permlane16_swap_b32 v34, v174
    v_add_f32 v34, v34, v174
    v_mov_b32 v174, v34
    s_nop 1
    v_permlane32_swap_b32 v34, v174
    v_add_f32 v34, v34, v174
    v_mov_b32 v175, v35
    s_nop 1
    v_permlane16_swap_b32 v35, v175
    v_add_f32 v35, v35, v175
    v_mov_b32 v175, v35
    s_nop 1
    v_permlane32_swap_b32 v35, v175
    v_add_f32 v35, v35, v175
    v_lshlrev_b32 v9, 4, v3
    v_add_u32 v9, 74752, v9
    s_lshl_b32 s7, s6, 8
    v_add_u32 v10, s7, v9
    s_mov_b64 exec, 0xffff
    ds_write_b128 v10, v[32:35]
    s_mov_b64 exec, -1
    s_waitcnt vmcnt(0) lgkmcnt(0)
    s_barrier
    s_cmp_lg_u32 s6, 0
    s_cbranch_scc1 L_kg_ker_fin_23
    ds_read_b128 v[44:47], v9 offset:0
    ds_read_b128 v[48:51], v9 offset:256
    ds_read_b128 v[52:55], v9 offset:512
    ds_read_b128 v[56:59], v9 offset:768
    s_waitcnt lgkmcnt(0)
    v_add_f32 v44, v44, v48
    v_add_f32 v52, v52, v56
    v_add_f32 v44, v44, v52
    v_add_f32 v45, v45, v49
    v_add_f32 v53, v53, v57
    v_add_f32 v45, v45, v53
    v_add_f32 v46, v46, v50
    v_add_f32 v54, v54, v58
    v_add_f32 v46, v46, v54
    v_add_f32 v47, v47, v51
    v_add_f32 v55, v55, v59
    v_add_f32 v47, v47, v55
    v_lshlrev_b32 v7, 5, v5
    s_lshl_b32 s7, s69, 3
    v_add_u32 v7, s7, v7
    s_mov_b64 exec, 0xffff
    buffer_store_dwordx2 v[44:45], v7, s[56:59], 0 offen offset:0 sc1
    buffer_store_dwordx2 v[46:47], v7, s[56:59], 0 offen offset:512 sc1
    s_mov_b64 exec, -1
    s_waitcnt vmcnt(0)
L_kg_ker_fin_23:
    s_cmp_lg_u32 s6, 0
    s_cbranch_scc1 L_kg_ker_sig_24
    s_lshl_b32 s7, s4, 8
    s_add_u32 s7, s7, 32768
    v_mov_b32 v9, s7
    v_mov_b32 v10, 1
    s_mov_b64 exec, 1
    global_atomic_add v9, v10, s[76:77]
    s_mov_b64 exec, -1
L_kg_ker_sig_24:
    s_lshl_b32 s7, s4, 6
    v_add_u32 v5, s7, v3
    v_lshlrev_b32 v5, 5, v5
    s_add_u32 s44, s42, 10887168
    s_addc_u32 s45, s43, 0
    s_mov_b32 s46, 10616832
    s_mov_b32 s47, 0x20000
    s_add_u32 s48, s42, 7110656
    s_addc_u32 s49, s43, 0
    s_mov_b32 s50, 2359296
    s_mov_b32 s51, 0x20000
    s_add_u32 s52, s42, 10866688
    s_addc_u32 s53, s43, 0
    s_mov_b32 s54, 18432
    s_mov_b32 s55, 0x20000
    s_add_u32 s56, s42, 21504000
    s_addc_u32 s57, s43, 0
    s_mov_b32 s58, 18874368
    s_mov_b32 s59, 0x20000
    s_add_u32 s60, s42, 9469952
    s_addc_u32 s61, s43, 0
    s_mov_b32 s62, 65536
    s_mov_b32 s63, 0x20000
    s_mul_i32 s7, s3, 36
    s_mul_i32 s8, s6, 9
    s_add_u32 s9, s7, s8
    s_mul_i32 s64, s9, 18432
    s_add_u32 s64, s64, 5308416
    s_mov_b32 s65, s5
    s_add_u32 s7, s7, s6
    s_mul_i32 s66, s7, 18432
    s_lshl_b32 s11, s7, 6
    s_mov_b32 s13, s5
    s_lshl_b32 s10, s3, 5
    s_add_u32 s10, s10, s4
    s_mul_i32 s10, s10, 36
    s_add_u32 s10, s10, s8
    s_lshl_b32 s10, s10, 11
    v_lshlrev_b32 v6, 4, v4
    v_lshrrev_b32 v7, 1, v4
    v_lshlrev_b32 v7, 8, v7
    v_lshl_add_u32 v7, v3, 4, v7
    v_and_b32 v10, 1, v4
    v_lshl_add_u32 v7, v10, 3, v7
    s_lshl_b32 s7, s6, 9
    s_add_u32 s7, s7, 73728
    v_add_u32 v7, s7, v7
L_dmain:
    v_add_u32 v11, 0x10000, v2
    v_add_u32 v10, 0x20000, v2
    s_add_u32 s67, s66, 0
    buffer_load_dwordx4 v[76:79], v2, s[44:47], s67 offen offset:0
    buffer_load_dwordx4 v[80:83], v2, s[44:47], s67 offen offset:1024
    buffer_load_dwordx4 v[84:87], v2, s[44:47], s67 offen offset:2048
    buffer_load_dwordx4 v[88:91], v2, s[44:47], s67 offen offset:3072
    s_add_u32 s67, s66, 4096
    buffer_load_dwordx4 v[92:95], v2, s[44:47], s67 offen offset:0
    buffer_load_dwordx4 v[96:99], v2, s[44:47], s67 offen offset:1024
    buffer_load_dwordx4 v[100:103], v2, s[44:47], s67 offen offset:2048
    buffer_load_dwordx4 v[104:107], v2, s[44:47], s67 offen offset:3072
    s_add_u32 s67, s66, 8192
    buffer_load_dwordx4 v[108:111], v2, s[44:47], s67 offen offset:0
    buffer_load_dwordx4 v[112:115], v2, s[44:47], s67 offen offset:1024
    buffer_load_dwordx4 v[116:119], v2, s[44:47], s67 offen offset:2048
    buffer_load_dwordx4 v[120:123], v2, s[44:47], s67 offen offset:3072
    s_add_u32 s67, s66, 12288
    buffer_load_dwordx4 v[124:127], v2, s[44:47], s67 offen offset:0
    buffer_load_dwordx4 v[128:131], v2, s[44:47], s67 offen offset:1024
    buffer_load_dwordx4 v[132:135], v2, s[44:47], s67 offen offset:2048
    buffer_load_dwordx4 v[136:139], v2, s[44:47], s67 offen offset:3072
    s_add_u32 s67, s66, 16384
    buffer_load_dwordx4 v[140:143], v2, s[44:47], s67 offen offset:0
    buffer_load_dwordx4 v[144:147], v2, s[44:47], s67 offen offset:1024
    s_cmp_lg_u32 s6, 0
    s_cbranch_scc1 L_kg_ker_xwait_25
    s_lshl_b32 s7, s4, 8
    s_add_u32 s7, s7, 32768
    v_mov_b32 v8, s7
    s_mov_b64 exec, 1
    s_mov_b32 s12, 0
L_kg_ker_xpoll_26:
    global_load_dword v9, v8, s[76:77] sc1
    s_waitcnt vmcnt(0)
    v_readfirstlane_b32 s7, v9
    s_add_u32 s12, s12, 1
    s_cmp_ge_u32 s7, 8
    s_cbranch_scc1 L_kg_ker_xok_27
    s_sleep 1
    s_cmp_lt_u32 s12, 0x20000
    s_cbranch_scc1 L_kg_ker_xpoll_26
L_kg_ker_xok_27:
    s_mov_b64 exec, -1
L_kg_ker_xwait_25:
    s_barrier
    buffer_load_dwordx4 v[44:47], v5, s[60:63], 0 offen offset:0 sc1
    buffer_load_dwordx4 v[48:51], v5, s[60:63], 0 offen offset:16 sc1
    buffer_load_dwordx4 v[52:55], v5, s[60:63], 0 offen offset:512 sc1
    buffer_load_dwordx4 v[56:59], v5, s[60:63], 0 offen offset:528 sc1
    buffer_load_dwordx4 v[60:63], v5, s[60:63], 0 offen offset:1024 sc1
    buffer_load_dwordx4 v[64:67], v5, s[60:63], 0 offen offset:1040 sc1
    buffer_load_dwordx4 v[68:71], v5, s[60:63], 0 offen offset:1536 sc1
    buffer_load_dwordx4 v[72:75], v5, s[60:63], 0 offen offset:1552 sc1
    s_mul_i32 s7, s4, 73728
    s_mul_i32 s12, s6, 18432
    s_add_u32 s7, s7, s12
    v_add_u32 v8, s12, v2
    s_add_u32 s8, s7, 0
    buffer_load_dwordx4 a[0:3], v2, s[48:51], s8 offen offset:0 sc1
    buffer_load_dwordx4 a[4:7], v2, s[48:51], s8 offen offset:1024 sc1
    buffer_load_dwordx4 a[8:11], v2, s[48:51], s8 offen offset:2048 sc1
    buffer_load_dwordx4 a[12:15], v2, s[48:51], s8 offen offset:3072 sc1
    s_add_u32 s8, s7, 4096
    buffer_load_dwordx4 a[16:19], v2, s[48:51], s8 offen offset:0 sc1
    buffer_load_dwordx4 a[20:23], v2, s[48:51], s8 offen offset:1024 sc1
    buffer_load_dwordx4 a[24:27], v2, s[48:51], s8 offen offset:2048 sc1
    buffer_load_dwordx4 a[28:31], v2, s[48:51], s8 offen offset:3072 sc1
    s_add_u32 s8, s7, 8192
    buffer_load_dwordx4 a[32:35], v2, s[48:51], s8 offen offset:0 sc1
    buffer_load_dwordx4 a[36:39], v2, s[48:51], s8 offen offset:1024 sc1
    buffer_load_dwordx4 a[40:43], v2, s[48:51], s8 offen offset:2048 sc1
    buffer_load_dwordx4 a[44:47], v2, s[48:51], s8 offen offset:3072 sc1
    s_add_u32 s8, s7, 12288
    buffer_load_dwordx4 a[48:51], v2, s[48:51], s8 offen offset:0 sc1
    buffer_load_dwordx4 a[52:55], v2, s[48:51], s8 offen offset:1024 sc1
    buffer_load_dwordx4 a[56:59], v2, s[48:51], s8 offen offset:2048 sc1
    buffer_load_dwordx4 a[60:63], v2, s[48:51], s8 offen offset:3072 sc1
    s_add_u32 s8, s7, 16384
    buffer_load_dwordx4 a[64:67], v2, s[48:51], s8 offen offset:0 sc1
    buffer_load_dwordx4 a[68:71], v2, s[48:51], s8 offen offset:1024 sc1
    s_waitcnt vmcnt(18)
    v_add_f32 v44, v44, v46
    v_add_f32 v45, v45, v47
    v_add_f32 v48, v48, v50
    v_add_f32 v49, v49, v51
    v_add_f32 v44, v44, v48
    v_add_f32 v45, v45, v49
    v_mul_f32 v46, 0x3ae38e39, v44
    v_mul_f32 v47, 0x3ae38e39, v45
    v_fma_f32 v47, -v46, v46, v47
    v_mov_b32 v240, v46
    v_cvt_pk_bf16_f32 v48, v240, v240
    v_lshlrev_b32 v240, 16, v48
    v_max_f32 v220, 0, v47
    v_cvt_pk_bf16_f32 v48, v220, v220
    v_lshlrev_b32 v220, 16, v48
    v_add_f32 v220, 0x3727c5ac, v220
    v_cvt_pk_bf16_f32 v48, v220, v220
    v_lshlrev_b32 v220, 16, v48
    v_sqrt_f32 v220, v220
    s_nop 0
    v_cvt_pk_bf16_f32 v48, v220, v220
    v_lshlrev_b32 v220, 16, v48
    v_rcp_f32 v220, v220
    s_nop 0
    v_mov_b32 v241, v220
    v_mul_f32 v232, 0xc0135761, v220
    v_mul_f32 v233, v220, v220
    v_mul_f32 v233, v233, v220
    v_mul_f32 v233, 0xbdd2d3e8, v233
    v_add_f32 v52, v52, v54
    v_add_f32 v53, v53, v55
    v_add_f32 v56, v56, v58
    v_add_f32 v57, v57, v59
    v_add_f32 v52, v52, v56
    v_add_f32 v53, v53, v57
    v_mul_f32 v54, 0x3ae38e39, v52
    v_mul_f32 v55, 0x3ae38e39, v53
    v_fma_f32 v55, -v54, v54, v55
    v_mov_b32 v242, v54
    v_cvt_pk_bf16_f32 v56, v242, v242
    v_lshlrev_b32 v242, 16, v56
    v_max_f32 v220, 0, v55
    v_cvt_pk_bf16_f32 v56, v220, v220
    v_lshlrev_b32 v220, 16, v56
    v_add_f32 v220, 0x3727c5ac, v220
    v_cvt_pk_bf16_f32 v56, v220, v220
    v_lshlrev_b32 v220, 16, v56
    v_sqrt_f32 v220, v220
    s_nop 0
    v_cvt_pk_bf16_f32 v56, v220, v220
    v_lshlrev_b32 v220, 16, v56
    v_rcp_f32 v220, v220
    s_nop 0
    v_mov_b32 v243, v220
    v_mul_f32 v234, 0xc0135761, v220
    v_mul_f32 v235, v220, v220
    v_mul_f32 v235, v235, v220
    v_mul_f32 v235, 0xbdd2d3e8, v235
    v_add_f32 v60, v60, v62
    v_add_f32 v61, v61, v63
    v_add_f32 v64, v64, v66
    v_add_f32 v65, v65, v67
    v_add_f32 v60, v60, v64
    v_add_f32 v61, v61, v65
    v_mul_f32 v62, 0x3ae38e39, v60
    v_mul_f32 v63, 0x3ae38e39, v61
    v_fma_f32 v63, -v62, v62, v63
    v_mov_b32 v244, v62
    v_cvt_pk_bf16_f32 v64, v244, v244
    v_lshlrev_b32 v244, 16, v64
    v_max_f32 v220, 0, v63
    v_cvt_pk_bf16_f32 v64, v220, v220
    v_lshlrev_b32 v220, 16, v64
    v_add_f32 v220, 0x3727c5ac, v220
    v_cvt_pk_bf16_f32 v64, v220, v220
    v_lshlrev_b32 v220, 16, v64
    v_sqrt_f32 v220, v220
    s_nop 0
    v_cvt_pk_bf16_f32 v64, v220, v220
    v_lshlrev_b32 v220, 16, v64
    v_rcp_f32 v220, v220
    s_nop 0
    v_mov_b32 v245, v220
    v_mul_f32 v236, 0xc0135761, v220
    v_mul_f32 v237, v220, v220
    v_mul_f32 v237, v237, v220
    v_mul_f32 v237, 0xbdd2d3e8, v237
    v_add_f32 v68, v68, v70
    v_add_f32 v69, v69, v71
    v_add_f32 v72, v72, v74
    v_add_f32 v73, v73, v75
    v_add_f32 v68, v68, v72
    v_add_f32 v69, v69, v73
    v_mul_f32 v70, 0x3ae38e39, v68
    v_mul_f32 v71, 0x3ae38e39, v69
    v_fma_f32 v71, -v70, v70, v71
    v_mov_b32 v246, v70
    v_cvt_pk_bf16_f32 v72, v246, v246
    v_lshlrev_b32 v246, 16, v72
    v_max_f32 v220, 0, v71
    v_cvt_pk_bf16_f32 v72, v220, v220
    v_lshlrev_b32 v220, 16, v72
    v_add_f32 v220, 0x3727c5ac, v220
    v_cvt_pk_bf16_f32 v72, v220, v220
    v_lshlrev_b32 v220, 16, v72
    v_sqrt_f32 v220, v220
    s_nop 0
    v_cvt_pk_bf16_f32 v72, v220, v220
    v_lshlrev_b32 v220, 16, v72
    v_rcp_f32 v220, v220
    s_nop 0
    v_mov_b32 v247, v220
    v_mul_f32 v238, 0xc0135761, v220
    v_mul_f32 v239, v220, v220
    v_mul_f32 v239, v239, v220
    v_mul_f32 v239, 0xbdd2d3e8, v239
    s_waitcnt vmcnt(17)
    ds_write_b128 v8, a[0:3] offset:0
    s_waitcnt vmcnt(16)
    ds_write_b128 v8, a[4:7] offset:1024
    s_waitcnt vmcnt(15)
    ds_write_b128 v8, a[8:11] offset:2048
    s_waitcnt vmcnt(14)
    ds_write_b128 v8, a[12:15] offset:3072
    s_waitcnt vmcnt(13)
    ds_write_b128 v8, a[16:19] offset:4096
    s_waitcnt vmcnt(12)
    ds_write_b128 v8, a[20:23] offset:5120
    s_waitcnt vmcnt(11)
    ds_write_b128 v8, a[24:27] offset:6144
    s_waitcnt vmcnt(10)
    ds_write_b128 v8, a[28:31] offset:7168
    s_waitcnt vmcnt(9)
    ds_write_b128 v8, a[32:35] offset:8192
    s_waitcnt vmcnt(8)
    ds_write_b128 v8, a[36:39] offset:9216
    s_waitcnt vmcnt(7)
    ds_write_b128 v8, a[40:43] offset:10240
    s_waitcnt vmcnt(6)
    ds_write_b128 v8, a[44:47] offset:11264
    s_waitcnt vmcnt(5)
    ds_write_b128 v8, a[48:51] offset:12288
    s_waitcnt vmcnt(4)
    ds_write_b128 v8, a[52:55] offset:13312
    s_waitcnt vmcnt(3)
    ds_write_b128 v8, a[56:59] offset:14336
    s_waitcnt vmcnt(2)
    ds_write_b128 v8, a[60:63] offset:15360
    s_waitcnt vmcnt(1)
    ds_write_b128 v8, a[64:67] offset:16384
    s_waitcnt vmcnt(0)
    ds_write_b128 v8, a[68:71] offset:17408
    s_waitcnt lgkmcnt(0)
    s_barrier
    ds_read_b128 a[0:3], v2 offset:0
    ds_read_b128 a[4:7], v2 offset:18432
    ds_read_b128 a[8:11], v2 offset:36864
    ds_read_b128 a[12:15], v2 offset:55296
    ds_read_b128 a[16:19], v2 offset:1024
    ds_read_b128 a[20:23], v2 offset:19456
    ds_read_b128 a[24:27], v2 offset:37888
    ds_read_b128 a[28:31], v2 offset:56320
    ds_read_b128 a[32:35], v2 offset:2048
    ds_read_b128 a[36:39], v2 offset:20480
    ds_read_b128 a[40:43], v2 offset:38912
    ds_read_b128 a[44:47], v2 offset:57344
    buffer_load_dwordx4 v[248:251], v6, s[52:55], s11 offen
    s_add_u32 s11, s11, 256
    v_mov_b32 v8, v7
    v_add_u32 v7, 2048, v7
    ds_read_b128 a[48:51], v2 offset:3072
    s_waitcnt lgkmcnt(12)
    v_mfma_f32_16x16x32_bf16 v[12:15], v[76:79], a[0:3], 0
    s_add_u32 s66, s66, 73728
    s_add_u32 s67, s66, 0
    buffer_load_dwordx4 v[148:151], v2, s[44:47], s67 offen offset:0
    ds_read_b128 a[52:55], v2 offset:21504
    s_waitcnt lgkmcnt(12)
    v_mfma_f32_16x16x32_bf16 v[16:19], v[76:79], a[4:7], 0
    buffer_load_dwordx4 v[152:155], v2, s[44:47], s67 offen offset:1024
    ds_read_b128 a[56:59], v2 offset:39936
    s_waitcnt lgkmcnt(12)
    v_mfma_f32_16x16x32_bf16 v[20:23], v[76:79], a[8:11], 0
    buffer_load_dwordx4 v[156:159], v2, s[44:47], s67 offen offset:2048
    ds_read_b128 a[60:63], v2 offset:58368
    s_waitcnt lgkmcnt(12)
    v_mfma_f32_16x16x32_bf16 v[24:27], v[76:79], a[12:15], 0
    ds_read_b128 a[64:67], v2 offset:4096
    s_waitcnt lgkmcnt(12)
    v_mfma_f32_16x16x32_bf16 v[12:15], v[80:83], a[16:19], v[12:15]
    buffer_load_dwordx4 v[160:163], v2, s[44:47], s67 offen offset:3072
    ds_read_b128 a[68:71], v2 offset:22528
    s_waitcnt lgkmcnt(12)
    v_mfma_f32_16x16x32_bf16 v[16:19], v[80:83], a[20:23], v[16:19]
    s_add_u32 s67, s66, 4096
    buffer_load_dwordx4 v[164:167], v2, s[44:47], s67 offen offset:0
    ds_read_b128 a[72:75], v2 offset:40960
    s_waitcnt lgkmcnt(12)
    v_mfma_f32_16x16x32_bf16 v[20:23], v[80:83], a[24:27], v[20:23]
    buffer_load_dwordx4 v[168:171], v2, s[44:47], s67 offen offset:1024
    ds_read_b128 a[76:79], v2 offset:59392
    s_waitcnt lgkmcnt(12)
    v_mfma_f32_16x16x32_bf16 v[24:27], v[80:83], a[28:31], v[24:27]
    ds_read_b128 a[80:83], v2 offset:5120
    s_waitcnt lgkmcnt(12)
    v_mfma_f32_16x16x32_bf16 v[12:15], v[84:87], a[32:35], v[12:15]
    buffer_load_dwordx4 v[172:175], v2, s[44:47], s67 offen offset:2048
    ds_read_b128 a[84:87], v2 offset:23552
    s_waitcnt lgkmcnt(12)
    v_mfma_f32_16x16x32_bf16 v[16:19], v[84:87], a[36:39], v[16:19]
    buffer_load_dwordx4 v[176:179], v2, s[44:47], s67 offen offset:3072
    ds_read_b128 a[88:91], v2 offset:41984
    s_waitcnt lgkmcnt(12)
    v_mfma_f32_16x16x32_bf16 v[20:23], v[84:87], a[40:43], v[20:23]
    s_add_u32 s67, s66, 8192
    buffer_load_dwordx4 v[180:183], v2, s[44:47], s67 offen offset:0
    ds_read_b128 a[92:95], v2 offset:60416
    s_waitcnt lgkmcnt(12)
    v_mfma_f32_16x16x32_bf16 v[24:27], v[84:87], a[44:47], v[24:27]
    ds_read_b128 a[96:99], v2 offset:6144
    s_waitcnt lgkmcnt(12)
    v_mfma_f32_16x16x32_bf16 v[12:15], v[88:91], a[48:51], v[12:15]
    buffer_load_dwordx4 v[184:187], v2, s[44:47], s67 offen offset:1024
    ds_read_b128 a[100:103], v2 offset:24576
    s_waitcnt lgkmcnt(12)
    v_mfma_f32_16x16x32_bf16 v[16:19], v[88:91], a[52:55], v[16:19]
    buffer_load_dwordx4 v[188:191], v2, s[44:47], s67 offen offset:2048
    ds_read_b128 a[104:107], v2 offset:43008
    s_waitcnt lgkmcnt(12)
    v_mfma_f32_16x16x32_bf16 v[20:23], v[88:91], a[56:59], v[20:23]
    buffer_load_dwordx4 v[192:195], v2, s[44:47], s67 offen offset:3072
    ds_read_b128 a[108:111], v2 offset:61440
    s_waitcnt lgkmcnt(12)
    v_mfma_f32_16x16x32_bf16 v[24:27], v[88:91], a[60:63], v[24:27]
    ds_read_b128 a[112:115], v2 offset:7168
    s_waitcnt lgkmcnt(12)
    v_mfma_f32_16x16x32_bf16 v[12:15], v[92:95], a[64:67], v[12:15]
    s_add_u32 s67, s66, 12288
    buffer_load_dwordx4 v[196:199], v2, s[44:47], s67 offen offset:0
    ds_read_b128 a[116:119], v2 offset:25600
    s_waitcnt lgkmcnt(12)
    v_mfma_f32_16x16x32_bf16 v[16:19], v[92:95], a[68:71], v[16:19]
    buffer_load_dwordx4 v[200:203], v2, s[44:47], s67 offen offset:1024
    ds_read_b128 a[120:123], v2 offset:44032
    s_waitcnt lgkmcnt(12)
    v_mfma_f32_16x16x32_bf16 v[20:23], v[92:95], a[72:75], v[20:23]
    buffer_load_dwordx4 v[204:207], v2, s[44:47], s67 offen offset:2048
    ds_read_b128 a[124:127], v2 offset:62464
    s_waitcnt lgkmcnt(12)
    v_mfma_f32_16x16x32_bf16 v[24:27], v[92:95], a[76:79], v[24:27]
    ds_read_b128 a[128:131], v2 offset:8192
    s_waitcnt lgkmcnt(12)
    v_mfma_f32_16x16x32_bf16 v[12:15], v[96:99], a[80:83], v[12:15]
    buffer_load_dwordx4 v[208:211], v2, s[44:47], s67 offen offset:3072
    ds_read_b128 a[132:135], v2 offset:26624
    s_waitcnt lgkmcnt(12)
    v_mfma_f32_16x16x32_bf16 v[16:19], v[96:99], a[84:87], v[16:19]
    s_add_u32 s67, s66, 16384
    buffer_load_dwordx4 v[212:215], v2, s[44:47], s67 offen offset:0
    ds_read_b128 a[136:139], v2 offset:45056
    s_waitcnt lgkmcnt(12)
    v_mfma_f32_16x16x32_bf16 v[20:23], v[96:99], a[88:91], v[20:23]
    buffer_load_dwordx4 v[216:219], v2, s[44:47], s67 offen offset:1024
    ds_read_b128 a[140:143], v2 offset:63488
    s_waitcnt lgkmcnt(12)
    v_mfma_f32_16x16x32_bf16 v[24:27], v[96:99], a[92:95], v[24:27]
    ds_read_b128 a[144:147], v2 offset:9216
    s_waitcnt lgkmcnt(12)
    v_mfma_f32_16x16x32_bf16 v[12:15], v[100:103], a[96:99], v[12:15]
    s_add_u32 s66, s66, 73728
    s_add_u32 s67, s66, 0
    buffer_load_dwordx4 v[76:79], v2, s[44:47], s67 offen offset:0
    ds_read_b128 a[148:151], v2 offset:27648
    s_waitcnt lgkmcnt(12)
    v_mfma_f32_16x16x32_bf16 v[16:19], v[100:103], a[100:103], v[16:19]
    buffer_load_dwordx4 v[80:83], v2, s[44:47], s67 offen offset:1024
    ds_read_b128 a[152:155], v2 offset:46080
    s_waitcnt lgkmcnt(12)
    v_mfma_f32_16x16x32_bf16 v[20:23], v[100:103], a[104:107], v[20:23]
    buffer_load_dwordx4 v[84:87], v2, s[44:47], s67 offen offset:2048
    ds_read_b128 a[156:159], v2 offset:64512
    s_waitcnt lgkmcnt(12)
    v_mfma_f32_16x16x32_bf16 v[24:27], v[100:103], a[108:111], v[24:27]
    ds_read_b128 a[160:163], v2 offset:10240
    s_waitcnt lgkmcnt(12)
    v_mfma_f32_16x16x32_bf16 v[12:15], v[104:107], a[112:115], v[12:15]
    buffer_load_dwordx4 v[88:91], v2, s[44:47], s67 offen offset:3072
    ds_read_b128 a[164:167], v2 offset:28672
    s_waitcnt lgkmcnt(12)
    v_mfma_f32_16x16x32_bf16 v[16:19], v[104:107], a[116:119], v[16:19]
    s_add_u32 s67, s66, 4096
    buffer_load_dwordx4 v[92:95], v2, s[44:47], s67 offen offset:0
    ds_read_b128 a[168:171], v2 offset:47104
    s_waitcnt lgkmcnt(12)
    v_mfma_f32_16x16x32_bf16 v[20:23], v[104:107], a[120:123], v[20:23]
    buffer_load_dwordx4 v[96:99], v2, s[44:47], s67 offen offset:1024
    ds_read_b128 a[172:175], v11 offset:0
    s_waitcnt lgkmcnt(12)
    v_mfma_f32_16x16x32_bf16 v[24:27], v[104:107], a[124:127], v[24:27]
    ds_read_b128 a[176:179], v2 offset:11264
    s_waitcnt lgkmcnt(12)
    v_mfma_f32_16x16x32_bf16 v[12:15], v[108:111], a[128:131], v[12:15]
    buffer_load_dwordx4 v[100:103], v2, s[44:47], s67 offen offset:2048
    ds_read_b128 a[180:183], v2 offset:29696
    s_waitcnt lgkmcnt(12)
    v_mfma_f32_16x16x32_bf16 v[16:19], v[108:111], a[132:135], v[16:19]
    buffer_load_dwordx4 v[104:107], v2, s[44:47], s67 offen offset:3072
    ds_read_b128 a[184:187], v2 offset:48128
    s_waitcnt lgkmcnt(12)
    v_mfma_f32_16x16x32_bf16 v[20:23], v[108:111], a[136:139], v[20:23]
    ds_read_b128 a[188:191], v11 offset:1024
    s_waitcnt lgkmcnt(12)
    v_mfma_f32_16x16x32_bf16 v[24:27], v[108:111], a[140:143], v[24:27]
    ds_read_b128 a[192:195], v2 offset:12288
    s_waitcnt lgkmcnt(12)
    v_mfma_f32_16x16x32_bf16 v[12:15], v[112:115], a[144:147], v[12:15]
    s_add_u32 s67, s66, 8192
    buffer_load_dwordx4 v[108:111], v2, s[44:47], s67 offen offset:0
    ds_read_b128 a[196:199], v2 offset:30720
    s_waitcnt lgkmcnt(12)
    v_mfma_f32_16x16x32_bf16 v[16:19], v[112:115], a[148:151], v[16:19]
    ds_read_b128 a[200:203], v2 offset:49152
    s_waitcnt lgkmcnt(12)
    v_mfma_f32_16x16x32_bf16 v[20:23], v[112:115], a[152:155], v[20:23]
    ds_read_b128 a[204:207], v11 offset:2048
    s_waitcnt lgkmcnt(12)
    v_mfma_f32_16x16x32_bf16 v[24:27], v[112:115], a[156:159], v[24:27]
    ds_read_b128 a[208:211], v2 offset:13312
    s_waitcnt lgkmcnt(12)
    v_mfma_f32_16x16x32_bf16 v[12:15], v[116:119], a[160:163], v[12:15]
    buffer_load_dwordx4 v[112:115], v2, s[44:47], s67 offen offset:1024
    ds_read_b128 a[212:215], v2 offset:31744
    s_waitcnt lgkmcnt(12)
    v_mfma_f32_16x16x32_bf16 v[16:19], v[116:119], a[164:167], v[16:19]
    ds_read_b128 a[216:219], v2 offset:50176
    s_waitcnt lgkmcnt(12)
    v_mfma_f32_16x16x32_bf16 v[20:23], v[116:119], a[168:171], v[20:23]
    ds_read_b128 a[220:223], v11 offset:3072
    s_waitcnt lgkmcnt(12)
    v_mfma_f32_16x16x32_bf16 v[24:27], v[116:119], a[172:175], v[24:27]
    ds_read_b128 a[224:227], v2 offset:14336
    s_waitcnt lgkmcnt(12)
    v_mfma_f32_16x16x32_bf16 v[12:15], v[120:123], a[176:179], v[12:15]
    buffer_load_dwordx4 v[116:119], v2, s[44:47], s67 offen offset:2048
    ds_read_b128 a[228:231], v2 offset:32768
    s_waitcnt lgkmcnt(12)
    v_mfma_f32_16x16x32_bf16 v[16:19], v[120:123], a[180:183], v[16:19]
    ds_read_b128 a[232:235], v2 offset:51200
    s_waitcnt lgkmcnt(12)
    v_mfma_f32_16x16x32_bf16 v[20:23], v[120:123], a[184:187], v[20:23]
    ds_read_b128 a[236:239], v11 offset:4096
    s_waitcnt lgkmcnt(12)
    v_mfma_f32_16x16x32_bf16 v[24:27], v[120:123], a[188:191], v[24:27]
    ds_read_b128 a[240:243], v2 offset:15360
    s_waitcnt lgkmcnt(12)
    v_mfma_f32_16x16x32_bf16 v[12:15], v[124:127], a[192:195], v[12:15]
    buffer_load_dwordx4 v[120:123], v2, s[44:47], s67 offen offset:3072
    ds_read_b128 a[244:247], v2 offset:33792
    s_waitcnt lgkmcnt(12)
    v_mfma_f32_16x16x32_bf16 v[16:19], v[124:127], a[196:199], v[16:19]
    ds_read_b128 a[248:251], v2 offset:52224
    s_waitcnt lgkmcnt(12)
    v_mfma_f32_16x16x32_bf16 v[20:23], v[124:127], a[200:203], v[20:23]
    ds_read_b128 a[252:255], v11 offset:5120
    s_waitcnt lgkmcnt(12)
    v_mfma_f32_16x16x32_bf16 v[24:27], v[124:127], a[204:207], v[24:27]
    ds_read_b128 v[44:47], v2 offset:16384
    s_waitcnt lgkmcnt(12)
    v_mfma_f32_16x16x32_bf16 v[12:15], v[128:131], a[208:211], v[12:15]
    s_add_u32 s67, s66, 12288
    buffer_load_dwordx4 v[124:127], v2, s[44:47], s67 offen offset:0
    ds_read_b128 v[48:51], v2 offset:34816
    s_waitcnt lgkmcnt(12)
    v_mfma_f32_16x16x32_bf16 v[16:19], v[128:131], a[212:215], v[16:19]
    ds_read_b128 v[52:55], v2 offset:53248
    s_waitcnt lgkmcnt(12)
    v_mfma_f32_16x16x32_bf16 v[20:23], v[128:131], a[216:219], v[20:23]
    ds_read_b128 v[56:59], v11 offset:6144
    s_waitcnt lgkmcnt(12)
    v_mfma_f32_16x16x32_bf16 v[24:27], v[128:131], a[220:223], v[24:27]
    ds_read_b128 v[60:63], v2 offset:17408
    s_waitcnt lgkmcnt(12)
    v_mfma_f32_16x16x32_bf16 v[12:15], v[132:135], a[224:227], v[12:15]
    buffer_load_dwordx4 v[128:131], v2, s[44:47], s67 offen offset:1024
    ds_read_b128 v[64:67], v2 offset:35840
    s_waitcnt lgkmcnt(12)
    v_mfma_f32_16x16x32_bf16 v[16:19], v[132:135], a[228:231], v[16:19]
    ds_read_b128 v[68:71], v2 offset:54272
    s_waitcnt lgkmcnt(12)
    v_mfma_f32_16x16x32_bf16 v[20:23], v[132:135], a[232:235], v[20:23]
    ds_read_b128 v[72:75], v11 offset:7168
    s_waitcnt lgkmcnt(12)
    v_mfma_f32_16x16x32_bf16 v[24:27], v[132:135], a[236:239], v[24:27]
    s_waitcnt lgkmcnt(11)
    v_mfma_f32_16x16x32_bf16 v[12:15], v[136:139], a[240:243], v[12:15]
    buffer_load_dwordx4 v[132:135], v2, s[44:47], s67 offen offset:2048
    s_waitcnt lgkmcnt(10)
    v_mfma_f32_16x16x32_bf16 v[16:19], v[136:139], a[244:247], v[16:19]
    s_waitcnt lgkmcnt(9)
    v_mfma_f32_16x16x32_bf16 v[20:23], v[136:139], a[248:251], v[20:23]
    s_waitcnt lgkmcnt(8)
    v_mfma_f32_16x16x32_bf16 v[24:27], v[136:139], a[252:255], v[24:27]
    s_waitcnt lgkmcnt(7)
    v_mfma_f32_16x16x32_bf16 v[12:15], v[140:143], v[44:47], v[12:15]
    buffer_load_dwordx4 v[136:139], v2, s[44:47], s67 offen offset:3072
    s_waitcnt lgkmcnt(6)
    v_mfma_f32_16x16x32_bf16 v[16:19], v[140:143], v[48:51], v[16:19]
    s_waitcnt lgkmcnt(5)
    v_mfma_f32_16x16x32_bf16 v[20:23], v[140:143], v[52:55], v[20:23]
    s_waitcnt lgkmcnt(4)
    v_mfma_f32_16x16x32_bf16 v[24:27], v[140:143], v[56:59], v[24:27]
    s_waitcnt lgkmcnt(3)
    v_mfma_f32_16x16x32_bf16 v[12:15], v[144:147], v[60:63], v[12:15]
    s_add_u32 s67, s66, 16384
    buffer_load_dwordx4 v[140:143], v2, s[44:47], s67 offen offset:0
    s_waitcnt lgkmcnt(2)
    v_mfma_f32_16x16x32_bf16 v[16:19], v[144:147], v[64:67], v[16:19]
    s_waitcnt lgkmcnt(1)
    v_mfma_f32_16x16x32_bf16 v[20:23], v[144:147], v[68:71], v[20:23]
    s_waitcnt lgkmcnt(0)
    v_mfma_f32_16x16x32_bf16 v[24:27], v[144:147], v[72:75], v[24:27]
    s_waitcnt vmcnt(35)
    s_mov_b32 s9, 0
L_kg_ker_lp_28:
    buffer_load_dwordx4 v[252:255], v6, s[52:55], s11 offen
    s_add_u32 s11, s11, 256
    v_mov_b32 v9, v7
    v_add_u32 v7, 2048, v7
    s_waitcnt vmcnt(35)
    v_mfma_f32_16x16x32_bf16 v[28:31], v[148:151], a[0:3], 0
    buffer_load_dwordx4 v[144:147], v2, s[44:47], s67 offen offset:1024
    v_mfma_f32_16x16x32_bf16 v[32:35], v[148:151], a[4:7], 0
    v_mfma_f32_16x16x32_bf16 v[36:39], v[148:151], a[8:11], 0
    v_mfma_f32_16x16x32_bf16 v[40:43], v[148:151], a[12:15], 0
    s_waitcnt vmcnt(35)
    v_mfma_f32_16x16x32_bf16 v[28:31], v[152:155], a[16:19], v[28:31]
    s_add_u32 s66, s66, 73728
    s_add_u32 s67, s66, 0
    buffer_load_dwordx4 v[148:151], v2, s[44:47], s67 offen offset:0
    v_fma_f32 v12, -v240, v248, v12
    v_fma_f32 v13, -v240, v249, v13
    v_fma_f32 v14, -v240, v250, v14
    v_mfma_f32_16x16x32_bf16 v[32:35], v[152:155], a[20:23], v[32:35]
    v_fma_f32 v15, -v240, v251, v15
    v_mul_f32 v220, v12, v12
    v_mfma_f32_16x16x32_bf16 v[36:39], v[152:155], a[24:27], v[36:39]
    v_mul_f32 v221, v13, v13
    v_mul_f32 v222, v14, v14
    v_mul_f32 v223, v15, v15
    v_mfma_f32_16x16x32_bf16 v[40:43], v[152:155], a[28:31], v[40:43]
    v_fma_f32 v220, v220, v233, v232
    v_fma_f32 v221, v221, v233, v232
    s_waitcnt vmcnt(35)
    v_mfma_f32_16x16x32_bf16 v[28:31], v[156:159], a[32:35], v[28:31]
    buffer_load_dwordx4 v[152:155], v2, s[44:47], s67 offen offset:1024
    v_fma_f32 v222, v222, v233, v232
    v_fma_f32 v223, v223, v233, v232
    v_mul_f32 v220, v12, v220
    v_mfma_f32_16x16x32_bf16 v[32:35], v[156:159], a[36:39], v[32:35]
    v_mul_f32 v221, v13, v221
    v_mul_f32 v222, v14, v222
    v_mfma_f32_16x16x32_bf16 v[36:39], v[156:159], a[40:43], v[36:39]
    v_mul_f32 v223, v15, v223
    v_exp_f32 v220, v220
    v_mfma_f32_16x16x32_bf16 v[40:43], v[156:159], a[44:47], v[40:43]
    v_exp_f32 v221, v221
    s_waitcnt vmcnt(35)
    v_mfma_f32_16x16x32_bf16 v[28:31], v[160:163], a[48:51], v[28:31]
    buffer_load_dwordx4 v[156:159], v2, s[44:47], s67 offen offset:2048
    v_exp_f32 v222, v222
    v_mfma_f32_16x16x32_bf16 v[32:35], v[160:163], a[52:55], v[32:35]
    v_exp_f32 v223, v223
    v_add_f32 v220, 1.0, v220
    v_mfma_f32_16x16x32_bf16 v[36:39], v[160:163], a[56:59], v[36:39]
    v_add_f32 v221, 1.0, v221
    v_add_f32 v222, 1.0, v222
    v_add_f32 v223, 1.0, v223
    v_mfma_f32_16x16x32_bf16 v[40:43], v[160:163], a[60:63], v[40:43]
    v_rcp_f32 v220, v220
    s_waitcnt vmcnt(35)
    v_mfma_f32_16x16x32_bf16 v[28:31], v[164:167], a[64:67], v[28:31]
    buffer_load_dwordx4 v[160:163], v2, s[44:47], s67 offen offset:3072
    v_rcp_f32 v221, v221
    v_mfma_f32_16x16x32_bf16 v[32:35], v[164:167], a[68:71], v[32:35]
    v_rcp_f32 v222, v222
    v_rcp_f32 v223, v223
    v_mfma_f32_16x16x32_bf16 v[36:39], v[164:167], a[72:75], v[36:39]
    v_mul_f32 v220, v12, v220
    v_mul_f32 v221, v13, v221
    v_mfma_f32_16x16x32_bf16 v[40:43], v[164:167], a[76:79], v[40:43]
    v_mul_f32 v222, v14, v222
    v_mul_f32 v223, v15, v223
    s_waitcnt vmcnt(35)
    v_mfma_f32_16x16x32_bf16 v[28:31], v[168:171], a[80:83], v[28:31]
    s_add_u32 s67, s66, 4096
    buffer_load_dwordx4 v[164:167], v2, s[44:47], s67 offen offset:0
    v_cvt_pk_bf16_f32 v228, v220, v221
    v_cvt_pk_bf16_f32 v229, v222, v223
    ds_write_b64 v8, v[228:229] offset:0
    v_mfma_f32_16x16x32_bf16 v[32:35], v[168:171], a[84:87], v[32:35]
    v_fma_f32 v16, -v242, v248, v16
    v_fma_f32 v17, -v242, v249, v17
    v_fma_f32 v18, -v242, v250, v18
    v_mfma_f32_16x16x32_bf16 v[36:39], v[168:171], a[88:91], v[36:39]
    v_fma_f32 v19, -v242, v251, v19
    v_mul_f32 v224, v16, v16
    v_mfma_f32_16x16x32_bf16 v[40:43], v[168:171], a[92:95], v[40:43]
    v_mul_f32 v225, v17, v17
    v_mul_f32 v226, v18, v18
    v_mul_f32 v227, v19, v19
    s_waitcnt vmcnt(35)
    v_mfma_f32_16x16x32_bf16 v[28:31], v[172:175], a[96:99], v[28:31]
    buffer_load_dwordx4 v[168:171], v2, s[44:47], s67 offen offset:1024
    v_fma_f32 v224, v224, v235, v234
    v_fma_f32 v225, v225, v235, v234
    v_mfma_f32_16x16x32_bf16 v[32:35], v[172:175], a[100:103], v[32:35]
    v_fma_f32 v226, v226, v235, v234
    v_fma_f32 v227, v227, v235, v234
    v_mul_f32 v224, v16, v224
    v_mfma_f32_16x16x32_bf16 v[36:39], v[172:175], a[104:107], v[36:39]
    v_mul_f32 v225, v17, v225
    v_mul_f32 v226, v18, v226
    v_mfma_f32_16x16x32_bf16 v[40:43], v[172:175], a[108:111], v[40:43]
    v_mul_f32 v227, v19, v227
    v_exp_f32 v224, v224
    s_waitcnt vmcnt(35)
    v_mfma_f32_16x16x32_bf16 v[28:31], v[176:179], a[112:115], v[28:31]
    buffer_load_dwordx4 v[172:175], v2, s[44:47], s67 offen offset:2048
    v_exp_f32 v225, v225
    v_mfma_f32_16x16x32_bf16 v[32:35], v[176:179], a[116:119], v[32:35]
    v_exp_f32 v226, v226
    v_mfma_f32_16x16x32_bf16 v[36:39], v[176:179], a[120:123], v[36:39]
    v_exp_f32 v227, v227
    v_add_f32 v224, 1.0, v224
    v_mfma_f32_16x16x32_bf16 v[40:43], v[176:179], a[124:127], v[40:43]
    v_add_f32 v225, 1.0, v225
    v_add_f32 v226, 1.0, v226
    v_add_f32 v227, 1.0, v227
    s_waitcnt vmcnt(35)
    v_mfma_f32_16x16x32_bf16 v[28:31], v[180:183], a[128:131], v[28:31]
    buffer_load_dwordx4 v[176:179], v2, s[44:47], s67 offen offset:3072
    v_rcp_f32 v224, v224
    v_mfma_f32_16x16x32_bf16 v[32:35], v[180:183], a[132:135], v[32:35]
    v_rcp_f32 v225, v225
    v_mfma_f32_16x16x32_bf16 v[36:39], v[180:183], a[136:139], v[36:39]
    v_rcp_f32 v226, v226
    v_rcp_f32 v227, v227
    v_mfma_f32_16x16x32_bf16 v[40:43], v[180:183], a[140:143], v[40:43]
    v_mul_f32 v224, v16, v224
    v_mul_f32 v225, v17, v225
    s_waitcnt vmcnt(35)
    v_mfma_f32_16x16x32_bf16 v[28:31], v[184:187], a[144:147], v[28:31]
    s_add_u32 s67, s66, 8192
    buffer_load_dwordx4 v[180:183], v2, s[44:47], s67 offen offset:0
    v_mul_f32 v226, v18, v226
    v_mul_f32 v227, v19, v227
    v_mfma_f32_16x16x32_bf16 v[32:35], v[184:187], a[148:151], v[32:35]
    v_cvt_pk_bf16_f32 v230, v224, v225
    v_cvt_pk_bf16_f32 v231, v226, v227
    ds_write_b64 v8, v[230:231] offset:18432
    v_mfma_f32_16x16x32_bf16 v[36:39], v[184:187], a[152:155], v[36:39]
    v_fma_f32 v20, -v244, v248, v20
    v_fma_f32 v21, -v244, v249, v21
    v_fma_f32 v22, -v244, v250, v22
    v_mfma_f32_16x16x32_bf16 v[40:43], v[184:187], a[156:159], v[40:43]
    v_fma_f32 v23, -v244, v251, v23
    v_mul_f32 v220, v20, v20
    s_waitcnt vmcnt(35)
    v_mfma_f32_16x16x32_bf16 v[28:31], v[188:191], a[160:163], v[28:31]
    buffer_load_dwordx4 v[184:187], v2, s[44:47], s67 offen offset:1024
    v_mul_f32 v221, v21, v21
    v_mul_f32 v222, v22, v22
    v_mul_f32 v223, v23, v23
    v_mfma_f32_16x16x32_bf16 v[32:35], v[188:191], a[164:167], v[32:35]
    v_fma_f32 v220, v220, v237, v236
    v_fma_f32 v221, v221, v237, v236
    v_mfma_f32_16x16x32_bf16 v[36:39], v[188:191], a[168:171], v[36:39]
    v_fma_f32 v222, v222, v237, v236
    v_fma_f32 v223, v223, v237, v236
    v_mul_f32 v220, v20, v220
    v_mfma_f32_16x16x32_bf16 v[40:43], v[188:191], a[172:175], v[40:43]
    v_mul_f32 v221, v21, v221
    v_mul_f32 v222, v22, v222
    s_waitcnt vmcnt(35)
    v_mfma_f32_16x16x32_bf16 v[28:31], v[192:195], a[176:179], v[28:31]
    buffer_load_dwordx4 v[188:191], v2, s[44:47], s67 offen offset:2048
    v_mul_f32 v223, v23, v223
    v_exp_f32 v220, v220
    v_mfma_f32_16x16x32_bf16 v[32:35], v[192:195], a[180:183], v[32:35]
    v_exp_f32 v221, v221
    v_mfma_f32_16x16x32_bf16 v[36:39], v[192:195], a[184:187], v[36:39]
    v_exp_f32 v222, v222
    v_mfma_f32_16x16x32_bf16 v[40:43], v[192:195], a[188:191], v[40:43]
    v_exp_f32 v223, v223
    v_add_f32 v220, 1.0, v220
    s_waitcnt vmcnt(35)
    v_mfma_f32_16x16x32_bf16 v[28:31], v[196:199], a[192:195], v[28:31]
    buffer_load_dwordx4 v[192:195], v2, s[44:47], s67 offen offset:3072
    v_add_f32 v221, 1.0, v221
    v_add_f32 v222, 1.0, v222
    v_add_f32 v223, 1.0, v223
    v_mfma_f32_16x16x32_bf16 v[32:35], v[196:199], a[196:199], v[32:35]
    v_rcp_f32 v220, v220
    v_mfma_f32_16x16x32_bf16 v[36:39], v[196:199], a[200:203], v[36:39]
    v_rcp_f32 v221, v221
    v_mfma_f32_16x16x32_bf16 v[40:43], v[196:199], a[204:207], v[40:43]
    v_rcp_f32 v222, v222
    v_rcp_f32 v223, v223
    s_waitcnt vmcnt(35)
    v_mfma_f32_16x16x32_bf16 v[28:31], v[200:203], a[208:211], v[28:31]
    s_add_u32 s67, s66, 12288
    buffer_load_dwordx4 v[196:199], v2, s[44:47], s67 offen offset:0
    v_mul_f32 v220, v20, v220
    v_mul_f32 v221, v21, v221
    v_mfma_f32_16x16x32_bf16 v[32:35], v[200:203], a[212:215], v[32:35]
    v_mul_f32 v222, v22, v222
    v_mul_f32 v223, v23, v223
    v_mfma_f32_16x16x32_bf16 v[36:39], v[200:203], a[216:219], v[36:39]
    v_cvt_pk_bf16_f32 v228, v220, v221
    v_cvt_pk_bf16_f32 v229, v222, v223
    ds_write_b64 v8, v[228:229] offset:36864
    v_mfma_f32_16x16x32_bf16 v[40:43], v[200:203], a[220:223], v[40:43]
    v_fma_f32 v24, -v246, v248, v24
    v_fma_f32 v25, -v246, v249, v25
    v_fma_f32 v26, -v246, v250, v26
    s_waitcnt vmcnt(35)
    v_mfma_f32_16x16x32_bf16 v[28:31], v[204:207], a[224:227], v[28:31]
    buffer_load_dwordx4 v[200:203], v2, s[44:47], s67 offen offset:1024
    v_fma_f32 v27, -v246, v251, v27
    v_mul_f32 v224, v24, v24
    v_mfma_f32_16x16x32_bf16 v[32:35], v[204:207], a[228:231], v[32:35]
    v_mul_f32 v225, v25, v25
    v_mul_f32 v226, v26, v26
    v_mul_f32 v227, v27, v27
    v_mfma_f32_16x16x32_bf16 v[36:39], v[204:207], a[232:235], v[36:39]
    v_fma_f32 v224, v224, v239, v238
    v_fma_f32 v225, v225, v239, v238
    v_mfma_f32_16x16x32_bf16 v[40:43], v[204:207], a[236:239], v[40:43]
    v_fma_f32 v226, v226, v239, v238
    v_fma_f32 v227, v227, v239, v238
    v_mul_f32 v224, v24, v224
    s_waitcnt vmcnt(35)
    v_mfma_f32_16x16x32_bf16 v[28:31], v[208:211], a[240:243], v[28:31]
    buffer_load_dwordx4 v[204:207], v2, s[44:47], s67 offen offset:2048
    v_mul_f32 v225, v25, v225
    v_mul_f32 v226, v26, v226
    v_mfma_f32_16x16x32_bf16 v[32:35], v[208:211], a[244:247], v[32:35]
    v_mul_f32 v227, v27, v227
    v_exp_f32 v224, v224
    v_mfma_f32_16x16x32_bf16 v[36:39], v[208:211], a[248:251], v[36:39]
    v_exp_f32 v225, v225
    v_mfma_f32_16x16x32_bf16 v[40:43], v[208:211], a[252:255], v[40:43]
    v_exp_f32 v226, v226
    s_waitcnt vmcnt(35)
    v_mfma_f32_16x16x32_bf16 v[28:31], v[212:215], v[44:47], v[28:31]
    buffer_load_dwordx4 v[208:211], v2, s[44:47], s67 offen offset:3072
    v_exp_f32 v227, v227
    v_add_f32 v224, 1.0, v224
    v_mfma_f32_16x16x32_bf16 v[32:35], v[212:215], v[48:51], v[32:35]
    v_add_f32 v225, 1.0, v225
    v_add_f32 v226, 1.0, v226
    v_add_f32 v227, 1.0, v227
    v_mfma_f32_16x16x32_bf16 v[36:39], v[212:215], v[52:55], v[36:39]
    v_rcp_f32 v224, v224
    v_mfma_f32_16x16x32_bf16 v[40:43], v[212:215], v[56:59], v[40:43]
    v_rcp_f32 v225, v225
    s_waitcnt vmcnt(35)
    v_mfma_f32_16x16x32_bf16 v[28:31], v[216:219], v[60:63], v[28:31]
    s_add_u32 s67, s66, 16384
    buffer_load_dwordx4 v[212:215], v2, s[44:47], s67 offen offset:0
    v_rcp_f32 v226, v226
    v_rcp_f32 v227, v227
    v_mfma_f32_16x16x32_bf16 v[32:35], v[216:219], v[64:67], v[32:35]
    v_mul_f32 v224, v24, v224
    v_mul_f32 v225, v25, v225
    v_mfma_f32_16x16x32_bf16 v[36:39], v[216:219], v[68:71], v[36:39]
    v_mul_f32 v226, v26, v226
    v_mul_f32 v227, v27, v227
    v_mfma_f32_16x16x32_bf16 v[40:43], v[216:219], v[72:75], v[40:43]
    v_cvt_pk_bf16_f32 v230, v224, v225
    v_cvt_pk_bf16_f32 v231, v226, v227
    ds_write_b64 v8, v[230:231] offset:55296
    s_waitcnt vmcnt(18)
    buffer_load_dwordx4 v[248:251], v6, s[52:55], s11 offen
    s_add_u32 s11, s11, 256
    v_mov_b32 v8, v7
    v_add_u32 v7, 2048, v7
    v_mfma_f32_16x16x32_bf16 v[12:15], v[76:79], a[0:3], 0
    buffer_load_dwordx4 v[216:219], v2, s[44:47], s67 offen offset:1024
    v_mfma_f32_16x16x32_bf16 v[16:19], v[76:79], a[4:7], 0
    v_mfma_f32_16x16x32_bf16 v[20:23], v[76:79], a[8:11], 0
    v_mfma_f32_16x16x32_bf16 v[24:27], v[76:79], a[12:15], 0
    v_mfma_f32_16x16x32_bf16 v[12:15], v[80:83], a[16:19], v[12:15]
    s_add_u32 s66, s66, 73728
    s_add_u32 s67, s66, 0
    buffer_load_dwordx4 v[76:79], v2, s[44:47], s67 offen offset:0
    v_fma_f32 v28, -v240, v252, v28
    v_fma_f32 v29, -v240, v253, v29
    v_fma_f32 v30, -v240, v254, v30
    v_mfma_f32_16x16x32_bf16 v[16:19], v[80:83], a[20:23], v[16:19]
    v_fma_f32 v31, -v240, v255, v31
    v_mul_f32 v220, v28, v28
    v_mfma_f32_16x16x32_bf16 v[20:23], v[80:83], a[24:27], v[20:23]
    v_mul_f32 v221, v29, v29
    v_mul_f32 v222, v30, v30
    v_mul_f32 v223, v31, v31
    v_mfma_f32_16x16x32_bf16 v[24:27], v[80:83], a[28:31], v[24:27]
    v_fma_f32 v220, v220, v233, v232
    v_fma_f32 v221, v221, v233, v232
    v_mfma_f32_16x16x32_bf16 v[12:15], v[84:87], a[32:35], v[12:15]
    buffer_load_dwordx4 v[80:83], v2, s[44:47], s67 offen offset:1024
    v_fma_f32 v222, v222, v233, v232
    v_fma_f32 v223, v223, v233, v232
    v_mul_f32 v220, v28, v220
    v_mfma_f32_16x16x32_bf16 v[16:19], v[84:87], a[36:39], v[16:19]
    v_mul_f32 v221, v29, v221
    v_mul_f32 v222, v30, v222
    v_mfma_f32_16x16x32_bf16 v[20:23], v[84:87], a[40:43], v[20:23]
    v_mul_f32 v223, v31, v223
    v_exp_f32 v220, v220
    v_mfma_f32_16x16x32_bf16 v[24:27], v[84:87], a[44:47], v[24:27]
    v_exp_f32 v221, v221
    v_mfma_f32_16x16x32_bf16 v[12:15], v[88:91], a[48:51], v[12:15]
    buffer_load_dwordx4 v[84:87], v2, s[44:47], s67 offen offset:2048
    v_exp_f32 v222, v222
    v_mfma_f32_16x16x32_bf16 v[16:19], v[88:91], a[52:55], v[16:19]
    v_exp_f32 v223, v223
    v_add_f32 v220, 1.0, v220
    v_mfma_f32_16x16x32_bf16 v[20:23], v[88:91], a[56:59], v[20:23]
    v_add_f32 v221, 1.0, v221
    v_add_f32 v222, 1.0, v222
    v_add_f32 v223, 1.0, v223
    v_mfma_f32_16x16x32_bf16 v[24:27], v[88:91], a[60:63], v[24:27]
    v_rcp_f32 v220, v220
    v_mfma_f32_16x16x32_bf16 v[12:15], v[92:95], a[64:67], v[12:15]
    buffer_load_dwordx4 v[88:91], v2, s[44:47], s67 offen offset:3072
    v_rcp_f32 v221, v221
    v_mfma_f32_16x16x32_bf16 v[16:19], v[92:95], a[68:71], v[16:19]
    v_rcp_f32 v222, v222
    v_rcp_f32 v223, v223
    v_mfma_f32_16x16x32_bf16 v[20:23], v[92:95], a[72:75], v[20:23]
    v_mul_f32 v220, v28, v220
    v_mul_f32 v221, v29, v221
    v_mfma_f32_16x16x32_bf16 v[24:27], v[92:95], a[76:79], v[24:27]
    v_mul_f32 v222, v30, v222
    v_mul_f32 v223, v31, v223
    v_mfma_f32_16x16x32_bf16 v[12:15], v[96:99], a[80:83], v[12:15]
    s_add_u32 s67, s66, 4096
    buffer_load_dwordx4 v[92:95], v2, s[44:47], s67 offen offset:0
    v_cvt_pk_bf16_f32 v228, v220, v221
    v_cvt_pk_bf16_f32 v229, v222, v223
    ds_write_b64 v9, v[228:229] offset:0
    v_mfma_f32_16x16x32_bf16 v[16:19], v[96:99], a[84:87], v[16:19]
    v_fma_f32 v32, -v242, v252, v32
    v_fma_f32 v33, -v242, v253, v33
    v_fma_f32 v34, -v242, v254, v34
    v_mfma_f32_16x16x32_bf16 v[20:23], v[96:99], a[88:91], v[20:23]
    v_fma_f32 v35, -v242, v255, v35
    v_mul_f32 v224, v32, v32
    v_mfma_f32_16x16x32_bf16 v[24:27], v[96:99], a[92:95], v[24:27]
    v_mul_f32 v225, v33, v33
    v_mul_f32 v226, v34, v34
    v_mul_f32 v227, v35, v35
    v_mfma_f32_16x16x32_bf16 v[12:15], v[100:103], a[96:99], v[12:15]
    buffer_load_dwordx4 v[96:99], v2, s[44:47], s67 offen offset:1024
    v_fma_f32 v224, v224, v235, v234
    v_fma_f32 v225, v225, v235, v234
    v_mfma_f32_16x16x32_bf16 v[16:19], v[100:103], a[100:103], v[16:19]
    v_fma_f32 v226, v226, v235, v234
    v_fma_f32 v227, v227, v235, v234
    v_mul_f32 v224, v32, v224
    v_mfma_f32_16x16x32_bf16 v[20:23], v[100:103], a[104:107], v[20:23]
    v_mul_f32 v225, v33, v225
    v_mul_f32 v226, v34, v226
    v_mfma_f32_16x16x32_bf16 v[24:27], v[100:103], a[108:111], v[24:27]
    v_mul_f32 v227, v35, v227
    v_exp_f32 v224, v224
    v_mfma_f32_16x16x32_bf16 v[12:15], v[104:107], a[112:115], v[12:15]
    buffer_load_dwordx4 v[100:103], v2, s[44:47], s67 offen offset:2048
    v_exp_f32 v225, v225
    v_mfma_f32_16x16x32_bf16 v[16:19], v[104:107], a[116:119], v[16:19]
    v_exp_f32 v226, v226
    v_mfma_f32_16x16x32_bf16 v[20:23], v[104:107], a[120:123], v[20:23]
    v_exp_f32 v227, v227
    v_add_f32 v224, 1.0, v224
    v_mfma_f32_16x16x32_bf16 v[24:27], v[104:107], a[124:127], v[24:27]
    v_add_f32 v225, 1.0, v225
    v_add_f32 v226, 1.0, v226
    v_add_f32 v227, 1.0, v227
    v_mfma_f32_16x16x32_bf16 v[12:15], v[108:111], a[128:131], v[12:15]
    buffer_load_dwordx4 v[104:107], v2, s[44:47], s67 offen offset:3072
    v_rcp_f32 v224, v224
    v_mfma_f32_16x16x32_bf16 v[16:19], v[108:111], a[132:135], v[16:19]
    v_rcp_f32 v225, v225
    v_mfma_f32_16x16x32_bf16 v[20:23], v[108:111], a[136:139], v[20:23]
    v_rcp_f32 v226, v226
    v_rcp_f32 v227, v227
    v_mfma_f32_16x16x32_bf16 v[24:27], v[108:111], a[140:143], v[24:27]
    v_mul_f32 v224, v32, v224
    v_mul_f32 v225, v33, v225
    v_mfma_f32_16x16x32_bf16 v[12:15], v[112:115], a[144:147], v[12:15]
    s_add_u32 s67, s66, 8192
    buffer_load_dwordx4 v[108:111], v2, s[44:47], s67 offen offset:0
    v_mul_f32 v226, v34, v226
    v_mul_f32 v227, v35, v227
    v_mfma_f32_16x16x32_bf16 v[16:19], v[112:115], a[148:151], v[16:19]
    v_cvt_pk_bf16_f32 v230, v224, v225
    v_cvt_pk_bf16_f32 v231, v226, v227
    ds_write_b64 v9, v[230:231] offset:18432
    v_mfma_f32_16x16x32_bf16 v[20:23], v[112:115], a[152:155], v[20:23]
    v_fma_f32 v36, -v244, v252, v36
    v_fma_f32 v37, -v244, v253, v37
    v_fma_f32 v38, -v244, v254, v38
    v_mfma_f32_16x16x32_bf16 v[24:27], v[112:115], a[156:159], v[24:27]
    v_fma_f32 v39, -v244, v255, v39
    v_mul_f32 v220, v36, v36
    v_mfma_f32_16x16x32_bf16 v[12:15], v[116:119], a[160:163], v[12:15]
    buffer_load_dwordx4 v[112:115], v2, s[44:47], s67 offen offset:1024
    v_mul_f32 v221, v37, v37
    v_mul_f32 v222, v38, v38
    v_mul_f32 v223, v39, v39
    v_mfma_f32_16x16x32_bf16 v[16:19], v[116:119], a[164:167], v[16:19]
    v_fma_f32 v220, v220, v237, v236
    v_fma_f32 v221, v221, v237, v236
    v_mfma_f32_16x16x32_bf16 v[20:23], v[116:119], a[168:171], v[20:23]
    v_fma_f32 v222, v222, v237, v236
    v_fma_f32 v223, v223, v237, v236
    v_mul_f32 v220, v36, v220
    v_mfma_f32_16x16x32_bf16 v[24:27], v[116:119], a[172:175], v[24:27]
    v_mul_f32 v221, v37, v221
    v_mul_f32 v222, v38, v222
    v_mfma_f32_16x16x32_bf16 v[12:15], v[120:123], a[176:179], v[12:15]
    buffer_load_dwordx4 v[116:119], v2, s[44:47], s67 offen offset:2048
    v_mul_f32 v223, v39, v223
    v_exp_f32 v220, v220
    v_mfma_f32_16x16x32_bf16 v[16:19], v[120:123], a[180:183], v[16:19]
    v_exp_f32 v221, v221
    v_mfma_f32_16x16x32_bf16 v[20:23], v[120:123], a[184:187], v[20:23]
    v_exp_f32 v222, v222
    v_mfma_f32_16x16x32_bf16 v[24:27], v[120:123], a[188:191], v[24:27]
    v_exp_f32 v223, v223
    v_add_f32 v220, 1.0, v220
    v_mfma_f32_16x16x32_bf16 v[12:15], v[124:127], a[192:195], v[12:15]
    buffer_load_dwordx4 v[120:123], v2, s[44:47], s67 offen offset:3072
    v_add_f32 v221, 1.0, v221
    v_add_f32 v222, 1.0, v222
    v_add_f32 v223, 1.0, v223
    v_mfma_f32_16x16x32_bf16 v[16:19], v[124:127], a[196:199], v[16:19]
    v_rcp_f32 v220, v220
    v_mfma_f32_16x16x32_bf16 v[20:23], v[124:127], a[200:203], v[20:23]
    v_rcp_f32 v221, v221
    v_mfma_f32_16x16x32_bf16 v[24:27], v[124:127], a[204:207], v[24:27]
    v_rcp_f32 v222, v222
    v_rcp_f32 v223, v223
    v_mfma_f32_16x16x32_bf16 v[12:15], v[128:131], a[208:211], v[12:15]
    s_add_u32 s67, s66, 12288
    buffer_load_dwordx4 v[124:127], v2, s[44:47], s67 offen offset:0
    v_mul_f32 v220, v36, v220
    v_mul_f32 v221, v37, v221
    v_mfma_f32_16x16x32_bf16 v[16:19], v[128:131], a[212:215], v[16:19]
    v_mul_f32 v222, v38, v222
    v_mul_f32 v223, v39, v223
    v_mfma_f32_16x16x32_bf16 v[20:23], v[128:131], a[216:219], v[20:23]
    v_cvt_pk_bf16_f32 v228, v220, v221
    v_cvt_pk_bf16_f32 v229, v222, v223
    ds_write_b64 v9, v[228:229] offset:36864
    v_mfma_f32_16x16x32_bf16 v[24:27], v[128:131], a[220:223], v[24:27]
    v_fma_f32 v40, -v246, v252, v40
    v_fma_f32 v41, -v246, v253, v41
    v_fma_f32 v42, -v246, v254, v42
    v_mfma_f32_16x16x32_bf16 v[12:15], v[132:135], a[224:227], v[12:15]
    buffer_load_dwordx4 v[128:131], v2, s[44:47], s67 offen offset:1024
    v_fma_f32 v43, -v246, v255, v43
    v_mul_f32 v224, v40, v40
    v_mfma_f32_16x16x32_bf16 v[16:19], v[132:135], a[228:231], v[16:19]
    v_mul_f32 v225, v41, v41
    v_mul_f32 v226, v42, v42
    v_mul_f32 v227, v43, v43
    v_mfma_f32_16x16x32_bf16 v[20:23], v[132:135], a[232:235], v[20:23]
    v_fma_f32 v224, v224, v239, v238
    v_fma_f32 v225, v225, v239, v238
    v_mfma_f32_16x16x32_bf16 v[24:27], v[132:135], a[236:239], v[24:27]
    v_fma_f32 v226, v226, v239, v238
    v_fma_f32 v227, v227, v239, v238
    v_mul_f32 v224, v40, v224
    v_mfma_f32_16x16x32_bf16 v[12:15], v[136:139], a[240:243], v[12:15]
    buffer_load_dwordx4 v[132:135], v2, s[44:47], s67 offen offset:2048
    v_mul_f32 v225, v41, v225
    v_mul_f32 v226, v42, v226
    v_mfma_f32_16x16x32_bf16 v[16:19], v[136:139], a[244:247], v[16:19]
    v_mul_f32 v227, v43, v227
    v_exp_f32 v224, v224
    v_mfma_f32_16x16x32_bf16 v[20:23], v[136:139], a[248:251], v[20:23]
    v_exp_f32 v225, v225
    v_mfma_f32_16x16x32_bf16 v[24:27], v[136:139], a[252:255], v[24:27]
    v_exp_f32 v226, v226
    v_mfma_f32_16x16x32_bf16 v[12:15], v[140:143], v[44:47], v[12:15]
    buffer_load_dwordx4 v[136:139], v2, s[44:47], s67 offen offset:3072
    v_exp_f32 v227, v227
    v_add_f32 v224, 1.0, v224
    v_mfma_f32_16x16x32_bf16 v[16:19], v[140:143], v[48:51], v[16:19]
    v_add_f32 v225, 1.0, v225
    v_add_f32 v226, 1.0, v226
    v_add_f32 v227, 1.0, v227
    v_mfma_f32_16x16x32_bf16 v[20:23], v[140:143], v[52:55], v[20:23]
    v_rcp_f32 v224, v224
    v_mfma_f32_16x16x32_bf16 v[24:27], v[140:143], v[56:59], v[24:27]
    v_rcp_f32 v225, v225
    s_waitcnt vmcnt(35)
    v_mfma_f32_16x16x32_bf16 v[12:15], v[144:147], v[60:63], v[12:15]
    s_add_u32 s67, s66, 16384
    buffer_load_dwordx4 v[140:143], v2, s[44:47], s67 offen offset:0
    v_rcp_f32 v226, v226
    v_rcp_f32 v227, v227
    v_mfma_f32_16x16x32_bf16 v[16:19], v[144:147], v[64:67], v[16:19]
    v_mul_f32 v224, v40, v224
    v_mul_f32 v225, v41, v225
    v_mfma_f32_16x16x32_bf16 v[20:23], v[144:147], v[68:71], v[20:23]
    v_mul_f32 v226, v42, v226
    v_mul_f32 v227, v43, v227
    v_mfma_f32_16x16x32_bf16 v[24:27], v[144:147], v[72:75], v[24:27]
    v_cvt_pk_bf16_f32 v230, v224, v225
    v_cvt_pk_bf16_f32 v231, v226, v227
    ds_write_b64 v9, v[230:231] offset:55296
    s_waitcnt vmcnt(18)
    s_add_u32 s9, s9, 1
    s_cmp_lt_u32 s9, 3
    s_cbranch_scc1 L_kg_ker_lp_28
    buffer_load_dwordx4 v[252:255], v6, s[52:55], s11 offen
    s_add_u32 s11, s11, 256
    v_mov_b32 v9, v7
    v_add_u32 v7, 2048, v7
    v_mfma_f32_16x16x32_bf16 v[28:31], v[148:151], a[0:3], 0
    buffer_load_dwordx4 v[144:147], v2, s[44:47], s67 offen offset:1024
    v_mfma_f32_16x16x32_bf16 v[32:35], v[148:151], a[4:7], 0
    v_mfma_f32_16x16x32_bf16 v[36:39], v[148:151], a[8:11], 0
    v_mfma_f32_16x16x32_bf16 v[40:43], v[148:151], a[12:15], 0
    v_mfma_f32_16x16x32_bf16 v[28:31], v[152:155], a[16:19], v[28:31]
    s_mul_i32 s66, s65, 18432
    s_add_u32 s66, s66, s64
    s_add_u32 s67, s66, 0
    buffer_load_dwordx4 v[148:151], v2, s[44:47], s67 offen offset:0
    v_fma_f32 v12, -v240, v248, v12
    v_fma_f32 v13, -v240, v249, v13
    v_fma_f32 v14, -v240, v250, v14
    v_mfma_f32_16x16x32_bf16 v[32:35], v[152:155], a[20:23], v[32:35]
    v_fma_f32 v15, -v240, v251, v15
    v_mul_f32 v220, v12, v12
    v_mfma_f32_16x16x32_bf16 v[36:39], v[152:155], a[24:27], v[36:39]
    v_mul_f32 v221, v13, v13
    v_mul_f32 v222, v14, v14
    v_mul_f32 v223, v15, v15
    v_mfma_f32_16x16x32_bf16 v[40:43], v[152:155], a[28:31], v[40:43]
    v_fma_f32 v220, v220, v233, v232
    v_fma_f32 v221, v221, v233, v232
    v_mfma_f32_16x16x32_bf16 v[28:31], v[156:159], a[32:35], v[28:31]
    buffer_load_dwordx4 v[152:155], v2, s[44:47], s67 offen offset:1024
    v_fma_f32 v222, v222, v233, v232
    v_fma_f32 v223, v223, v233, v232
    v_mul_f32 v220, v12, v220
    v_mfma_f32_16x16x32_bf16 v[32:35], v[156:159], a[36:39], v[32:35]
    v_mul_f32 v221, v13, v221
    v_mul_f32 v222, v14, v222
    v_mfma_f32_16x16x32_bf16 v[36:39], v[156:159], a[40:43], v[36:39]
    v_mul_f32 v223, v15, v223
    v_exp_f32 v220, v220
    v_mfma_f32_16x16x32_bf16 v[40:43], v[156:159], a[44:47], v[40:43]
    v_exp_f32 v221, v221
    v_mfma_f32_16x16x32_bf16 v[28:31], v[160:163], a[48:51], v[28:31]
    buffer_load_dwordx4 v[156:159], v2, s[44:47], s67 offen offset:2048
    v_exp_f32 v222, v222
    v_mfma_f32_16x16x32_bf16 v[32:35], v[160:163], a[52:55], v[32:35]
    v_exp_f32 v223, v223
    v_add_f32 v220, 1.0, v220
    v_mfma_f32_16x16x32_bf16 v[36:39], v[160:163], a[56:59], v[36:39]
    v_add_f32 v221, 1.0, v221
    v_add_f32 v222, 1.0, v222
    v_add_f32 v223, 1.0, v223
    v_mfma_f32_16x16x32_bf16 v[40:43], v[160:163], a[60:63], v[40:43]
    v_rcp_f32 v220, v220
    v_mfma_f32_16x16x32_bf16 v[28:31], v[164:167], a[64:67], v[28:31]
    buffer_load_dwordx4 v[160:163], v2, s[44:47], s67 offen offset:3072
    v_rcp_f32 v221, v221
    v_mfma_f32_16x16x32_bf16 v[32:35], v[164:167], a[68:71], v[32:35]
    v_rcp_f32 v222, v222
    v_rcp_f32 v223, v223
    v_mfma_f32_16x16x32_bf16 v[36:39], v[164:167], a[72:75], v[36:39]
    v_mul_f32 v220, v12, v220
    v_mul_f32 v221, v13, v221
    v_mfma_f32_16x16x32_bf16 v[40:43], v[164:167], a[76:79], v[40:43]
    v_mul_f32 v222, v14, v222
    v_mul_f32 v223, v15, v223
    v_mfma_f32_16x16x32_bf16 v[28:31], v[168:171], a[80:83], v[28:31]
    s_add_u32 s67, s66, 4096
    buffer_load_dwordx4 v[164:167], v2, s[44:47], s67 offen offset:0
    v_cvt_pk_bf16_f32 v228, v220, v221
    v_cvt_pk_bf16_f32 v229, v222, v223
    ds_write_b64 v8, v[228:229] offset:0
    v_mfma_f32_16x16x32_bf16 v[32:35], v[168:171], a[84:87], v[32:35]
    v_fma_f32 v16, -v242, v248, v16
    v_fma_f32 v17, -v242, v249, v17
    v_fma_f32 v18, -v242, v250, v18
    v_mfma_f32_16x16x32_bf16 v[36:39], v[168:171], a[88:91], v[36:39]
    v_fma_f32 v19, -v242, v251, v19
    v_mul_f32 v224, v16, v16
    v_mfma_f32_16x16x32_bf16 v[40:43], v[168:171], a[92:95], v[40:43]
    v_mul_f32 v225, v17, v17
    v_mul_f32 v226, v18, v18
    v_mul_f32 v227, v19, v19
    v_mfma_f32_16x16x32_bf16 v[28:31], v[172:175], a[96:99], v[28:31]
    buffer_load_dwordx4 v[168:171], v2, s[44:47], s67 offen offset:1024
    v_fma_f32 v224, v224, v235, v234
    v_fma_f32 v225, v225, v235, v234
    v_mfma_f32_16x16x32_bf16 v[32:35], v[172:175], a[100:103], v[32:35]
    v_fma_f32 v226, v226, v235, v234
    v_fma_f32 v227, v227, v235, v234
    v_mul_f32 v224, v16, v224
    v_mfma_f32_16x16x32_bf16 v[36:39], v[172:175], a[104:107], v[36:39]
    v_mul_f32 v225, v17, v225
    v_mul_f32 v226, v18, v226
    v_mfma_f32_16x16x32_bf16 v[40:43], v[172:175], a[108:111], v[40:43]
    v_mul_f32 v227, v19, v227
    v_exp_f32 v224, v224
    v_mfma_f32_16x16x32_bf16 v[28:31], v[176:179], a[112:115], v[28:31]
    buffer_load_dwordx4 v[172:175], v2, s[44:47], s67 offen offset:2048
    v_exp_f32 v225, v225
    v_mfma_f32_16x16x32_bf16 v[32:35], v[176:179], a[116:119], v[32:35]
    v_exp_f32 v226, v226
    v_mfma_f32_16x16x32_bf16 v[36:39], v[176:179], a[120:123], v[36:39]
    v_exp_f32 v227, v227
    v_add_f32 v224, 1.0, v224
    v_mfma_f32_16x16x32_bf16 v[40:43], v[176:179], a[124:127], v[40:43]
    v_add_f32 v225, 1.0, v225
    v_add_f32 v226, 1.0, v226
    v_add_f32 v227, 1.0, v227
    v_mfma_f32_16x16x32_bf16 v[28:31], v[180:183], a[128:131], v[28:31]
    buffer_load_dwordx4 v[176:179], v2, s[44:47], s67 offen offset:3072
    v_rcp_f32 v224, v224
    v_mfma_f32_16x16x32_bf16 v[32:35], v[180:183], a[132:135], v[32:35]
    v_rcp_f32 v225, v225
    v_mfma_f32_16x16x32_bf16 v[36:39], v[180:183], a[136:139], v[36:39]
    v_rcp_f32 v226, v226
    v_rcp_f32 v227, v227
    v_mfma_f32_16x16x32_bf16 v[40:43], v[180:183], a[140:143], v[40:43]
    v_mul_f32 v224, v16, v224
    v_mul_f32 v225, v17, v225
    v_mfma_f32_16x16x32_bf16 v[28:31], v[184:187], a[144:147], v[28:31]
    s_add_u32 s67, s66, 8192
    buffer_load_dwordx4 v[180:183], v2, s[44:47], s67 offen offset:0
    v_mul_f32 v226, v18, v226
    v_mul_f32 v227, v19, v227
    v_mfma_f32_16x16x32_bf16 v[32:35], v[184:187], a[148:151], v[32:35]
    v_cvt_pk_bf16_f32 v230, v224, v225
    v_cvt_pk_bf16_f32 v231, v226, v227
    ds_write_b64 v8, v[230:231] offset:18432
    v_mfma_f32_16x16x32_bf16 v[36:39], v[184:187], a[152:155], v[36:39]
    v_fma_f32 v20, -v244, v248, v20
    v_fma_f32 v21, -v244, v249, v21
    v_fma_f32 v22, -v244, v250, v22
    v_mfma_f32_16x16x32_bf16 v[40:43], v[184:187], a[156:159], v[40:43]
    v_fma_f32 v23, -v244, v251, v23
    v_mul_f32 v220, v20, v20
    v_mfma_f32_16x16x32_bf16 v[28:31], v[188:191], a[160:163], v[28:31]
    buffer_load_dwordx4 v[184:187], v2, s[44:47], s67 offen offset:1024
    v_mul_f32 v221, v21, v21
    v_mul_f32 v222, v22, v22
    v_mul_f32 v223, v23, v23
    v_mfma_f32_16x16x32_bf16 v[32:35], v[188:191], a[164:167], v[32:35]
    v_fma_f32 v220, v220, v237, v236
    v_fma_f32 v221, v221, v237, v236
    v_mfma_f32_16x16x32_bf16 v[36:39], v[188:191], a[168:171], v[36:39]
    v_fma_f32 v222, v222, v237, v236
    v_fma_f32 v223, v223, v237, v236
    v_mul_f32 v220, v20, v220
    v_mfma_f32_16x16x32_bf16 v[40:43], v[188:191], a[172:175], v[40:43]
    v_mul_f32 v221, v21, v221
    v_mul_f32 v222, v22, v222
    v_mfma_f32_16x16x32_bf16 v[28:31], v[192:195], a[176:179], v[28:31]
    buffer_load_dwordx4 v[188:191], v2, s[44:47], s67 offen offset:2048
    v_mul_f32 v223, v23, v223
    v_exp_f32 v220, v220
    v_mfma_f32_16x16x32_bf16 v[32:35], v[192:195], a[180:183], v[32:35]
    v_exp_f32 v221, v221
    v_mfma_f32_16x16x32_bf16 v[36:39], v[192:195], a[184:187], v[36:39]
    v_exp_f32 v222, v222
    v_mfma_f32_16x16x32_bf16 v[40:43], v[192:195], a[188:191], v[40:43]
    v_exp_f32 v223, v223
    v_add_f32 v220, 1.0, v220
    v_mfma_f32_16x16x32_bf16 v[28:31], v[196:199], a[192:195], v[28:31]
    buffer_load_dwordx4 v[192:195], v2, s[44:47], s67 offen offset:3072
    v_add_f32 v221, 1.0, v221
    v_add_f32 v222, 1.0, v222
    v_add_f32 v223, 1.0, v223
    v_mfma_f32_16x16x32_bf16 v[32:35], v[196:199], a[196:199], v[32:35]
    v_rcp_f32 v220, v220
    v_mfma_f32_16x16x32_bf16 v[36:39], v[196:199], a[200:203], v[36:39]
    v_rcp_f32 v221, v221
    v_mfma_f32_16x16x32_bf16 v[40:43], v[196:199], a[204:207], v[40:43]
    v_rcp_f32 v222, v222
    v_rcp_f32 v223, v223
    v_mfma_f32_16x16x32_bf16 v[28:31], v[200:203], a[208:211], v[28:31]
    s_add_u32 s67, s66, 12288
    buffer_load_dwordx4 v[196:199], v2, s[44:47], s67 offen offset:0
    v_mul_f32 v220, v20, v220
    v_mul_f32 v221, v21, v221
    v_mfma_f32_16x16x32_bf16 v[32:35], v[200:203], a[212:215], v[32:35]
    v_mul_f32 v222, v22, v222
    v_mul_f32 v223, v23, v223
    v_mfma_f32_16x16x32_bf16 v[36:39], v[200:203], a[216:219], v[36:39]
    v_cvt_pk_bf16_f32 v228, v220, v221
    v_cvt_pk_bf16_f32 v229, v222, v223
    ds_write_b64 v8, v[228:229] offset:36864
    v_mfma_f32_16x16x32_bf16 v[40:43], v[200:203], a[220:223], v[40:43]
    v_fma_f32 v24, -v246, v248, v24
    v_fma_f32 v25, -v246, v249, v25
    v_fma_f32 v26, -v246, v250, v26
    v_mfma_f32_16x16x32_bf16 v[28:31], v[204:207], a[224:227], v[28:31]
    buffer_load_dwordx4 v[200:203], v2, s[44:47], s67 offen offset:1024
    v_fma_f32 v27, -v246, v251, v27
    v_mul_f32 v224, v24, v24
    v_mfma_f32_16x16x32_bf16 v[32:35], v[204:207], a[228:231], v[32:35]
    v_mul_f32 v225, v25, v25
    v_mul_f32 v226, v26, v26
    v_mul_f32 v227, v27, v27
    v_mfma_f32_16x16x32_bf16 v[36:39], v[204:207], a[232:235], v[36:39]
    v_fma_f32 v224, v224, v239, v238
    v_fma_f32 v225, v225, v239, v238
    v_mfma_f32_16x16x32_bf16 v[40:43], v[204:207], a[236:239], v[40:43]
    v_fma_f32 v226, v226, v239, v238
    v_fma_f32 v227, v227, v239, v238
    v_mul_f32 v224, v24, v224
    v_mfma_f32_16x16x32_bf16 v[28:31], v[208:211], a[240:243], v[28:31]
    buffer_load_dwordx4 v[204:207], v2, s[44:47], s67 offen offset:2048
    v_mul_f32 v225, v25, v225
    v_mul_f32 v226, v26, v226
    v_mfma_f32_16x16x32_bf16 v[32:35], v[208:211], a[244:247], v[32:35]
    v_mul_f32 v227, v27, v227
    v_exp_f32 v224, v224
    v_mfma_f32_16x16x32_bf16 v[36:39], v[208:211], a[248:251], v[36:39]
    v_exp_f32 v225, v225
    v_mfma_f32_16x16x32_bf16 v[40:43], v[208:211], a[252:255], v[40:43]
    v_exp_f32 v226, v226
    v_mfma_f32_16x16x32_bf16 v[28:31], v[212:215], v[44:47], v[28:31]
    buffer_load_dwordx4 v[208:211], v2, s[44:47], s67 offen offset:3072
    v_exp_f32 v227, v227
    v_add_f32 v224, 1.0, v224
    v_mfma_f32_16x16x32_bf16 v[32:35], v[212:215], v[48:51], v[32:35]
    v_add_f32 v225, 1.0, v225
    v_add_f32 v226, 1.0, v226
    v_add_f32 v227, 1.0, v227
    v_mfma_f32_16x16x32_bf16 v[36:39], v[212:215], v[52:55], v[36:39]
    v_rcp_f32 v224, v224
    v_mfma_f32_16x16x32_bf16 v[40:43], v[212:215], v[56:59], v[40:43]
    v_rcp_f32 v225, v225
    s_waitcnt vmcnt(35)
    v_mfma_f32_16x16x32_bf16 v[28:31], v[216:219], v[60:63], v[28:31]
    s_add_u32 s67, s66, 16384
    buffer_load_dwordx4 v[212:215], v2, s[44:47], s67 offen offset:0
    v_rcp_f32 v226, v226
    v_rcp_f32 v227, v227
    v_mfma_f32_16x16x32_bf16 v[32:35], v[216:219], v[64:67], v[32:35]
    v_mul_f32 v224, v24, v224
    v_mul_f32 v225, v25, v225
    v_mfma_f32_16x16x32_bf16 v[36:39], v[216:219], v[68:71], v[36:39]
    v_mul_f32 v226, v26, v226
    v_mul_f32 v227, v27, v227
    v_mfma_f32_16x16x32_bf16 v[40:43], v[216:219], v[72:75], v[40:43]
    v_cvt_pk_bf16_f32 v230, v224, v225
    v_cvt_pk_bf16_f32 v231, v226, v227
    ds_write_b64 v8, v[230:231] offset:55296
    s_waitcnt vmcnt(18)
    buffer_load_dwordx4 v[248:251], v6, s[52:55], s11 offen
    s_add_u32 s11, s11, 256
    v_mov_b32 v8, v7
    v_add_u32 v7, 2048, v7
    v_mfma_f32_16x16x32_bf16 v[12:15], v[76:79], a[0:3], 0
    buffer_load_dwordx4 v[216:219], v2, s[44:47], s67 offen offset:1024
    v_mfma_f32_16x16x32_bf16 v[16:19], v[76:79], a[4:7], 0
    v_mfma_f32_16x16x32_bf16 v[20:23], v[76:79], a[8:11], 0
    v_mfma_f32_16x16x32_bf16 v[24:27], v[76:79], a[12:15], 0
    v_mfma_f32_16x16x32_bf16 v[12:15], v[80:83], a[16:19], v[12:15]
    s_add_u32 s65, s65, 1
    s_cmp_eq_u32 s65, 9
    s_cselect_b32 s65, 0, s65
    s_mul_i32 s66, s65, 18432
    s_add_u32 s66, s66, s64
    s_add_u32 s67, s66, 0
    buffer_load_dwordx4 v[76:79], v2, s[44:47], s67 offen offset:0
    v_fma_f32 v28, -v240, v252, v28
    v_fma_f32 v29, -v240, v253, v29
    v_fma_f32 v30, -v240, v254, v30
    v_mfma_f32_16x16x32_bf16 v[16:19], v[80:83], a[20:23], v[16:19]
    v_fma_f32 v31, -v240, v255, v31
    v_mul_f32 v220, v28, v28
    v_mfma_f32_16x16x32_bf16 v[20:23], v[80:83], a[24:27], v[20:23]
    v_mul_f32 v221, v29, v29
    v_mul_f32 v222, v30, v30
    v_mul_f32 v223, v31, v31
    v_mfma_f32_16x16x32_bf16 v[24:27], v[80:83], a[28:31], v[24:27]
    v_fma_f32 v220, v220, v233, v232
    v_fma_f32 v221, v221, v233, v232
    v_mfma_f32_16x16x32_bf16 v[12:15], v[84:87], a[32:35], v[12:15]
    buffer_load_dwordx4 v[80:83], v2, s[44:47], s67 offen offset:1024
    v_fma_f32 v222, v222, v233, v232
    v_fma_f32 v223, v223, v233, v232
    v_mul_f32 v220, v28, v220
    v_mfma_f32_16x16x32_bf16 v[16:19], v[84:87], a[36:39], v[16:19]
    v_mul_f32 v221, v29, v221
    v_mul_f32 v222, v30, v222
    v_mfma_f32_16x16x32_bf16 v[20:23], v[84:87], a[40:43], v[20:23]
    v_mul_f32 v223, v31, v223
    v_exp_f32 v220, v220
    v_mfma_f32_16x16x32_bf16 v[24:27], v[84:87], a[44:47], v[24:27]
    v_exp_f32 v221, v221
    v_mfma_f32_16x16x32_bf16 v[12:15], v[88:91], a[48:51], v[12:15]
    buffer_load_dwordx4 v[84:87], v2, s[44:47], s67 offen offset:2048
    v_exp_f32 v222, v222
    v_mfma_f32_16x16x32_bf16 v[16:19], v[88:91], a[52:55], v[16:19]
    v_exp_f32 v223, v223
    v_add_f32 v220, 1.0, v220
    v_mfma_f32_16x16x32_bf16 v[20:23], v[88:91], a[56:59], v[20:23]
    v_add_f32 v221, 1.0, v221
    v_add_f32 v222, 1.0, v222
    v_add_f32 v223, 1.0, v223
    v_mfma_f32_16x16x32_bf16 v[24:27], v[88:91], a[60:63], v[24:27]
    v_rcp_f32 v220, v220
    v_mfma_f32_16x16x32_bf16 v[12:15], v[92:95], a[64:67], v[12:15]
    buffer_load_dwordx4 v[88:91], v2, s[44:47], s67 offen offset:3072
    v_rcp_f32 v221, v221
    v_mfma_f32_16x16x32_bf16 v[16:19], v[92:95], a[68:71], v[16:19]
    v_rcp_f32 v222, v222
    v_rcp_f32 v223, v223
    v_mfma_f32_16x16x32_bf16 v[20:23], v[92:95], a[72:75], v[20:23]
    v_mul_f32 v220, v28, v220
    v_mul_f32 v221, v29, v221
    v_mfma_f32_16x16x32_bf16 v[24:27], v[92:95], a[76:79], v[24:27]
    v_mul_f32 v222, v30, v222
    v_mul_f32 v223, v31, v223
    v_mfma_f32_16x16x32_bf16 v[12:15], v[96:99], a[80:83], v[12:15]
    s_add_u32 s67, s66, 4096
    buffer_load_dwordx4 v[92:95], v2, s[44:47], s67 offen offset:0
    v_cvt_pk_bf16_f32 v228, v220, v221
    v_cvt_pk_bf16_f32 v229, v222, v223
    ds_write_b64 v9, v[228:229] offset:0
    v_mfma_f32_16x16x32_bf16 v[16:19], v[96:99], a[84:87], v[16:19]
    v_fma_f32 v32, -v242, v252, v32
    v_fma_f32 v33, -v242, v253, v33
    v_fma_f32 v34, -v242, v254, v34
    v_mfma_f32_16x16x32_bf16 v[20:23], v[96:99], a[88:91], v[20:23]
    v_fma_f32 v35, -v242, v255, v35
    v_mul_f32 v224, v32, v32
    v_mfma_f32_16x16x32_bf16 v[24:27], v[96:99], a[92:95], v[24:27]
    v_mul_f32 v225, v33, v33
    v_mul_f32 v226, v34, v34
    v_mul_f32 v227, v35, v35
    v_mfma_f32_16x16x32_bf16 v[12:15], v[100:103], a[96:99], v[12:15]
    buffer_load_dwordx4 v[96:99], v2, s[44:47], s67 offen offset:1024
    v_fma_f32 v224, v224, v235, v234
    v_fma_f32 v225, v225, v235, v234
    v_mfma_f32_16x16x32_bf16 v[16:19], v[100:103], a[100:103], v[16:19]
    v_fma_f32 v226, v226, v235, v234
    v_fma_f32 v227, v227, v235, v234
    v_mul_f32 v224, v32, v224
    v_mfma_f32_16x16x32_bf16 v[20:23], v[100:103], a[104:107], v[20:23]
    v_mul_f32 v225, v33, v225
    v_mul_f32 v226, v34, v226
    v_mfma_f32_16x16x32_bf16 v[24:27], v[100:103], a[108:111], v[24:27]
    v_mul_f32 v227, v35, v227
    v_exp_f32 v224, v224
    v_mfma_f32_16x16x32_bf16 v[12:15], v[104:107], a[112:115], v[12:15]
    buffer_load_dwordx4 v[100:103], v2, s[44:47], s67 offen offset:2048
    v_exp_f32 v225, v225
    v_mfma_f32_16x16x32_bf16 v[16:19], v[104:107], a[116:119], v[16:19]
    v_exp_f32 v226, v226
    v_mfma_f32_16x16x32_bf16 v[20:23], v[104:107], a[120:123], v[20:23]
    v_exp_f32 v227, v227
    v_add_f32 v224, 1.0, v224
    v_mfma_f32_16x16x32_bf16 v[24:27], v[104:107], a[124:127], v[24:27]
    v_add_f32 v225, 1.0, v225
    v_add_f32 v226, 1.0, v226
    v_add_f32 v227, 1.0, v227
    v_mfma_f32_16x16x32_bf16 v[12:15], v[108:111], a[128:131], v[12:15]
    buffer_load_dwordx4 v[104:107], v2, s[44:47], s67 offen offset:3072
    v_rcp_f32 v224, v224
    v_mfma_f32_16x16x32_bf16 v[16:19], v[108:111], a[132:135], v[16:19]
    v_rcp_f32 v225, v225
    v_mfma_f32_16x16x32_bf16 v[20:23], v[108:111], a[136:139], v[20:23]
    v_rcp_f32 v226, v226
    v_rcp_f32 v227, v227
    v_mfma_f32_16x16x32_bf16 v[24:27], v[108:111], a[140:143], v[24:27]
    v_mul_f32 v224, v32, v224
    v_mul_f32 v225, v33, v225
    v_mfma_f32_16x16x32_bf16 v[12:15], v[112:115], a[144:147], v[12:15]
    s_add_u32 s67, s66, 8192
    buffer_load_dwordx4 v[108:111], v2, s[44:47], s67 offen offset:0
    v_mul_f32 v226, v34, v226
    v_mul_f32 v227, v35, v227
    v_mfma_f32_16x16x32_bf16 v[16:19], v[112:115], a[148:151], v[16:19]
    v_cvt_pk_bf16_f32 v230, v224, v225
    v_cvt_pk_bf16_f32 v231, v226, v227
    ds_write_b64 v9, v[230:231] offset:18432
    v_mfma_f32_16x16x32_bf16 v[20:23], v[112:115], a[152:155], v[20:23]
    v_fma_f32 v36, -v244, v252, v36
    v_fma_f32 v37, -v244, v253, v37
    v_fma_f32 v38, -v244, v254, v38
    v_mfma_f32_16x16x32_bf16 v[24:27], v[112:115], a[156:159], v[24:27]
    v_fma_f32 v39, -v244, v255, v39
    v_mul_f32 v220, v36, v36
    v_mfma_f32_16x16x32_bf16 v[12:15], v[116:119], a[160:163], v[12:15]
    buffer_load_dwordx4 v[112:115], v2, s[44:47], s67 offen offset:1024
    v_mul_f32 v221, v37, v37
    v_mul_f32 v222, v38, v38
    v_mul_f32 v223, v39, v39
    v_mfma_f32_16x16x32_bf16 v[16:19], v[116:119], a[164:167], v[16:19]
    v_fma_f32 v220, v220, v237, v236
    v_fma_f32 v221, v221, v237, v236
    v_mfma_f32_16x16x32_bf16 v[20:23], v[116:119], a[168:171], v[20:23]
    v_fma_f32 v222, v222, v237, v236
    v_fma_f32 v223, v223, v237, v236
    v_mul_f32 v220, v36, v220
    v_mfma_f32_16x16x32_bf16 v[24:27], v[116:119], a[172:175], v[24:27]
    v_mul_f32 v221, v37, v221
    v_mul_f32 v222, v38, v222
    v_mfma_f32_16x16x32_bf16 v[12:15], v[120:123], a[176:179], v[12:15]
    buffer_load_dwordx4 v[116:119], v2, s[44:47], s67 offen offset:2048
    v_mul_f32 v223, v39, v223
    v_exp_f32 v220, v220
    v_mfma_f32_16x16x32_bf16 v[16:19], v[120:123], a[180:183], v[16:19]
    v_exp_f32 v221, v221
    v_mfma_f32_16x16x32_bf16 v[20:23], v[120:123], a[184:187], v[20:23]
    v_exp_f32 v222, v222
    v_mfma_f32_16x16x32_bf16 v[24:27], v[120:123], a[188:191], v[24:27]
    v_exp_f32 v223, v223
    v_add_f32 v220, 1.0, v220
    v_mfma_f32_16x16x32_bf16 v[12:15], v[124:127], a[192:195], v[12:15]
    buffer_load_dwordx4 v[120:123], v2, s[44:47], s67 offen offset:3072
    v_add_f32 v221, 1.0, v221
    v_add_f32 v222, 1.0, v222
    v_add_f32 v223, 1.0, v223
    v_mfma_f32_16x16x32_bf16 v[16:19], v[124:127], a[196:199], v[16:19]
    v_rcp_f32 v220, v220
    v_mfma_f32_16x16x32_bf16 v[20:23], v[124:127], a[200:203], v[20:23]
    v_rcp_f32 v221, v221
    v_mfma_f32_16x16x32_bf16 v[24:27], v[124:127], a[204:207], v[24:27]
    v_rcp_f32 v222, v222
    v_rcp_f32 v223, v223
    v_mfma_f32_16x16x32_bf16 v[12:15], v[128:131], a[208:211], v[12:15]
    s_add_u32 s67, s66, 12288
    buffer_load_dwordx4 v[124:127], v2, s[44:47], s67 offen offset:0
    v_mul_f32 v220, v36, v220
    v_mul_f32 v221, v37, v221
    v_mfma_f32_16x16x32_bf16 v[16:19], v[128:131], a[212:215], v[16:19]
    v_mul_f32 v222, v38, v222
    v_mul_f32 v223, v39, v223
    v_mfma_f32_16x16x32_bf16 v[20:23], v[128:131], a[216:219], v[20:23]
    v_cvt_pk_bf16_f32 v228, v220, v221
    v_cvt_pk_bf16_f32 v229, v222, v223
    ds_write_b64 v9, v[228:229] offset:36864
    v_mfma_f32_16x16x32_bf16 v[24:27], v[128:131], a[220:223], v[24:27]
    v_fma_f32 v40, -v246, v252, v40
    v_fma_f32 v41, -v246, v253, v41
    v_fma_f32 v42, -v246, v254, v42
    v_mfma_f32_16x16x32_bf16 v[12:15], v[132:135], a[224:227], v[12:15]
    buffer_load_dwordx4 v[128:131], v2, s[44:47], s67 offen offset:1024
    v_fma_f32 v43, -v246, v255, v43
    v_mul_f32 v224, v40, v40
    v_mfma_f32_16x16x32_bf16 v[16:19], v[132:135], a[228:231], v[16:19]
    v_mul_f32 v225, v41, v41
    v_mul_f32 v226, v42, v42
    v_mul_f32 v227, v43, v43
    v_mfma_f32_16x16x32_bf16 v[20:23], v[132:135], a[232:235], v[20:23]
    v_fma_f32 v224, v224, v239, v238
    v_fma_f32 v225, v225, v239, v238
    v_mfma_f32_16x16x32_bf16 v[24:27], v[132:135], a[236:239], v[24:27]
    v_fma_f32 v226, v226, v239, v238
    v_fma_f32 v227, v227, v239, v238
    v_mul_f32 v224, v40, v224
    v_mfma_f32_16x16x32_bf16 v[12:15], v[136:139], a[240:243], v[12:15]
    buffer_load_dwordx4 v[132:135], v2, s[44:47], s67 offen offset:2048
    v_mul_f32 v225, v41, v225
    v_mul_f32 v226, v42, v226
    v_mfma_f32_16x16x32_bf16 v[16:19], v[136:139], a[244:247], v[16:19]
    v_mul_f32 v227, v43, v227
    v_exp_f32 v224, v224
    v_mfma_f32_16x16x32_bf16 v[20:23], v[136:139], a[248:251], v[20:23]
    v_exp_f32 v225, v225
    v_mfma_f32_16x16x32_bf16 v[24:27], v[136:139], a[252:255], v[24:27]
    v_exp_f32 v226, v226
    v_mfma_f32_16x16x32_bf16 v[12:15], v[140:143], v[44:47], v[12:15]
    buffer_load_dwordx4 v[136:139], v2, s[44:47], s67 offen offset:3072
    v_exp_f32 v227, v227
    v_add_f32 v224, 1.0, v224
    v_mfma_f32_16x16x32_bf16 v[16:19], v[140:143], v[48:51], v[16:19]
    v_add_f32 v225, 1.0, v225
    v_add_f32 v226, 1.0, v226
    v_add_f32 v227, 1.0, v227
    v_mfma_f32_16x16x32_bf16 v[20:23], v[140:143], v[52:55], v[20:23]
    v_rcp_f32 v224, v224
    v_mfma_f32_16x16x32_bf16 v[24:27], v[140:143], v[56:59], v[24:27]
    v_rcp_f32 v225, v225
    s_waitcnt vmcnt(35)
    v_mfma_f32_16x16x32_bf16 v[12:15], v[144:147], v[60:63], v[12:15]
    s_add_u32 s67, s66, 16384
    buffer_load_dwordx4 v[140:143], v2, s[44:47], s67 offen offset:0
    v_rcp_f32 v226, v226
    v_rcp_f32 v227, v227
    v_mfma_f32_16x16x32_bf16 v[16:19], v[144:147], v[64:67], v[16:19]
    v_mul_f32 v224, v40, v224
    v_mul_f32 v225, v41, v225
    v_mfma_f32_16x16x32_bf16 v[20:23], v[144:147], v[68:71], v[20:23]
    v_mul_f32 v226, v42, v226
    v_mul_f32 v227, v43, v227
    v_mfma_f32_16x16x32_bf16 v[24:27], v[144:147], v[72:75], v[24:27]
    v_cvt_pk_bf16_f32 v230, v224, v225
    v_cvt_pk_bf16_f32 v231, v226, v227
    ds_write_b64 v9, v[230:231] offset:55296
    s_waitcnt vmcnt(18)
    s_waitcnt lgkmcnt(0)
    s_barrier
    ds_read_b128 a[0:3], v11 offset:8192
    ds_read_b128 a[4:7], v11 offset:26624
    ds_read_b128 a[8:11], v11 offset:45056
    ds_read_b128 a[12:15], v11 offset:63488
    ds_read_b128 a[16:19], v11 offset:9216
    ds_read_b128 a[20:23], v11 offset:27648
    ds_read_b128 a[24:27], v11 offset:46080
    ds_read_b128 a[28:31], v11 offset:64512
    ds_read_b128 a[32:35], v11 offset:10240
    ds_read_b128 a[36:39], v11 offset:28672
    ds_read_b128 a[40:43], v11 offset:47104
    ds_read_b128 a[44:47], v10 offset:0
    s_lshl_b32 s15, s13, 11
    s_add_u32 s15, s15, s10
    s_add_u32 s13, s13, 1
    s_cmp_eq_u32 s13, 9
    s_cselect_b32 s13, 0, s13
    ds_read_b128 a[48:51], v11 offset:11264
    s_waitcnt lgkmcnt(12)
    v_mfma_f32_16x16x32_bf16 v[28:31], v[148:151], a[0:3], 0
    buffer_load_dwordx4 v[144:147], v2, s[44:47], s67 offen offset:1024
    ds_read_b128 a[52:55], v11 offset:29696
    s_waitcnt lgkmcnt(12)
    v_mfma_f32_16x16x32_bf16 v[32:35], v[148:151], a[4:7], 0
    ds_read_b128 a[56:59], v11 offset:48128
    s_waitcnt lgkmcnt(12)
    v_mfma_f32_16x16x32_bf16 v[36:39], v[148:151], a[8:11], 0
    ds_read_b128 a[60:63], v10 offset:1024
    s_waitcnt lgkmcnt(12)
    v_mfma_f32_16x16x32_bf16 v[40:43], v[148:151], a[12:15], 0
    ds_read_b128 a[64:67], v11 offset:12288
    s_waitcnt lgkmcnt(12)
    v_mfma_f32_16x16x32_bf16 v[28:31], v[152:155], a[16:19], v[28:31]
    s_add_u32 s65, s65, 1
    s_cmp_eq_u32 s65, 9
    s_cselect_b32 s65, 0, s65
    s_mul_i32 s66, s65, 18432
    s_add_u32 s66, s66, s64
    s_add_u32 s67, s66, 0
    buffer_load_dwordx4 v[148:151], v2, s[44:47], s67 offen offset:0
    v_fma_f32 v12, -v240, v248, v12
    v_fma_f32 v13, -v240, v249, v13
    v_fma_f32 v14, -v240, v250, v14
    v_fma_f32 v15, -v240, v251, v15
    ds_read_b128 a[68:71], v11 offset:30720
    s_waitcnt lgkmcnt(12)
    v_mfma_f32_16x16x32_bf16 v[32:35], v[152:155], a[20:23], v[32:35]
    v_mul_f32 v220, v12, v12
    v_mul_f32 v221, v13, v13
    v_mul_f32 v222, v14, v14
    v_mul_f32 v223, v15, v15
    ds_read_b128 a[72:75], v11 offset:49152
    s_waitcnt lgkmcnt(12)
    v_mfma_f32_16x16x32_bf16 v[36:39], v[152:155], a[24:27], v[36:39]
    v_fma_f32 v220, v220, v233, v232
    v_fma_f32 v221, v221, v233, v232
    v_fma_f32 v222, v222, v233, v232
    v_fma_f32 v223, v223, v233, v232
    ds_read_b128 a[76:79], v10 offset:2048
    s_waitcnt lgkmcnt(12)
    v_mfma_f32_16x16x32_bf16 v[40:43], v[152:155], a[28:31], v[40:43]
    v_mul_f32 v220, v12, v220
    v_mul_f32 v221, v13, v221
    v_mul_f32 v222, v14, v222
    v_mul_f32 v223, v15, v223
    ds_read_b128 a[80:83], v11 offset:13312
    s_waitcnt lgkmcnt(12)
    v_mfma_f32_16x16x32_bf16 v[28:31], v[156:159], a[32:35], v[28:31]
    buffer_load_dwordx4 v[152:155], v2, s[44:47], s67 offen offset:1024
    v_exp_f32 v220, v220
    v_exp_f32 v221, v221
    ds_read_b128 a[84:87], v11 offset:31744
    s_waitcnt lgkmcnt(12)
    v_mfma_f32_16x16x32_bf16 v[32:35], v[156:159], a[36:39], v[32:35]
    v_exp_f32 v222, v222
    v_exp_f32 v223, v223
    ds_read_b128 a[88:91], v11 offset:50176
    s_waitcnt lgkmcnt(12)
    v_mfma_f32_16x16x32_bf16 v[36:39], v[156:159], a[40:43], v[36:39]
    v_add_f32 v220, 1.0, v220
    v_add_f32 v221, 1.0, v221
    v_add_f32 v222, 1.0, v222
    ds_read_b128 a[92:95], v10 offset:3072
    s_waitcnt lgkmcnt(12)
    v_mfma_f32_16x16x32_bf16 v[40:43], v[156:159], a[44:47], v[40:43]
    v_add_f32 v223, 1.0, v223
    v_rcp_f32 v220, v220
    v_rcp_f32 v221, v221
    ds_read_b128 a[96:99], v11 offset:14336
    s_waitcnt lgkmcnt(12)
    v_mfma_f32_16x16x32_bf16 v[28:31], v[160:163], a[48:51], v[28:31]
    buffer_load_dwordx4 v[156:159], v2, s[44:47], s67 offen offset:2048
    v_rcp_f32 v222, v222
    v_rcp_f32 v223, v223
    ds_read_b128 a[100:103], v11 offset:32768
    s_waitcnt lgkmcnt(12)
    v_mfma_f32_16x16x32_bf16 v[32:35], v[160:163], a[52:55], v[32:35]
    v_mul_f32 v220, v12, v220
    v_mul_f32 v221, v13, v221
    v_mul_f32 v222, v14, v222
    ds_read_b128 a[104:107], v11 offset:51200
    s_waitcnt lgkmcnt(12)
    v_mfma_f32_16x16x32_bf16 v[36:39], v[160:163], a[56:59], v[36:39]
    v_mul_f32 v223, v15, v223
    v_cvt_pk_bf16_f32 v228, v220, v221
    v_cvt_pk_bf16_f32 v229, v222, v223
    ds_write_b64 v8, v[228:229] offset:0
    ds_read_b128 a[108:111], v10 offset:4096
    s_waitcnt lgkmcnt(13)
    v_mfma_f32_16x16x32_bf16 v[40:43], v[160:163], a[60:63], v[40:43]
    v_fma_f32 v16, -v242, v248, v16
    v_fma_f32 v17, -v242, v249, v17
    v_fma_f32 v18, -v242, v250, v18
    v_fma_f32 v19, -v242, v251, v19
    ds_read_b128 a[112:115], v11 offset:15360
    s_waitcnt lgkmcnt(13)
    v_mfma_f32_16x16x32_bf16 v[28:31], v[164:167], a[64:67], v[28:31]
    buffer_load_dwordx4 v[160:163], v2, s[44:47], s67 offen offset:3072
    v_mul_f32 v224, v16, v16
    v_mul_f32 v225, v17, v17
    v_mul_f32 v226, v18, v18
    v_mul_f32 v227, v19, v19
    ds_read_b128 a[116:119], v11 offset:33792
    s_waitcnt lgkmcnt(13)
    v_mfma_f32_16x16x32_bf16 v[32:35], v[164:167], a[68:71], v[32:35]
    v_fma_f32 v224, v224, v235, v234
    v_fma_f32 v225, v225, v235, v234
    v_fma_f32 v226, v226, v235, v234
    v_fma_f32 v227, v227, v235, v234
    ds_read_b128 a[120:123], v11 offset:52224
    s_waitcnt lgkmcnt(13)
    v_mfma_f32_16x16x32_bf16 v[36:39], v[164:167], a[72:75], v[36:39]
    v_mul_f32 v224, v16, v224
    v_mul_f32 v225, v17, v225
    v_mul_f32 v226, v18, v226
    v_mul_f32 v227, v19, v227
    ds_read_b128 a[124:127], v10 offset:5120
    s_waitcnt lgkmcnt(13)
    v_mfma_f32_16x16x32_bf16 v[40:43], v[164:167], a[76:79], v[40:43]
    v_exp_f32 v224, v224
    v_exp_f32 v225, v225
    ds_read_b128 a[128:131], v11 offset:16384
    s_waitcnt lgkmcnt(13)
    v_mfma_f32_16x16x32_bf16 v[28:31], v[168:171], a[80:83], v[28:31]
    s_add_u32 s67, s66, 4096
    buffer_load_dwordx4 v[164:167], v2, s[44:47], s67 offen offset:0
    v_exp_f32 v226, v226
    v_exp_f32 v227, v227
    ds_read_b128 a[132:135], v11 offset:34816
    s_waitcnt lgkmcnt(13)
    v_mfma_f32_16x16x32_bf16 v[32:35], v[168:171], a[84:87], v[32:35]
    v_add_f32 v224, 1.0, v224
    v_add_f32 v225, 1.0, v225
    v_add_f32 v226, 1.0, v226
    ds_read_b128 a[136:139], v11 offset:53248
    s_waitcnt lgkmcnt(13)
    v_mfma_f32_16x16x32_bf16 v[36:39], v[168:171], a[88:91], v[36:39]
    v_add_f32 v227, 1.0, v227
    v_rcp_f32 v224, v224
    v_rcp_f32 v225, v225
    ds_read_b128 a[140:143], v10 offset:6144
    s_waitcnt lgkmcnt(13)
    v_mfma_f32_16x16x32_bf16 v[40:43], v[168:171], a[92:95], v[40:43]
    v_rcp_f32 v226, v226
    v_rcp_f32 v227, v227
    ds_read_b128 a[144:147], v11 offset:17408
    s_waitcnt lgkmcnt(13)
    v_mfma_f32_16x16x32_bf16 v[28:31], v[172:175], a[96:99], v[28:31]
    buffer_load_dwordx4 v[168:171], v2, s[44:47], s67 offen offset:1024
    v_mul_f32 v224, v16, v224
    v_mul_f32 v225, v17, v225
    v_mul_f32 v226, v18, v226
    ds_read_b128 a[148:151], v11 offset:35840
    s_waitcnt lgkmcnt(13)
    v_mfma_f32_16x16x32_bf16 v[32:35], v[172:175], a[100:103], v[32:35]
    v_mul_f32 v227, v19, v227
    v_cvt_pk_bf16_f32 v230, v224, v225
    v_cvt_pk_bf16_f32 v231, v226, v227
    ds_write_b64 v8, v[230:231] offset:18432
    ds_read_b128 a[152:155], v11 offset:54272
    s_waitcnt lgkmcnt(14)
    v_mfma_f32_16x16x32_bf16 v[36:39], v[172:175], a[104:107], v[36:39]
    v_fma_f32 v20, -v244, v248, v20
    v_fma_f32 v21, -v244, v249, v21
    v_fma_f32 v22, -v244, v250, v22
    v_fma_f32 v23, -v244, v251, v23
    ds_read_b128 a[156:159], v10 offset:7168
    s_waitcnt lgkmcnt(13)
    v_mfma_f32_16x16x32_bf16 v[40:43], v[172:175], a[108:111], v[40:43]
    v_mul_f32 v220, v20, v20
    v_mul_f32 v221, v21, v21
    v_mul_f32 v222, v22, v22
    v_mul_f32 v223, v23, v23
    ds_read_b128 a[160:163], v11 offset:18432
    s_waitcnt lgkmcnt(13)
    v_mfma_f32_16x16x32_bf16 v[28:31], v[176:179], a[112:115], v[28:31]
    buffer_load_dwordx4 v[172:175], v2, s[44:47], s67 offen offset:2048
    v_fma_f32 v220, v220, v237, v236
    v_fma_f32 v221, v221, v237, v236
    v_fma_f32 v222, v222, v237, v236
    v_fma_f32 v223, v223, v237, v236
    ds_read_b128 a[164:167], v11 offset:36864
    s_waitcnt lgkmcnt(13)
    v_mfma_f32_16x16x32_bf16 v[32:35], v[176:179], a[116:119], v[32:35]
    v_mul_f32 v220, v20, v220
    v_mul_f32 v221, v21, v221
    v_mul_f32 v222, v22, v222
    v_mul_f32 v223, v23, v223
    ds_read_b128 a[168:171], v11 offset:55296
    s_waitcnt lgkmcnt(13)
    v_mfma_f32_16x16x32_bf16 v[36:39], v[176:179], a[120:123], v[36:39]
    v_exp_f32 v220, v220
    v_exp_f32 v221, v221
    ds_read_b128 a[172:175], v10 offset:8192
    s_waitcnt lgkmcnt(13)
    v_mfma_f32_16x16x32_bf16 v[40:43], v[176:179], a[124:127], v[40:43]
    v_exp_f32 v222, v222
    v_exp_f32 v223, v223
    ds_read_b128 a[176:179], v11 offset:19456
    s_waitcnt lgkmcnt(13)
    v_mfma_f32_16x16x32_bf16 v[28:31], v[180:183], a[128:131], v[28:31]
    buffer_load_dwordx4 v[176:179], v2, s[44:47], s67 offen offset:3072
    v_add_f32 v220, 1.0, v220
    v_add_f32 v221, 1.0, v221
    v_add_f32 v222, 1.0, v222
    ds_read_b128 a[180:183], v11 offset:37888
    s_waitcnt lgkmcnt(13)
    v_mfma_f32_16x16x32_bf16 v[32:35], v[180:183], a[132:135], v[32:35]
    v_add_f32 v223, 1.0, v223
    v_rcp_f32 v220, v220
    v_rcp_f32 v221, v221
    ds_read_b128 a[184:187], v11 offset:56320
    s_waitcnt lgkmcnt(13)
    v_mfma_f32_16x16x32_bf16 v[36:39], v[180:183], a[136:139], v[36:39]
    v_rcp_f32 v222, v222
    v_rcp_f32 v223, v223
    ds_read_b128 a[188:191], v10 offset:9216
    s_waitcnt lgkmcnt(13)
    v_mfma_f32_16x16x32_bf16 v[40:43], v[180:183], a[140:143], v[40:43]
    v_mul_f32 v220, v20, v220
    v_mul_f32 v221, v21, v221
    v_mul_f32 v222, v22, v222
    ds_read_b128 a[192:195], v11 offset:20480
    s_waitcnt lgkmcnt(13)
    v_mfma_f32_16x16x32_bf16 v[28:31], v[184:187], a[144:147], v[28:31]
    s_add_u32 s67, s66, 8192
    buffer_load_dwordx4 v[180:183], v2, s[44:47], s67 offen offset:0
    v_mul_f32 v223, v23, v223
    v_cvt_pk_bf16_f32 v228, v220, v221
    v_cvt_pk_bf16_f32 v229, v222, v223
    ds_write_b64 v8, v[228:229] offset:36864
    ds_read_b128 a[196:199], v11 offset:38912
    s_waitcnt lgkmcnt(14)
    v_mfma_f32_16x16x32_bf16 v[32:35], v[184:187], a[148:151], v[32:35]
    v_fma_f32 v24, -v246, v248, v24
    v_fma_f32 v25, -v246, v249, v25
    v_fma_f32 v26, -v246, v250, v26
    v_fma_f32 v27, -v246, v251, v27
    ds_read_b128 a[200:203], v11 offset:57344
    s_waitcnt lgkmcnt(13)
    v_mfma_f32_16x16x32_bf16 v[36:39], v[184:187], a[152:155], v[36:39]
    v_mul_f32 v224, v24, v24
    v_mul_f32 v225, v25, v25
    v_mul_f32 v226, v26, v26
    v_mul_f32 v227, v27, v27
    ds_read_b128 a[204:207], v10 offset:10240
    s_waitcnt lgkmcnt(13)
    v_mfma_f32_16x16x32_bf16 v[40:43], v[184:187], a[156:159], v[40:43]
    v_fma_f32 v224, v224, v239, v238
    v_fma_f32 v225, v225, v239, v238
    v_fma_f32 v226, v226, v239, v238
    v_fma_f32 v227, v227, v239, v238
    ds_read_b128 a[208:211], v11 offset:21504
    s_waitcnt lgkmcnt(13)
    v_mfma_f32_16x16x32_bf16 v[28:31], v[188:191], a[160:163], v[28:31]
    buffer_load_dwordx4 v[184:187], v2, s[44:47], s67 offen offset:1024
    v_mul_f32 v224, v24, v224
    v_mul_f32 v225, v25, v225
    v_mul_f32 v226, v26, v226
    v_mul_f32 v227, v27, v227
    ds_read_b128 a[212:215], v11 offset:39936
    s_waitcnt lgkmcnt(13)
    v_mfma_f32_16x16x32_bf16 v[32:35], v[188:191], a[164:167], v[32:35]
    v_exp_f32 v224, v224
    v_exp_f32 v225, v225
    ds_read_b128 a[216:219], v11 offset:58368
    s_waitcnt lgkmcnt(13)
    v_mfma_f32_16x16x32_bf16 v[36:39], v[188:191], a[168:171], v[36:39]
    v_exp_f32 v226, v226
    v_exp_f32 v227, v227
    ds_read_b128 a[220:223], v10 offset:11264
    s_waitcnt lgkmcnt(13)
    v_mfma_f32_16x16x32_bf16 v[40:43], v[188:191], a[172:175], v[40:43]
    v_add_f32 v224, 1.0, v224
    v_add_f32 v225, 1.0, v225
    v_add_f32 v226, 1.0, v226
    ds_read_b128 a[224:227], v11 offset:22528
    s_waitcnt lgkmcnt(13)
    v_mfma_f32_16x16x32_bf16 v[28:31], v[192:195], a[176:179], v[28:31]
    buffer_load_dwordx4 v[188:191], v2, s[44:47], s67 offen offset:2048
    v_add_f32 v227, 1.0, v227
    v_rcp_f32 v224, v224
    v_rcp_f32 v225, v225
    ds_read_b128 a[228:231], v11 offset:40960
    s_waitcnt lgkmcnt(13)
    v_mfma_f32_16x16x32_bf16 v[32:35], v[192:195], a[180:183], v[32:35]
    v_rcp_f32 v226, v226
    v_rcp_f32 v227, v227
    ds_read_b128 a[232:235], v11 offset:59392
    s_waitcnt lgkmcnt(13)
    v_mfma_f32_16x16x32_bf16 v[36:39], v[192:195], a[184:187], v[36:39]
    v_mul_f32 v224, v24, v224
    v_mul_f32 v225, v25, v225
    v_mul_f32 v226, v26, v226
    ds_read_b128 a[236:239], v10 offset:12288
    s_waitcnt lgkmcnt(13)
    v_mfma_f32_16x16x32_bf16 v[40:43], v[192:195], a[188:191], v[40:43]
    v_mul_f32 v227, v27, v227
    v_cvt_pk_bf16_f32 v230, v224, v225
    v_cvt_pk_bf16_f32 v231, v226, v227
    ds_write_b64 v8, v[230:231] offset:55296
    ds_read_b128 a[240:243], v11 offset:23552
    s_waitcnt lgkmcnt(14)
    v_mfma_f32_16x16x32_bf16 v[28:31], v[196:199], a[192:195], v[28:31]
    buffer_load_dwordx4 v[192:195], v2, s[44:47], s67 offen offset:3072
    ds_read_b128 a[244:247], v11 offset:41984
    s_waitcnt lgkmcnt(13)
    v_mfma_f32_16x16x32_bf16 v[32:35], v[196:199], a[196:199], v[32:35]
    ds_read_b128 a[248:251], v11 offset:60416
    s_waitcnt lgkmcnt(13)
    v_mfma_f32_16x16x32_bf16 v[36:39], v[196:199], a[200:203], v[36:39]
    ds_read_b128 a[252:255], v10 offset:13312
    s_waitcnt lgkmcnt(13)
    v_mfma_f32_16x16x32_bf16 v[40:43], v[196:199], a[204:207], v[40:43]
    s_waitcnt lgkmcnt(4)
    s_barrier
    ds_read_b128 v[44:47], v11 offset:24576
    v_mfma_f32_16x16x32_bf16 v[28:31], v[200:203], a[208:211], v[28:31]
    s_add_u32 s67, s66, 12288
    buffer_load_dwordx4 v[196:199], v2, s[44:47], s67 offen offset:0
    ds_read_b128 v[48:51], v11 offset:43008
    v_mfma_f32_16x16x32_bf16 v[32:35], v[200:203], a[212:215], v[32:35]
    ds_read_b128 v[52:55], v11 offset:61440
    v_mfma_f32_16x16x32_bf16 v[36:39], v[200:203], a[216:219], v[36:39]
    ds_read_b128 v[56:59], v10 offset:14336
    v_mfma_f32_16x16x32_bf16 v[40:43], v[200:203], a[220:223], v[40:43]
    ds_read_b128 v[60:63], v11 offset:25600
    v_mfma_f32_16x16x32_bf16 v[28:31], v[204:207], a[224:227], v[28:31]
    buffer_load_dwordx4 v[200:203], v2, s[44:47], s67 offen offset:1024
    ds_read_b128 v[64:67], v11 offset:44032
    v_mfma_f32_16x16x32_bf16 v[32:35], v[204:207], a[228:231], v[32:35]
    ds_read_b128 v[68:71], v11 offset:62464
    v_mfma_f32_16x16x32_bf16 v[36:39], v[204:207], a[232:235], v[36:39]
    ds_read_b128 v[72:75], v10 offset:15360
    v_mfma_f32_16x16x32_bf16 v[40:43], v[204:207], a[236:239], v[40:43]
    s_waitcnt lgkmcnt(11)
    v_mfma_f32_16x16x32_bf16 v[28:31], v[208:211], a[240:243], v[28:31]
    buffer_load_dwordx4 v[204:207], v2, s[44:47], s67 offen offset:2048
    s_waitcnt lgkmcnt(10)
    v_mfma_f32_16x16x32_bf16 v[32:35], v[208:211], a[244:247], v[32:35]
    s_waitcnt lgkmcnt(9)
    v_mfma_f32_16x16x32_bf16 v[36:39], v[208:211], a[248:251], v[36:39]
    s_waitcnt lgkmcnt(8)
    v_mfma_f32_16x16x32_bf16 v[40:43], v[208:211], a[252:255], v[40:43]
    s_waitcnt lgkmcnt(7)
    v_mfma_f32_16x16x32_bf16 v[28:31], v[212:215], v[44:47], v[28:31]
    buffer_load_dwordx4 v[208:211], v2, s[44:47], s67 offen offset:3072
    s_waitcnt lgkmcnt(6)
    v_mfma_f32_16x16x32_bf16 v[32:35], v[212:215], v[48:51], v[32:35]
    s_waitcnt lgkmcnt(5)
    v_mfma_f32_16x16x32_bf16 v[36:39], v[212:215], v[52:55], v[36:39]
    s_waitcnt lgkmcnt(4)
    v_mfma_f32_16x16x32_bf16 v[40:43], v[212:215], v[56:59], v[40:43]
    s_waitcnt vmcnt(34)
    s_waitcnt lgkmcnt(3)
    v_mfma_f32_16x16x32_bf16 v[28:31], v[216:219], v[60:63], v[28:31]
    s_add_u32 s67, s66, 16384
    buffer_load_dwordx4 v[212:215], v2, s[44:47], s67 offen offset:0
    s_waitcnt lgkmcnt(2)
    v_mfma_f32_16x16x32_bf16 v[32:35], v[216:219], v[64:67], v[32:35]
    s_waitcnt lgkmcnt(1)
    v_mfma_f32_16x16x32_bf16 v[36:39], v[216:219], v[68:71], v[36:39]
    s_waitcnt lgkmcnt(0)
    v_mfma_f32_16x16x32_bf16 v[40:43], v[216:219], v[72:75], v[40:43]
    s_mov_b32 s9, 0
L_kg_ker_lp_29:
    s_lshl_b32 s14, s13, 11
    s_add_u32 s14, s14, s10
    s_add_u32 s13, s13, 1
    s_cmp_eq_u32 s13, 9
    s_cselect_b32 s13, 0, s13
    s_waitcnt vmcnt(34)
    v_mfma_f32_16x16x32_bf16 v[12:15], v[76:79], a[0:3], 0
    buffer_load_dwordx4 v[216:219], v2, s[44:47], s67 offen offset:1024
    v_mfma_f32_16x16x32_bf16 v[16:19], v[76:79], a[4:7], 0
    v_mfma_f32_16x16x32_bf16 v[20:23], v[76:79], a[8:11], 0
    v_mfma_f32_16x16x32_bf16 v[24:27], v[76:79], a[12:15], 0
    s_waitcnt vmcnt(34)
    v_mfma_f32_16x16x32_bf16 v[12:15], v[80:83], a[16:19], v[12:15]
    s_add_u32 s65, s65, 1
    s_cmp_eq_u32 s65, 9
    s_cselect_b32 s65, 0, s65
    s_mul_i32 s66, s65, 18432
    s_add_u32 s66, s66, s64
    s_add_u32 s67, s66, 0
    buffer_load_dwordx4 v[76:79], v2, s[44:47], s67 offen offset:0
    v_mfma_f32_16x16x32_bf16 v[16:19], v[80:83], a[20:23], v[16:19]
    v_cvt_pk_bf16_f32 v220, v28, v29
    v_mfma_f32_16x16x32_bf16 v[20:23], v[80:83], a[24:27], v[20:23]
    v_mfma_f32_16x16x32_bf16 v[24:27], v[80:83], a[28:31], v[24:27]
    v_cvt_pk_bf16_f32 v221, v30, v31
    s_waitcnt vmcnt(34)
    v_mfma_f32_16x16x32_bf16 v[12:15], v[84:87], a[32:35], v[12:15]
    buffer_load_dwordx4 v[80:83], v2, s[44:47], s67 offen offset:1024
    v_mfma_f32_16x16x32_bf16 v[16:19], v[84:87], a[36:39], v[16:19]
    v_cvt_pk_bf16_f32 v222, v32, v33
    v_mfma_f32_16x16x32_bf16 v[20:23], v[84:87], a[40:43], v[20:23]
    v_mfma_f32_16x16x32_bf16 v[24:27], v[84:87], a[44:47], v[24:27]
    s_waitcnt vmcnt(34)
    v_mfma_f32_16x16x32_bf16 v[12:15], v[88:91], a[48:51], v[12:15]
    buffer_load_dwordx4 v[84:87], v2, s[44:47], s67 offen offset:2048
    v_cvt_pk_bf16_f32 v223, v34, v35
    v_mfma_f32_16x16x32_bf16 v[16:19], v[88:91], a[52:55], v[16:19]
    v_mfma_f32_16x16x32_bf16 v[20:23], v[88:91], a[56:59], v[20:23]
    v_cvt_pk_bf16_f32 v224, v36, v37
    v_mfma_f32_16x16x32_bf16 v[24:27], v[88:91], a[60:63], v[24:27]
    s_waitcnt vmcnt(34)
    v_mfma_f32_16x16x32_bf16 v[12:15], v[92:95], a[64:67], v[12:15]
    buffer_load_dwordx4 v[88:91], v2, s[44:47], s67 offen offset:3072
    v_mfma_f32_16x16x32_bf16 v[16:19], v[92:95], a[68:71], v[16:19]
    v_cvt_pk_bf16_f32 v225, v38, v39
    v_mfma_f32_16x16x32_bf16 v[20:23], v[92:95], a[72:75], v[20:23]
    v_mfma_f32_16x16x32_bf16 v[24:27], v[92:95], a[76:79], v[24:27]
    v_cvt_pk_bf16_f32 v226, v40, v41
    s_waitcnt vmcnt(34)
    v_mfma_f32_16x16x32_bf16 v[12:15], v[96:99], a[80:83], v[12:15]
    s_add_u32 s67, s66, 4096
    buffer_load_dwordx4 v[92:95], v2, s[44:47], s67 offen offset:0
    v_mfma_f32_16x16x32_bf16 v[16:19], v[96:99], a[84:87], v[16:19]
    v_cvt_pk_bf16_f32 v227, v42, v43
    v_mfma_f32_16x16x32_bf16 v[20:23], v[96:99], a[88:91], v[20:23]
    v_mfma_f32_16x16x32_bf16 v[24:27], v[96:99], a[92:95], v[24:27]
    s_waitcnt vmcnt(34)
    v_mfma_f32_16x16x32_bf16 v[12:15], v[100:103], a[96:99], v[12:15]
    buffer_load_dwordx4 v[96:99], v2, s[44:47], s67 offen offset:1024
    buffer_store_dwordx4 v[220:223], v2, s[56:59], s15 offen sc1
    v_mfma_f32_16x16x32_bf16 v[16:19], v[100:103], a[100:103], v[16:19]
    v_mfma_f32_16x16x32_bf16 v[20:23], v[100:103], a[104:107], v[20:23]
    buffer_store_dwordx4 v[224:227], v2, s[56:59], s15 offen offset:1024 sc1
    v_mfma_f32_16x16x32_bf16 v[24:27], v[100:103], a[108:111], v[24:27]
    s_waitcnt vmcnt(36)
    v_mfma_f32_16x16x32_bf16 v[12:15], v[104:107], a[112:115], v[12:15]
    buffer_load_dwordx4 v[100:103], v2, s[44:47], s67 offen offset:2048
    v_mfma_f32_16x16x32_bf16 v[16:19], v[104:107], a[116:119], v[16:19]
    v_mfma_f32_16x16x32_bf16 v[20:23], v[104:107], a[120:123], v[20:23]
    v_mfma_f32_16x16x32_bf16 v[24:27], v[104:107], a[124:127], v[24:27]
    s_waitcnt vmcnt(36)
    v_mfma_f32_16x16x32_bf16 v[12:15], v[108:111], a[128:131], v[12:15]
    buffer_load_dwordx4 v[104:107], v2, s[44:47], s67 offen offset:3072
    v_mfma_f32_16x16x32_bf16 v[16:19], v[108:111], a[132:135], v[16:19]
    v_mfma_f32_16x16x32_bf16 v[20:23], v[108:111], a[136:139], v[20:23]
    v_mfma_f32_16x16x32_bf16 v[24:27], v[108:111], a[140:143], v[24:27]
    s_waitcnt vmcnt(36)
    v_mfma_f32_16x16x32_bf16 v[12:15], v[112:115], a[144:147], v[12:15]
    s_add_u32 s67, s66, 8192
    buffer_load_dwordx4 v[108:111], v2, s[44:47], s67 offen offset:0
    v_mfma_f32_16x16x32_bf16 v[16:19], v[112:115], a[148:151], v[16:19]
    v_mfma_f32_16x16x32_bf16 v[20:23], v[112:115], a[152:155], v[20:23]
    v_mfma_f32_16x16x32_bf16 v[24:27], v[112:115], a[156:159], v[24:27]
    s_waitcnt vmcnt(36)
    v_mfma_f32_16x16x32_bf16 v[12:15], v[116:119], a[160:163], v[12:15]
    buffer_load_dwordx4 v[112:115], v2, s[44:47], s67 offen offset:1024
    v_mfma_f32_16x16x32_bf16 v[16:19], v[116:119], a[164:167], v[16:19]
    v_mfma_f32_16x16x32_bf16 v[20:23], v[116:119], a[168:171], v[20:23]
    v_mfma_f32_16x16x32_bf16 v[24:27], v[116:119], a[172:175], v[24:27]
    s_waitcnt vmcnt(36)
    v_mfma_f32_16x16x32_bf16 v[12:15], v[120:123], a[176:179], v[12:15]
    buffer_load_dwordx4 v[116:119], v2, s[44:47], s67 offen offset:2048
    v_mfma_f32_16x16x32_bf16 v[16:19], v[120:123], a[180:183], v[16:19]
    v_mfma_f32_16x16x32_bf16 v[20:23], v[120:123], a[184:187], v[20:23]
    v_mfma_f32_16x16x32_bf16 v[24:27], v[120:123], a[188:191], v[24:27]
    s_waitcnt vmcnt(36)
    v_mfma_f32_16x16x32_bf16 v[12:15], v[124:127], a[192:195], v[12:15]
    buffer_load_dwordx4 v[120:123], v2, s[44:47], s67 offen offset:3072
    v_mfma_f32_16x16x32_bf16 v[16:19], v[124:127], a[196:199], v[16:19]
    v_mfma_f32_16x16x32_bf16 v[20:23], v[124:127], a[200:203], v[20:23]
    v_mfma_f32_16x16x32_bf16 v[24:27], v[124:127], a[204:207], v[24:27]
    s_waitcnt vmcnt(36)
    v_mfma_f32_16x16x32_bf16 v[12:15], v[128:131], a[208:211], v[12:15]
    s_add_u32 s67, s66, 12288
    buffer_load_dwordx4 v[124:127], v2, s[44:47], s67 offen offset:0
    v_mfma_f32_16x16x32_bf16 v[16:19], v[128:131], a[212:215], v[16:19]
    v_mfma_f32_16x16x32_bf16 v[20:23], v[128:131], a[216:219], v[20:23]
    v_mfma_f32_16x16x32_bf16 v[24:27], v[128:131], a[220:223], v[24:27]
    s_waitcnt vmcnt(36)
    v_mfma_f32_16x16x32_bf16 v[12:15], v[132:135], a[224:227], v[12:15]
    buffer_load_dwordx4 v[128:131], v2, s[44:47], s67 offen offset:1024
    v_mfma_f32_16x16x32_bf16 v[16:19], v[132:135], a[228:231], v[16:19]
    v_mfma_f32_16x16x32_bf16 v[20:23], v[132:135], a[232:235], v[20:23]
    v_mfma_f32_16x16x32_bf16 v[24:27], v[132:135], a[236:239], v[24:27]
    s_waitcnt vmcnt(36)
    v_mfma_f32_16x16x32_bf16 v[12:15], v[136:139], a[240:243], v[12:15]
    buffer_load_dwordx4 v[132:135], v2, s[44:47], s67 offen offset:2048
    v_mfma_f32_16x16x32_bf16 v[16:19], v[136:139], a[244:247], v[16:19]
    v_mfma_f32_16x16x32_bf16 v[20:23], v[136:139], a[248:251], v[20:23]
    v_mfma_f32_16x16x32_bf16 v[24:27], v[136:139], a[252:255], v[24:27]
    s_waitcnt vmcnt(36)
    v_mfma_f32_16x16x32_bf16 v[12:15], v[140:143], v[44:47], v[12:15]
    buffer_load_dwordx4 v[136:139], v2, s[44:47], s67 offen offset:3072
    v_mfma_f32_16x16x32_bf16 v[16:19], v[140:143], v[48:51], v[16:19]
    v_mfma_f32_16x16x32_bf16 v[20:23], v[140:143], v[52:55], v[20:23]
    v_mfma_f32_16x16x32_bf16 v[24:27], v[140:143], v[56:59], v[24:27]
    s_waitcnt vmcnt(36)
    v_mfma_f32_16x16x32_bf16 v[12:15], v[144:147], v[60:63], v[12:15]
    s_add_u32 s67, s66, 16384
    buffer_load_dwordx4 v[140:143], v2, s[44:47], s67 offen offset:0
    v_mfma_f32_16x16x32_bf16 v[16:19], v[144:147], v[64:67], v[16:19]
    v_mfma_f32_16x16x32_bf16 v[20:23], v[144:147], v[68:71], v[20:23]
    v_mfma_f32_16x16x32_bf16 v[24:27], v[144:147], v[72:75], v[24:27]
    s_lshl_b32 s15, s13, 11
    s_add_u32 s15, s15, s10
    s_add_u32 s13, s13, 1
    s_cmp_eq_u32 s13, 9
    s_cselect_b32 s13, 0, s13
    s_waitcnt vmcnt(36)
    v_mfma_f32_16x16x32_bf16 v[28:31], v[148:151], a[0:3], 0
    buffer_load_dwordx4 v[144:147], v2, s[44:47], s67 offen offset:1024
    v_mfma_f32_16x16x32_bf16 v[32:35], v[148:151], a[4:7], 0
    v_mfma_f32_16x16x32_bf16 v[36:39], v[148:151], a[8:11], 0
    v_mfma_f32_16x16x32_bf16 v[40:43], v[148:151], a[12:15], 0
    s_waitcnt vmcnt(36)
    v_mfma_f32_16x16x32_bf16 v[28:31], v[152:155], a[16:19], v[28:31]
    s_add_u32 s65, s65, 1
    s_cmp_eq_u32 s65, 9
    s_cselect_b32 s65, 0, s65
    s_mul_i32 s66, s65, 18432
    s_add_u32 s66, s66, s64
    s_add_u32 s67, s66, 0
    buffer_load_dwordx4 v[148:151], v2, s[44:47], s67 offen offset:0
    v_mfma_f32_16x16x32_bf16 v[32:35], v[152:155], a[20:23], v[32:35]
    v_cvt_pk_bf16_f32 v220, v12, v13
    v_mfma_f32_16x16x32_bf16 v[36:39], v[152:155], a[24:27], v[36:39]
    v_mfma_f32_16x16x32_bf16 v[40:43], v[152:155], a[28:31], v[40:43]
    v_cvt_pk_bf16_f32 v221, v14, v15
    s_waitcnt vmcnt(36)
    v_mfma_f32_16x16x32_bf16 v[28:31], v[156:159], a[32:35], v[28:31]
    buffer_load_dwordx4 v[152:155], v2, s[44:47], s67 offen offset:1024
    v_mfma_f32_16x16x32_bf16 v[32:35], v[156:159], a[36:39], v[32:35]
    v_cvt_pk_bf16_f32 v222, v16, v17
    v_mfma_f32_16x16x32_bf16 v[36:39], v[156:159], a[40:43], v[36:39]
    v_mfma_f32_16x16x32_bf16 v[40:43], v[156:159], a[44:47], v[40:43]
    s_waitcnt vmcnt(36)
    v_mfma_f32_16x16x32_bf16 v[28:31], v[160:163], a[48:51], v[28:31]
    buffer_load_dwordx4 v[156:159], v2, s[44:47], s67 offen offset:2048
    v_cvt_pk_bf16_f32 v223, v18, v19
    v_mfma_f32_16x16x32_bf16 v[32:35], v[160:163], a[52:55], v[32:35]
    v_mfma_f32_16x16x32_bf16 v[36:39], v[160:163], a[56:59], v[36:39]
    v_cvt_pk_bf16_f32 v224, v20, v21
    v_mfma_f32_16x16x32_bf16 v[40:43], v[160:163], a[60:63], v[40:43]
    s_waitcnt vmcnt(36)
    v_mfma_f32_16x16x32_bf16 v[28:31], v[164:167], a[64:67], v[28:31]
    buffer_load_dwordx4 v[160:163], v2, s[44:47], s67 offen offset:3072
    v_mfma_f32_16x16x32_bf16 v[32:35], v[164:167], a[68:71], v[32:35]
    v_cvt_pk_bf16_f32 v225, v22, v23
    v_mfma_f32_16x16x32_bf16 v[36:39], v[164:167], a[72:75], v[36:39]
    v_mfma_f32_16x16x32_bf16 v[40:43], v[164:167], a[76:79], v[40:43]
    v_cvt_pk_bf16_f32 v226, v24, v25
    s_waitcnt vmcnt(36)
    v_mfma_f32_16x16x32_bf16 v[28:31], v[168:171], a[80:83], v[28:31]
    s_add_u32 s67, s66, 4096
    buffer_load_dwordx4 v[164:167], v2, s[44:47], s67 offen offset:0
    v_mfma_f32_16x16x32_bf16 v[32:35], v[168:171], a[84:87], v[32:35]
    v_cvt_pk_bf16_f32 v227, v26, v27
    v_mfma_f32_16x16x32_bf16 v[36:39], v[168:171], a[88:91], v[36:39]
    v_mfma_f32_16x16x32_bf16 v[40:43], v[168:171], a[92:95], v[40:43]
    s_waitcnt vmcnt(36)
    v_mfma_f32_16x16x32_bf16 v[28:31], v[172:175], a[96:99], v[28:31]
    buffer_load_dwordx4 v[168:171], v2, s[44:47], s67 offen offset:1024
    buffer_store_dwordx4 v[220:223], v2, s[56:59], s14 offen sc1
    v_mfma_f32_16x16x32_bf16 v[32:35], v[172:175], a[100:103], v[32:35]
    v_mfma_f32_16x16x32_bf16 v[36:39], v[172:175], a[104:107], v[36:39]
    buffer_store_dwordx4 v[224:227], v2, s[56:59], s14 offen offset:1024 sc1
    v_mfma_f32_16x16x32_bf16 v[40:43], v[172:175], a[108:111], v[40:43]
    s_waitcnt vmcnt(38)
    v_mfma_f32_16x16x32_bf16 v[28:31], v[176:179], a[112:115], v[28:31]
    buffer_load_dwordx4 v[172:175], v2, s[44:47], s67 offen offset:2048
    v_mfma_f32_16x16x32_bf16 v[32:35], v[176:179], a[116:119], v[32:35]
    v_mfma_f32_16x16x32_bf16 v[36:39], v[176:179], a[120:123], v[36:39]
    v_mfma_f32_16x16x32_bf16 v[40:43], v[176:179], a[124:127], v[40:43]
    s_waitcnt vmcnt(38)
    v_mfma_f32_16x16x32_bf16 v[28:31], v[180:183], a[128:131], v[28:31]
    buffer_load_dwordx4 v[176:179], v2, s[44:47], s67 offen offset:3072
    v_mfma_f32_16x16x32_bf16 v[32:35], v[180:183], a[132:135], v[32:35]
    v_mfma_f32_16x16x32_bf16 v[36:39], v[180:183], a[136:139], v[36:39]
    v_mfma_f32_16x16x32_bf16 v[40:43], v[180:183], a[140:143], v[40:43]
    s_waitcnt vmcnt(38)
    v_mfma_f32_16x16x32_bf16 v[28:31], v[184:187], a[144:147], v[28:31]
    s_add_u32 s67, s66, 8192
    buffer_load_dwordx4 v[180:183], v2, s[44:47], s67 offen offset:0
    v_mfma_f32_16x16x32_bf16 v[32:35], v[184:187], a[148:151], v[32:35]
    v_mfma_f32_16x16x32_bf16 v[36:39], v[184:187], a[152:155], v[36:39]
    v_mfma_f32_16x16x32_bf16 v[40:43], v[184:187], a[156:159], v[40:43]
    s_waitcnt vmcnt(38)
    v_mfma_f32_16x16x32_bf16 v[28:31], v[188:191], a[160:163], v[28:31]
    buffer_load_dwordx4 v[184:187], v2, s[44:47], s67 offen offset:1024
    v_mfma_f32_16x16x32_bf16 v[32:35], v[188:191], a[164:167], v[32:35]
    v_mfma_f32_16x16x32_bf16 v[36:39], v[188:191], a[168:171], v[36:39]
    v_mfma_f32_16x16x32_bf16 v[40:43], v[188:191], a[172:175], v[40:43]
    s_waitcnt vmcnt(38)
    v_mfma_f32_16x16x32_bf16 v[28:31], v[192:195], a[176:179], v[28:31]
    buffer_load_dwordx4 v[188:191], v2, s[44:47], s67 offen offset:2048
    v_mfma_f32_16x16x32_bf16 v[32:35], v[192:195], a[180:183], v[32:35]
    v_mfma_f32_16x16x32_bf16 v[36:39], v[192:195], a[184:187], v[36:39]
    v_mfma_f32_16x16x32_bf16 v[40:43], v[192:195], a[188:191], v[40:43]
    s_waitcnt vmcnt(38)
    v_mfma_f32_16x16x32_bf16 v[28:31], v[196:199], a[192:195], v[28:31]
    buffer_load_dwordx4 v[192:195], v2, s[44:47], s67 offen offset:3072
    v_mfma_f32_16x16x32_bf16 v[32:35], v[196:199], a[196:199], v[32:35]
    v_mfma_f32_16x16x32_bf16 v[36:39], v[196:199], a[200:203], v[36:39]
    v_mfma_f32_16x16x32_bf16 v[40:43], v[196:199], a[204:207], v[40:43]
    s_waitcnt vmcnt(38)
    v_mfma_f32_16x16x32_bf16 v[28:31], v[200:203], a[208:211], v[28:31]
    s_add_u32 s67, s66, 12288
    buffer_load_dwordx4 v[196:199], v2, s[44:47], s67 offen offset:0
    v_mfma_f32_16x16x32_bf16 v[32:35], v[200:203], a[212:215], v[32:35]
    v_mfma_f32_16x16x32_bf16 v[36:39], v[200:203], a[216:219], v[36:39]
    v_mfma_f32_16x16x32_bf16 v[40:43], v[200:203], a[220:223], v[40:43]
    s_waitcnt vmcnt(38)
    v_mfma_f32_16x16x32_bf16 v[28:31], v[204:207], a[224:227], v[28:31]
    buffer_load_dwordx4 v[200:203], v2, s[44:47], s67 offen offset:1024
    v_mfma_f32_16x16x32_bf16 v[32:35], v[204:207], a[228:231], v[32:35]
    v_mfma_f32_16x16x32_bf16 v[36:39], v[204:207], a[232:235], v[36:39]
    v_mfma_f32_16x16x32_bf16 v[40:43], v[204:207], a[236:239], v[40:43]
    s_waitcnt vmcnt(38)
    v_mfma_f32_16x16x32_bf16 v[28:31], v[208:211], a[240:243], v[28:31]
    buffer_load_dwordx4 v[204:207], v2, s[44:47], s67 offen offset:2048
    v_mfma_f32_16x16x32_bf16 v[32:35], v[208:211], a[244:247], v[32:35]
    v_mfma_f32_16x16x32_bf16 v[36:39], v[208:211], a[248:251], v[36:39]
    v_mfma_f32_16x16x32_bf16 v[40:43], v[208:211], a[252:255], v[40:43]
    s_waitcnt vmcnt(38)
    v_mfma_f32_16x16x32_bf16 v[28:31], v[212:215], v[44:47], v[28:31]
    buffer_load_dwordx4 v[208:211], v2, s[44:47], s67 offen offset:3072
    v_mfma_f32_16x16x32_bf16 v[32:35], v[212:215], v[48:51], v[32:35]
    v_mfma_f32_16x16x32_bf16 v[36:39], v[212:215], v[52:55], v[36:39]
    v_mfma_f32_16x16x32_bf16 v[40:43], v[212:215], v[56:59], v[40:43]
    s_waitcnt vmcnt(38)
    v_mfma_f32_16x16x32_bf16 v[28:31], v[216:219], v[60:63], v[28:31]
    s_add_u32 s67, s66, 16384
    buffer_load_dwordx4 v[212:215], v2, s[44:47], s67 offen offset:0
    v_mfma_f32_16x16x32_bf16 v[32:35], v[216:219], v[64:67], v[32:35]
    v_mfma_f32_16x16x32_bf16 v[36:39], v[216:219], v[68:71], v[36:39]
    v_mfma_f32_16x16x32_bf16 v[40:43], v[216:219], v[72:75], v[40:43]
    s_add_u32 s9, s9, 1
    s_cmp_lt_u32 s9, 3
    s_cbranch_scc1 L_kg_ker_lp_29
    s_waitcnt vmcnt(31)
    s_add_u32 s76, s42, 40378368
    s_addc_u32 s77, s43, 0
    s_lshl_b32 s7, s4, 8
    v_mov_b32 v5, s7
    v_mov_b32 v6, 1
    s_mov_b64 exec, 1
    global_atomic_add v5, v6, s[76:77]
    s_mov_b64 exec, -1
    s_lshl_b32 s14, s13, 11
    s_add_u32 s14, s14, s10
    s_add_u32 s13, s13, 1
    s_cmp_eq_u32 s13, 9
    s_cselect_b32 s13, 0, s13
    v_mfma_f32_16x16x32_bf16 v[12:15], v[76:79], a[0:3], 0
    buffer_load_dwordx4 v[216:219], v2, s[44:47], s67 offen offset:1024
    v_mfma_f32_16x16x32_bf16 v[16:19], v[76:79], a[4:7], 0
    v_mfma_f32_16x16x32_bf16 v[20:23], v[76:79], a[8:11], 0
    v_mfma_f32_16x16x32_bf16 v[24:27], v[76:79], a[12:15], 0
    v_mfma_f32_16x16x32_bf16 v[12:15], v[80:83], a[16:19], v[12:15]
    s_add_u32 s65, s65, 1
    s_cmp_eq_u32 s65, 9
    s_cselect_b32 s65, 0, s65
    s_mul_i32 s66, s65, 18432
    s_add_u32 s66, s66, s64
    v_mfma_f32_16x16x32_bf16 v[16:19], v[80:83], a[20:23], v[16:19]
    v_cvt_pk_bf16_f32 v220, v28, v29
    v_mfma_f32_16x16x32_bf16 v[20:23], v[80:83], a[24:27], v[20:23]
    v_mfma_f32_16x16x32_bf16 v[24:27], v[80:83], a[28:31], v[24:27]
    v_cvt_pk_bf16_f32 v221, v30, v31
    v_mfma_f32_16x16x32_bf16 v[12:15], v[84:87], a[32:35], v[12:15]
    v_mfma_f32_16x16x32_bf16 v[16:19], v[84:87], a[36:39], v[16:19]
    v_cvt_pk_bf16_f32 v222, v32, v33
    v_mfma_f32_16x16x32_bf16 v[20:23], v[84:87], a[40:43], v[20:23]
    v_mfma_f32_16x16x32_bf16 v[24:27], v[84:87], a[44:47], v[24:27]
    v_mfma_f32_16x16x32_bf16 v[12:15], v[88:91], a[48:51], v[12:15]
    v_cvt_pk_bf16_f32 v223, v34, v35
    v_mfma_f32_16x16x32_bf16 v[16:19], v[88:91], a[52:55], v[16:19]
    v_mfma_f32_16x16x32_bf16 v[20:23], v[88:91], a[56:59], v[20:23]
    v_cvt_pk_bf16_f32 v224, v36, v37
    v_mfma_f32_16x16x32_bf16 v[24:27], v[88:91], a[60:63], v[24:27]
    v_mfma_f32_16x16x32_bf16 v[12:15], v[92:95], a[64:67], v[12:15]
    v_mfma_f32_16x16x32_bf16 v[16:19], v[92:95], a[68:71], v[16:19]
    v_cvt_pk_bf16_f32 v225, v38, v39
    v_mfma_f32_16x16x32_bf16 v[20:23], v[92:95], a[72:75], v[20:23]
    v_mfma_f32_16x16x32_bf16 v[24:27], v[92:95], a[76:79], v[24:27]
    v_cvt_pk_bf16_f32 v226, v40, v41
    v_mfma_f32_16x16x32_bf16 v[12:15], v[96:99], a[80:83], v[12:15]
    v_mfma_f32_16x16x32_bf16 v[16:19], v[96:99], a[84:87], v[16:19]
    v_cvt_pk_bf16_f32 v227, v42, v43
    v_mfma_f32_16x16x32_bf16 v[20:23], v[96:99], a[88:91], v[20:23]
    v_mfma_f32_16x16x32_bf16 v[24:27], v[96:99], a[92:95], v[24:27]
    s_waitcnt vmcnt(32)
    v_mfma_f32_16x16x32_bf16 v[12:15], v[100:103], a[96:99], v[12:15]
    buffer_store_dwordx4 v[220:223], v2, s[56:59], s15 offen sc1
    v_mfma_f32_16x16x32_bf16 v[16:19], v[100:103], a[100:103], v[16:19]
    v_mfma_f32_16x16x32_bf16 v[20:23], v[100:103], a[104:107], v[20:23]
    buffer_store_dwordx4 v[224:227], v2, s[56:59], s15 offen offset:1024 sc1
    v_mfma_f32_16x16x32_bf16 v[24:27], v[100:103], a[108:111], v[24:27]
    s_waitcnt vmcnt(33)
    v_mfma_f32_16x16x32_bf16 v[12:15], v[104:107], a[112:115], v[12:15]
    v_mfma_f32_16x16x32_bf16 v[16:19], v[104:107], a[116:119], v[16:19]
    v_mfma_f32_16x16x32_bf16 v[20:23], v[104:107], a[120:123], v[20:23]
    v_mfma_f32_16x16x32_bf16 v[24:27], v[104:107], a[124:127], v[24:27]
    s_waitcnt vmcnt(32)
    v_mfma_f32_16x16x32_bf16 v[12:15], v[108:111], a[128:131], v[12:15]
    v_mfma_f32_16x16x32_bf16 v[16:19], v[108:111], a[132:135], v[16:19]
    v_mfma_f32_16x16x32_bf16 v[20:23], v[108:111], a[136:139], v[20:23]
    v_mfma_f32_16x16x32_bf16 v[24:27], v[108:111], a[140:143], v[24:27]
    s_waitcnt vmcnt(31)
    v_mfma_f32_16x16x32_bf16 v[12:15], v[112:115], a[144:147], v[12:15]
    v_mfma_f32_16x16x32_bf16 v[16:19], v[112:115], a[148:151], v[16:19]
    v_mfma_f32_16x16x32_bf16 v[20:23], v[112:115], a[152:155], v[20:23]
    v_mfma_f32_16x16x32_bf16 v[24:27], v[112:115], a[156:159], v[24:27]
    s_waitcnt vmcnt(30)
    v_mfma_f32_16x16x32_bf16 v[12:15], v[116:119], a[160:163], v[12:15]
    v_mfma_f32_16x16x32_bf16 v[16:19], v[116:119], a[164:167], v[16:19]
    v_mfma_f32_16x16x32_bf16 v[20:23], v[116:119], a[168:171], v[20:23]
    v_mfma_f32_16x16x32_bf16 v[24:27], v[116:119], a[172:175], v[24:27]
    s_waitcnt vmcnt(29)
    v_mfma_f32_16x16x32_bf16 v[12:15], v[120:123], a[176:179], v[12:15]
    v_mfma_f32_16x16x32_bf16 v[16:19], v[120:123], a[180:183], v[16:19]
    v_mfma_f32_16x16x32_bf16 v[20:23], v[120:123], a[184:187], v[20:23]
    v_mfma_f32_16x16x32_bf16 v[24:27], v[120:123], a[188:191], v[24:27]
    s_waitcnt vmcnt(28)
    v_mfma_f32_16x16x32_bf16 v[12:15], v[124:127], a[192:195], v[12:15]
    v_mfma_f32_16x16x32_bf16 v[16:19], v[124:127], a[196:199], v[16:19]
    v_mfma_f32_16x16x32_bf16 v[20:23], v[124:127], a[200:203], v[20:23]
    v_mfma_f32_16x16x32_bf16 v[24:27], v[124:127], a[204:207], v[24:27]
    s_waitcnt vmcnt(27)
    v_mfma_f32_16x16x32_bf16 v[12:15], v[128:131], a[208:211], v[12:15]
    v_mfma_f32_16x16x32_bf16 v[16:19], v[128:131], a[212:215], v[16:19]
    v_mfma_f32_16x16x32_bf16 v[20:23], v[128:131], a[216:219], v[20:23]
    v_mfma_f32_16x16x32_bf16 v[24:27], v[128:131], a[220:223], v[24:27]
    s_waitcnt vmcnt(26)
    v_mfma_f32_16x16x32_bf16 v[12:15], v[132:135], a[224:227], v[12:15]
    v_mfma_f32_16x16x32_bf16 v[16:19], v[132:135], a[228:231], v[16:19]
    v_mfma_f32_16x16x32_bf16 v[20:23], v[132:135], a[232:235], v[20:23]
    v_mfma_f32_16x16x32_bf16 v[24:27], v[132:135], a[236:239], v[24:27]
    s_waitcnt vmcnt(25)
    v_mfma_f32_16x16x32_bf16 v[12:15], v[136:139], a[240:243], v[12:15]
    v_mfma_f32_16x16x32_bf16 v[16:19], v[136:139], a[244:247], v[16:19]
    v_mfma_f32_16x16x32_bf16 v[20:23], v[136:139], a[248:251], v[20:23]
    v_mfma_f32_16x16x32_bf16 v[24:27], v[136:139], a[252:255], v[24:27]
    s_waitcnt vmcnt(24)
    v_mfma_f32_16x16x32_bf16 v[12:15], v[140:143], v[44:47], v[12:15]
    v_mfma_f32_16x16x32_bf16 v[16:19], v[140:143], v[48:51], v[16:19]
    v_mfma_f32_16x16x32_bf16 v[20:23], v[140:143], v[52:55], v[20:23]
    v_mfma_f32_16x16x32_bf16 v[24:27], v[140:143], v[56:59], v[24:27]
    s_waitcnt vmcnt(23)
    v_mfma_f32_16x16x32_bf16 v[12:15], v[144:147], v[60:63], v[12:15]
    v_mfma_f32_16x16x32_bf16 v[16:19], v[144:147], v[64:67], v[16:19]
    v_mfma_f32_16x16x32_bf16 v[20:23], v[144:147], v[68:71], v[20:23]
    v_mfma_f32_16x16x32_bf16 v[24:27], v[144:147], v[72:75], v[24:27]
    s_lshl_b32 s15, s13, 11
    s_add_u32 s15, s15, s10
    s_add_u32 s13, s13, 1
    s_cmp_eq_u32 s13, 9
    s_cselect_b32 s13, 0, s13
    s_waitcnt vmcnt(22)
    v_mfma_f32_16x16x32_bf16 v[28:31], v[148:151], a[0:3], 0
    v_mfma_f32_16x16x32_bf16 v[32:35], v[148:151], a[4:7], 0
    v_mfma_f32_16x16x32_bf16 v[36:39], v[148:151], a[8:11], 0
    v_mfma_f32_16x16x32_bf16 v[40:43], v[148:151], a[12:15], 0
    s_waitcnt vmcnt(21)
    v_mfma_f32_16x16x32_bf16 v[28:31], v[152:155], a[16:19], v[28:31]
    v_mfma_f32_16x16x32_bf16 v[32:35], v[152:155], a[20:23], v[32:35]
    v_cvt_pk_bf16_f32 v220, v12, v13
    v_mfma_f32_16x16x32_bf16 v[36:39], v[152:155], a[24:27], v[36:39]
    v_mfma_f32_16x16x32_bf16 v[40:43], v[152:155], a[28:31], v[40:43]
    v_cvt_pk_bf16_f32 v221, v14, v15
    s_waitcnt vmcnt(20)
    v_mfma_f32_16x16x32_bf16 v[28:31], v[156:159], a[32:35], v[28:31]
    v_mfma_f32_16x16x32_bf16 v[32:35], v[156:159], a[36:39], v[32:35]
    v_cvt_pk_bf16_f32 v222, v16, v17
    v_mfma_f32_16x16x32_bf16 v[36:39], v[156:159], a[40:43], v[36:39]
    v_mfma_f32_16x16x32_bf16 v[40:43], v[156:159], a[44:47], v[40:43]
    s_waitcnt vmcnt(19)
    v_mfma_f32_16x16x32_bf16 v[28:31], v[160:163], a[48:51], v[28:31]
    v_cvt_pk_bf16_f32 v223, v18, v19
    v_mfma_f32_16x16x32_bf16 v[32:35], v[160:163], a[52:55], v[32:35]
    v_mfma_f32_16x16x32_bf16 v[36:39], v[160:163], a[56:59], v[36:39]
    v_cvt_pk_bf16_f32 v224, v20, v21
    v_mfma_f32_16x16x32_bf16 v[40:43], v[160:163], a[60:63], v[40:43]
    s_waitcnt vmcnt(18)
    v_mfma_f32_16x16x32_bf16 v[28:31], v[164:167], a[64:67], v[28:31]
    v_mfma_f32_16x16x32_bf16 v[32:35], v[164:167], a[68:71], v[32:35]
    v_cvt_pk_bf16_f32 v225, v22, v23
    v_mfma_f32_16x16x32_bf16 v[36:39], v[164:167], a[72:75], v[36:39]
    v_mfma_f32_16x16x32_bf16 v[40:43], v[164:167], a[76:79], v[40:43]
    v_cvt_pk_bf16_f32 v226, v24, v25
    s_waitcnt vmcnt(17)
    v_mfma_f32_16x16x32_bf16 v[28:31], v[168:171], a[80:83], v[28:31]
    v_mfma_f32_16x16x32_bf16 v[32:35], v[168:171], a[84:87], v[32:35]
    v_cvt_pk_bf16_f32 v227, v26, v27
    v_mfma_f32_16x16x32_bf16 v[36:39], v[168:171], a[88:91], v[36:39]
    v_mfma_f32_16x16x32_bf16 v[40:43], v[168:171], a[92:95], v[40:43]
    s_waitcnt vmcnt(14)
    v_mfma_f32_16x16x32_bf16 v[28:31], v[172:175], a[96:99], v[28:31]
    buffer_store_dwordx4 v[220:223], v2, s[56:59], s14 offen sc1
    v_mfma_f32_16x16x32_bf16 v[32:35], v[172:175], a[100:103], v[32:35]
    v_mfma_f32_16x16x32_bf16 v[36:39], v[172:175], a[104:107], v[36:39]
    buffer_store_dwordx4 v[224:227], v2, s[56:59], s14 offen offset:1024 sc1
    v_mfma_f32_16x16x32_bf16 v[40:43], v[172:175], a[108:111], v[40:43]
    s_waitcnt vmcnt(15)
    v_mfma_f32_16x16x32_bf16 v[28:31], v[176:179], a[112:115], v[28:31]
    v_mfma_f32_16x16x32_bf16 v[32:35], v[176:179], a[116:119], v[32:35]
    v_mfma_f32_16x16x32_bf16 v[36:39], v[176:179], a[120:123], v[36:39]
    v_mfma_f32_16x16x32_bf16 v[40:43], v[176:179], a[124:127], v[40:43]
    s_waitcnt vmcnt(14)
    v_mfma_f32_16x16x32_bf16 v[28:31], v[180:183], a[128:131], v[28:31]
    v_mfma_f32_16x16x32_bf16 v[32:35], v[180:183], a[132:135], v[32:35]
    v_mfma_f32_16x16x32_bf16 v[36:39], v[180:183], a[136:139], v[36:39]
    v_mfma_f32_16x16x32_bf16 v[40:43], v[180:183], a[140:143], v[40:43]
    s_waitcnt vmcnt(13)
    v_mfma_f32_16x16x32_bf16 v[28:31], v[184:187], a[144:147], v[28:31]
    v_mfma_f32_16x16x32_bf16 v[32:35], v[184:187], a[148:151], v[32:35]
    v_mfma_f32_16x16x32_bf16 v[36:39], v[184:187], a[152:155], v[36:39]
    v_mfma_f32_16x16x32_bf16 v[40:43], v[184:187], a[156:159], v[40:43]
    s_waitcnt vmcnt(12)
    v_mfma_f32_16x16x32_bf16 v[28:31], v[188:191], a[160:163], v[28:31]
    v_mfma_f32_16x16x32_bf16 v[32:35], v[188:191], a[164:167], v[32:35]
    v_mfma_f32_16x16x32_bf16 v[36:39], v[188:191], a[168:171], v[36:39]
    v_mfma_f32_16x16x32_bf16 v[40:43], v[188:191], a[172:175], v[40:43]
    s_waitcnt vmcnt(11)
    v_mfma_f32_16x16x32_bf16 v[28:31], v[192:195], a[176:179], v[28:31]
    v_mfma_f32_16x16x32_bf16 v[32:35], v[192:195], a[180:183], v[32:35]
    v_mfma_f32_16x16x32_bf16 v[36:39], v[192:195], a[184:187], v[36:39]
    v_mfma_f32_16x16x32_bf16 v[40:43], v[192:195], a[188:191], v[40:43]
    s_waitcnt vmcnt(10)
    v_mfma_f32_16x16x32_bf16 v[28:31], v[196:199], a[192:195], v[28:31]
    v_mfma_f32_16x16x32_bf16 v[32:35], v[196:199], a[196:199], v[32:35]
    v_mfma_f32_16x16x32_bf16 v[36:39], v[196:199], a[200:203], v[36:39]
    v_mfma_f32_16x16x32_bf16 v[40:43], v[196:199], a[204:207], v[40:43]
    s_waitcnt vmcnt(9)
    v_mfma_f32_16x16x32_bf16 v[28:31], v[200:203], a[208:211], v[28:31]
    v_mfma_f32_16x16x32_bf16 v[32:35], v[200:203], a[212:215], v[32:35]
    v_mfma_f32_16x16x32_bf16 v[36:39], v[200:203], a[216:219], v[36:39]
    v_mfma_f32_16x16x32_bf16 v[40:43], v[200:203], a[220:223], v[40:43]
    s_waitcnt vmcnt(8)
    v_mfma_f32_16x16x32_bf16 v[28:31], v[204:207], a[224:227], v[28:31]
    v_mfma_f32_16x16x32_bf16 v[32:35], v[204:207], a[228:231], v[32:35]
    v_mfma_f32_16x16x32_bf16 v[36:39], v[204:207], a[232:235], v[36:39]
    v_mfma_f32_16x16x32_bf16 v[40:43], v[204:207], a[236:239], v[40:43]
    s_waitcnt vmcnt(7)
    v_mfma_f32_16x16x32_bf16 v[28:31], v[208:211], a[240:243], v[28:31]
    v_mfma_f32_16x16x32_bf16 v[32:35], v[208:211], a[244:247], v[32:35]
    v_mfma_f32_16x16x32_bf16 v[36:39], v[208:211], a[248:251], v[36:39]
    v_mfma_f32_16x16x32_bf16 v[40:43], v[208:211], a[252:255], v[40:43]
    s_waitcnt vmcnt(6)
    v_mfma_f32_16x16x32_bf16 v[28:31], v[212:215], v[44:47], v[28:31]
    v_mfma_f32_16x16x32_bf16 v[32:35], v[212:215], v[48:51], v[32:35]
    v_mfma_f32_16x16x32_bf16 v[36:39], v[212:215], v[52:55], v[36:39]
    v_mfma_f32_16x16x32_bf16 v[40:43], v[212:215], v[56:59], v[40:43]
    s_waitcnt vmcnt(4)
    v_mfma_f32_16x16x32_bf16 v[28:31], v[216:219], v[60:63], v[28:31]
    v_mfma_f32_16x16x32_bf16 v[32:35], v[216:219], v[64:67], v[32:35]
    v_mfma_f32_16x16x32_bf16 v[36:39], v[216:219], v[68:71], v[36:39]
    v_mfma_f32_16x16x32_bf16 v[40:43], v[216:219], v[72:75], v[40:43]
    s_nop 4
    v_cvt_pk_bf16_f32 v220, v28, v29
    v_cvt_pk_bf16_f32 v221, v30, v31
    v_cvt_pk_bf16_f32 v222, v32, v33
    v_cvt_pk_bf16_f32 v223, v34, v35
    v_cvt_pk_bf16_f32 v224, v36, v37
    v_cvt_pk_bf16_f32 v225, v38, v39
    v_cvt_pk_bf16_f32 v226, v40, v41
    v_cvt_pk_bf16_f32 v227, v42, v43
    buffer_store_dwordx4 v[220:223], v2, s[56:59], s15 offen sc1
    buffer_store_dwordx4 v[224:227], v2, s[56:59], s15 offen offset:1024 sc1
    s_add_u32 s44, s42, 2375680
    s_addc_u32 s45, s43, 0
    s_mov_b32 s46, 2359296
    s_mov_b32 s47, 0x20000
    s_mov_b32 s52, s38
    s_mov_b32 s53, s39
    s_mov_b32 s54, 2359296
    s_mov_b32 s55, 0x20000
    v_mov_b32 v9, v5
    v_add_u32 v11, 24576, v5
    v_lshrrev_b32 v5, 1, v4
    v_lshlrev_b32 v5, 8, v5
    v_lshl_add_u32 v5, v3, 4, v5
    v_and_b32 v6, 1, v4
    v_lshl_add_u32 v5, v6, 3, v5
    v_mul_u32_u24 v6, 1152, v3
    v_lshl_add_u32 v6, v4, 3, v6
    v_add_u32 v7, 18432, v5
    v_add_u32 v8, 18432, v6
    s_mul_i32 s7, s3, 5
    s_add_u32 s7, s7, s6
    s_mul_i32 s8, s7, 26
    s_lshr_b32 s8, s8, 8
    s_mul_i32 s9, s8, 10
    s_sub_u32 s9, s7, s9
    s_lshr_b32 s9, s9, 1
    s_and_b32 s67, s7, 1
    s_add_u32 s9, s9, s5
    s_sub_u32 s12, s9, 9
    s_cmp_ge_u32 s9, 9
    s_cselect_b32 s9, s12, s9
    s_mul_i32 s8, s8, 9
    s_add_u32 s7, s8, s9
    s_mul_i32 s8, s4, 36
    s_add_u32 s8, s8, s7
    s_lshl_b32 s8, s8, 1
    s_add_u32 s8, s8, s67
    s_lshl_b32 s64, s8, 10
    s_lshl_b32 s8, s4, 1
    s_add_u32 s8, s8, s67
    s_mul_i32 s9, s8, 36864
    s_lshl_b32 s12, s7, 9
    s_add_u32 s65, s9, s12
    s_lshl_b32 s12, s7, 5
    s_add_u32 s66, s9, s12
    s_mul_i32 s7, s3, 5
    s_add_u32 s7, s7, 4
    s_mul_i32 s8, s7, 26
    s_lshr_b32 s8, s8, 8
    s_mul_i32 s9, s8, 10
    s_sub_u32 s9, s7, s9
    s_lshr_b32 s9, s9, 1
    s_and_b32 s71, s7, 1
    s_add_u32 s9, s9, s5
    s_sub_u32 s12, s9, 9
    s_cmp_ge_u32 s9, 9
    s_cselect_b32 s9, s12, s9
    s_mul_i32 s8, s8, 9
    s_add_u32 s7, s8, s9
    s_mul_i32 s8, s4, 36
    s_add_u32 s8, s8, s7
    s_lshl_b32 s8, s8, 1
    s_add_u32 s8, s8, s71
    s_lshl_b32 s68, s8, 10
    s_lshl_b32 s8, s4, 1
    s_add_u32 s8, s8, s71
    s_mul_i32 s9, s8, 36864
    s_lshl_b32 s12, s7, 9
    s_add_u32 s69, s9, s12
    s_lshl_b32 s12, s7, 5
    s_add_u32 s70, s9, s12
    s_lshl_b32 s7, s3, 2
    s_add_u32 s7, s7, s6
    s_lshr_b32 s8, s7, 3
    s_bfe_u32 s9, s7, 0x20001
    s_add_u32 s9, s9, 5
    s_and_b32 s75, s7, 1
    s_add_u32 s9, s9, s5
    s_sub_u32 s12, s9, 9
    s_cmp_ge_u32 s9, 9
    s_cselect_b32 s9, s12, s9
    s_mul_i32 s8, s8, 9
    s_add_u32 s7, s8, s9
    s_mul_i32 s8, s4, 36
    s_add_u32 s8, s8, s7
    s_lshl_b32 s8, s8, 1
    s_add_u32 s8, s8, s75
    s_lshl_b32 s72, s8, 10
    s_lshl_b32 s8, s4, 1
    s_add_u32 s8, s8, s75
    s_mul_i32 s9, s8, 36864
    s_lshl_b32 s12, s7, 9
    s_add_u32 s73, s9, s12
    s_lshl_b32 s12, s7, 5
    s_add_u32 s74, s9, s12
    s_mov_b32 s8, 0x00003f80
    s_mov_b32 s9, 0x3f800000
    s_waitcnt vmcnt(0)
    v_mov_b32 v10, 1
    s_mov_b64 exec, 1
    global_atomic_add v11, v10, s[76:77]
    s_mov_b64 exec, -1
    buffer_load_dwordx2 v[172:173], v5, s[48:51], s65 offen sc1
    buffer_load_dwordx2 v[184:185], v6, s[44:47], s66 offen sc1
    buffer_load_dwordx2 v[174:175], v7, s[48:51], s65 offen sc1
    buffer_load_dwordx2 v[186:187], v8, s[44:47], s66 offen sc1
    buffer_load_dwordx2 v[176:177], v5, s[48:51], s69 offen sc1
    buffer_load_dwordx2 v[188:189], v6, s[44:47], s70 offen sc1
    buffer_load_dwordx2 v[178:179], v7, s[48:51], s69 offen sc1
    buffer_load_dwordx2 v[190:191], v8, s[44:47], s70 offen sc1
    buffer_load_dwordx2 v[180:181], v5, s[48:51], s73 offen sc1
    buffer_load_dwordx2 v[192:193], v6, s[44:47], s74 offen sc1
    buffer_load_dwordx2 v[182:183], v7, s[48:51], s73 offen sc1
    buffer_load_dwordx2 v[194:195], v8, s[44:47], s74 offen sc1
    s_cmp_lg_u32 s6, 0
    s_cbranch_scc1 L_kg_ker_rwait_30
    s_mov_b64 exec, 1
    s_mov_b32 s12, 0
L_kg_ker_rpoll_31:
    global_load_dword v10, v9, s[76:77] sc1
    s_waitcnt vmcnt(0)
    v_readfirstlane_b32 s7, v10
    s_add_u32 s12, s12, 1
    s_cmp_ge_u32 s7, 32
    s_cbranch_scc1 L_kg_ker_rok_32
    s_sleep 2
    s_cmp_lt_u32 s12, 0x20000
    s_cbranch_scc1 L_kg_ker_rpoll_31
L_kg_ker_rok_32:
    s_mov_b64 exec, -1
L_kg_ker_rwait_30:
    s_barrier
    s_mov_b32 s7, s64
    buffer_load_dwordx4 v[76:79], v2, s[56:59], s7 offen sc1
    s_add_u32 s7, s7, 2359296
    buffer_load_dwordx4 v[80:83], v2, s[56:59], s7 offen sc1
    s_add_u32 s7, s7, 2359296
    buffer_load_dwordx4 v[84:87], v2, s[56:59], s7 offen sc1
    s_add_u32 s7, s7, 2359296
    buffer_load_dwordx4 v[88:91], v2, s[56:59], s7 offen sc1
    s_add_u32 s7, s7, 2359296
    buffer_load_dwordx4 v[92:95], v2, s[56:59], s7 offen sc1
    s_add_u32 s7, s7, 2359296
    buffer_load_dwordx4 v[96:99], v2, s[56:59], s7 offen sc1
    s_add_u32 s7, s7, 2359296
    buffer_load_dwordx4 v[100:103], v2, s[56:59], s7 offen sc1
    s_add_u32 s7, s7, 2359296
    buffer_load_dwordx4 v[104:107], v2, s[56:59], s7 offen sc1
    s_cmp_lg_u32 s6, 3
    s_cbranch_scc1 L_kg_ker_r3_33
    s_mov_b32 s7, s68
    buffer_load_dwordx4 v[108:111], v2, s[56:59], s7 offen sc1
    s_add_u32 s7, s7, 2359296
    buffer_load_dwordx4 v[112:115], v2, s[56:59], s7 offen sc1
    s_add_u32 s7, s7, 2359296
    buffer_load_dwordx4 v[116:119], v2, s[56:59], s7 offen sc1
    s_add_u32 s7, s7, 2359296
    buffer_load_dwordx4 v[120:123], v2, s[56:59], s7 offen sc1
    s_add_u32 s7, s7, 2359296
    buffer_load_dwordx4 v[124:127], v2, s[56:59], s7 offen sc1
    s_add_u32 s7, s7, 2359296
    buffer_load_dwordx4 v[128:131], v2, s[56:59], s7 offen sc1
    s_add_u32 s7, s7, 2359296
    buffer_load_dwordx4 v[132:135], v2, s[56:59], s7 offen sc1
    s_add_u32 s7, s7, 2359296
    buffer_load_dwordx4 v[136:139], v2, s[56:59], s7 offen sc1
L_kg_ker_r3_33:
    s_cmp_lg_u32 s6, 0
    s_cbranch_scc1 L_kg_ker_rwait_34
    s_mov_b64 exec, 1
    s_mov_b32 s12, 0
L_kg_ker_rpoll_35:
    global_load_dword v10, v11, s[76:77] sc1
    s_waitcnt vmcnt(0)
    v_readfirstlane_b32 s7, v10
    s_add_u32 s12, s12, 1
    s_cmp_ge_u32 s7, 32
    s_cbranch_scc1 L_kg_ker_rok_36
    s_sleep 2
    s_cmp_lt_u32 s12, 0x20000
    s_cbranch_scc1 L_kg_ker_rpoll_35
L_kg_ker_rok_36:
    s_mov_b64 exec, -1
L_kg_ker_rwait_34:
    s_barrier
    s_mov_b32 s7, s72
    buffer_load_dwordx4 v[140:143], v2, s[56:59], s7 offen sc1
    s_add_u32 s7, s7, 2359296
    buffer_load_dwordx4 v[144:147], v2, s[56:59], s7 offen sc1
    s_add_u32 s7, s7, 2359296
    buffer_load_dwordx4 v[148:151], v2, s[56:59], s7 offen sc1
    s_add_u32 s7, s7, 2359296
    buffer_load_dwordx4 v[152:155], v2, s[56:59], s7 offen sc1
    s_add_u32 s7, s7, 2359296
    buffer_load_dwordx4 v[156:159], v2, s[56:59], s7 offen sc1
    s_add_u32 s7, s7, 2359296
    buffer_load_dwordx4 v[160:163], v2, s[56:59], s7 offen sc1
    s_add_u32 s7, s7, 2359296
    buffer_load_dwordx4 v[164:167], v2, s[56:59], s7 offen sc1
    s_add_u32 s7, s7, 2359296
    buffer_load_dwordx4 v[168:171], v2, s[56:59], s7 offen sc1
    s_waitcnt vmcnt(8)
    v_dot2_f32_bf16 v12, v76, s8, 0
    v_dot2_f32_bf16 v13, v76, s9, 0
    v_dot2_f32_bf16 v14, v77, s8, 0
    v_dot2_f32_bf16 v15, v77, s9, 0
    v_dot2_f32_bf16 v16, v78, s8, 0
    v_dot2_f32_bf16 v17, v78, s9, 0
    v_dot2_f32_bf16 v18, v79, s8, 0
    v_dot2_f32_bf16 v19, v79, s9, 0
    v_dot2_f32_bf16 v12, v80, s8, v12
    v_dot2_f32_bf16 v13, v80, s9, v13
    v_dot2_f32_bf16 v14, v81, s8, v14
    v_dot2_f32_bf16 v15, v81, s9, v15
    v_dot2_f32_bf16 v16, v82, s8, v16
    v_dot2_f32_bf16 v17, v82, s9, v17
    v_dot2_f32_bf16 v18, v83, s8, v18
    v_dot2_f32_bf16 v19, v83, s9, v19
    v_dot2_f32_bf16 v12, v84, s8, v12
    v_dot2_f32_bf16 v13, v84, s9, v13
    v_dot2_f32_bf16 v14, v85, s8, v14
    v_dot2_f32_bf16 v15, v85, s9, v15
    v_dot2_f32_bf16 v16, v86, s8, v16
    v_dot2_f32_bf16 v17, v86, s9, v17
    v_dot2_f32_bf16 v18, v87, s8, v18
    v_dot2_f32_bf16 v19, v87, s9, v19
    v_dot2_f32_bf16 v12, v88, s8, v12
    v_dot2_f32_bf16 v13, v88, s9, v13
    v_dot2_f32_bf16 v14, v89, s8, v14
    v_dot2_f32_bf16 v15, v89, s9, v15
    v_dot2_f32_bf16 v16, v90, s8, v16
    v_dot2_f32_bf16 v17, v90, s9, v17
    v_dot2_f32_bf16 v18, v91, s8, v18
    v_dot2_f32_bf16 v19, v91, s9, v19
    v_dot2_f32_bf16 v12, v92, s8, v12
    v_dot2_f32_bf16 v13, v92, s9, v13
    v_dot2_f32_bf16 v14, v93, s8, v14
    v_dot2_f32_bf16 v15, v93, s9, v15
    v_dot2_f32_bf16 v16, v94, s8, v16
    v_dot2_f32_bf16 v17, v94, s9, v17
    v_dot2_f32_bf16 v18, v95, s8, v18
    v_dot2_f32_bf16 v19, v95, s9, v19
    v_dot2_f32_bf16 v12, v96, s8, v12
    v_dot2_f32_bf16 v13, v96, s9, v13
    v_dot2_f32_bf16 v14, v97, s8, v14
    v_dot2_f32_bf16 v15, v97, s9, v15
    v_dot2_f32_bf16 v16, v98, s8, v16
    v_dot2_f32_bf16 v17, v98, s9, v17
    v_dot2_f32_bf16 v18, v99, s8, v18
    v_dot2_f32_bf16 v19, v99, s9, v19
    v_dot2_f32_bf16 v12, v100, s8, v12
    v_dot2_f32_bf16 v13, v100, s9, v13
    v_dot2_f32_bf16 v14, v101, s8, v14
    v_dot2_f32_bf16 v15, v101, s9, v15
    v_dot2_f32_bf16 v16, v102, s8, v16
    v_dot2_f32_bf16 v17, v102, s9, v17
    v_dot2_f32_bf16 v18, v103, s8, v18
    v_dot2_f32_bf16 v19, v103, s9, v19
    v_dot2_f32_bf16 v12, v104, s8, v12
    v_dot2_f32_bf16 v13, v104, s9, v13
    v_dot2_f32_bf16 v14, v105, s8, v14
    v_dot2_f32_bf16 v15, v105, s9, v15
    v_dot2_f32_bf16 v16, v106, s8, v16
    v_dot2_f32_bf16 v17, v106, s9, v17
    v_dot2_f32_bf16 v18, v107, s8, v18
    v_dot2_f32_bf16 v19, v107, s9, v19
    s_cmp_eq_u32 s67, 1
    s_cselect_b64 vcc, -1, 0
    v_cndmask_b32 v24, v241, v245, vcc
    v_cndmask_b32 v25, v243, v247, vcc
    v_mul_f32 v12, v12, v24
    v_mul_f32 v13, v13, v24
    v_mul_f32 v14, v14, v24
    v_mul_f32 v15, v15, v24
    v_mul_f32 v16, v16, v25
    v_mul_f32 v17, v17, v25
    v_mul_f32 v18, v18, v25
    v_mul_f32 v19, v19, v25
    v_cvt_pk_bf16_f32 v20, v12, v13
    v_lshlrev_b32 v12, 16, v20
    v_and_b32 v13, 0xffff0000, v20
    v_dot2_f32_bf16 v12, v172, s8, v12
    v_dot2_f32_bf16 v13, v172, s9, v13
    v_cvt_pk_bf16_f32 v20, v14, v15
    v_lshlrev_b32 v14, 16, v20
    v_and_b32 v15, 0xffff0000, v20
    v_dot2_f32_bf16 v14, v173, s8, v14
    v_dot2_f32_bf16 v15, v173, s9, v15
    v_cvt_pk_bf16_f32 v20, v16, v17
    v_lshlrev_b32 v16, 16, v20
    v_and_b32 v17, 0xffff0000, v20
    v_dot2_f32_bf16 v16, v174, s8, v16
    v_dot2_f32_bf16 v17, v174, s9, v17
    v_cvt_pk_bf16_f32 v20, v18, v19
    v_lshlrev_b32 v18, 16, v20
    v_and_b32 v19, 0xffff0000, v20
    v_dot2_f32_bf16 v18, v175, s8, v18
    v_dot2_f32_bf16 v19, v175, s9, v19
    v_cvt_pk_bf16_f32 v20, v12, v13
    v_lshlrev_b32 v12, 16, v20
    v_and_b32 v13, 0xffff0000, v20
    v_dot2_f32_bf16 v12, v184, s8, v12
    v_dot2_f32_bf16 v13, v184, s9, v13
    v_cvt_pk_bf16_f32 v20, v14, v15
    v_lshlrev_b32 v14, 16, v20
    v_and_b32 v15, 0xffff0000, v20
    v_dot2_f32_bf16 v14, v185, s8, v14
    v_dot2_f32_bf16 v15, v185, s9, v15
    v_cvt_pk_bf16_f32 v20, v16, v17
    v_lshlrev_b32 v16, 16, v20
    v_and_b32 v17, 0xffff0000, v20
    v_dot2_f32_bf16 v16, v186, s8, v16
    v_dot2_f32_bf16 v17, v186, s9, v17
    v_cvt_pk_bf16_f32 v20, v18, v19
    v_lshlrev_b32 v18, 16, v20
    v_and_b32 v19, 0xffff0000, v20
    v_dot2_f32_bf16 v18, v187, s8, v18
    v_dot2_f32_bf16 v19, v187, s9, v19
    v_cvt_pk_bf16_f32 v184, v12, v13
    v_cvt_pk_bf16_f32 v185, v14, v15
    v_cvt_pk_bf16_f32 v186, v16, v17
    v_cvt_pk_bf16_f32 v187, v18, v19
    buffer_store_dwordx2 v[184:185], v6, s[52:55], s66 offen
    buffer_store_dwordx2 v[186:187], v8, s[52:55], s66 offen
    s_cmp_lg_u32 s6, 3
    s_cbranch_scc1 L_kg_ker_r4_37
    v_dot2_f32_bf16 v12, v108, s8, 0
    v_dot2_f32_bf16 v13, v108, s9, 0
    v_dot2_f32_bf16 v14, v109, s8, 0
    v_dot2_f32_bf16 v15, v109, s9, 0
    v_dot2_f32_bf16 v16, v110, s8, 0
    v_dot2_f32_bf16 v17, v110, s9, 0
    v_dot2_f32_bf16 v18, v111, s8, 0
    v_dot2_f32_bf16 v19, v111, s9, 0
    v_dot2_f32_bf16 v12, v112, s8, v12
    v_dot2_f32_bf16 v13, v112, s9, v13
    v_dot2_f32_bf16 v14, v113, s8, v14
    v_dot2_f32_bf16 v15, v113, s9, v15
    v_dot2_f32_bf16 v16, v114, s8, v16
    v_dot2_f32_bf16 v17, v114, s9, v17
    v_dot2_f32_bf16 v18, v115, s8, v18
    v_dot2_f32_bf16 v19, v115, s9, v19
    v_dot2_f32_bf16 v12, v116, s8, v12
    v_dot2_f32_bf16 v13, v116, s9, v13
    v_dot2_f32_bf16 v14, v117, s8, v14
    v_dot2_f32_bf16 v15, v117, s9, v15
    v_dot2_f32_bf16 v16, v118, s8, v16
    v_dot2_f32_bf16 v17, v118, s9, v17
    v_dot2_f32_bf16 v18, v119, s8, v18
    v_dot2_f32_bf16 v19, v119, s9, v19
    v_dot2_f32_bf16 v12, v120, s8, v12
    v_dot2_f32_bf16 v13, v120, s9, v13
    v_dot2_f32_bf16 v14, v121, s8, v14
    v_dot2_f32_bf16 v15, v121, s9, v15
    v_dot2_f32_bf16 v16, v122, s8, v16
    v_dot2_f32_bf16 v17, v122, s9, v17
    v_dot2_f32_bf16 v18, v123, s8, v18
    v_dot2_f32_bf16 v19, v123, s9, v19
    v_dot2_f32_bf16 v12, v124, s8, v12
    v_dot2_f32_bf16 v13, v124, s9, v13
    v_dot2_f32_bf16 v14, v125, s8, v14
    v_dot2_f32_bf16 v15, v125, s9, v15
    v_dot2_f32_bf16 v16, v126, s8, v16
    v_dot2_f32_bf16 v17, v126, s9, v17
    v_dot2_f32_bf16 v18, v127, s8, v18
    v_dot2_f32_bf16 v19, v127, s9, v19
    v_dot2_f32_bf16 v12, v128, s8, v12
    v_dot2_f32_bf16 v13, v128, s9, v13
    v_dot2_f32_bf16 v14, v129, s8, v14
    v_dot2_f32_bf16 v15, v129, s9, v15
    v_dot2_f32_bf16 v16, v130, s8, v16
    v_dot2_f32_bf16 v17, v130, s9, v17
    v_dot2_f32_bf16 v18, v131, s8, v18
    v_dot2_f32_bf16 v19, v131, s9, v19
    v_dot2_f32_bf16 v12, v132, s8, v12
    v_dot2_f32_bf16 v13, v132, s9, v13
    v_dot2_f32_bf16 v14, v133, s8, v14
    v_dot2_f32_bf16 v15, v133, s9, v15
    v_dot2_f32_bf16 v16, v134, s8, v16
    v_dot2_f32_bf16 v17, v134, s9, v17
    v_dot2_f32_bf16 v18, v135, s8, v18
    v_dot2_f32_bf16 v19, v135, s9, v19
    v_dot2_f32_bf16 v12, v136, s8, v12
    v_dot2_f32_bf16 v13, v136, s9, v13
    v_dot2_f32_bf16 v14, v137, s8, v14
    v_dot2_f32_bf16 v15, v137, s9, v15
    v_dot2_f32_bf16 v16, v138, s8, v16
    v_dot2_f32_bf16 v17, v138, s9, v17
    v_dot2_f32_bf16 v18, v139, s8, v18
    v_dot2_f32_bf16 v19, v139, s9, v19
    s_cmp_eq_u32 s71, 1
    s_cselect_b64 vcc, -1, 0
    v_cndmask_b32 v24, v241, v245, vcc
    v_cndmask_b32 v25, v243, v247, vcc
    v_mul_f32 v12, v12, v24
    v_mul_f32 v13, v13, v24
    v_mul_f32 v14, v14, v24
    v_mul_f32 v15, v15, v24
    v_mul_f32 v16, v16, v25
    v_mul_f32 v17, v17, v25
    v_mul_f32 v18, v18, v25
    v_mul_f32 v19, v19, v25
    v_cvt_pk_bf16_f32 v20, v12, v13
    v_lshlrev_b32 v12, 16, v20
    v_and_b32 v13, 0xffff0000, v20
    v_dot2_f32_bf16 v12, v176, s8, v12
    v_dot2_f32_bf16 v13, v176, s9, v13
    v_cvt_pk_bf16_f32 v20, v14, v15
    v_lshlrev_b32 v14, 16, v20
    v_and_b32 v15, 0xffff0000, v20
    v_dot2_f32_bf16 v14, v177, s8, v14
    v_dot2_f32_bf16 v15, v177, s9, v15
    v_cvt_pk_bf16_f32 v20, v16, v17
    v_lshlrev_b32 v16, 16, v20
    v_and_b32 v17, 0xffff0000, v20
    v_dot2_f32_bf16 v16, v178, s8, v16
    v_dot2_f32_bf16 v17, v178, s9, v17
    v_cvt_pk_bf16_f32 v20, v18, v19
    v_lshlrev_b32 v18, 16, v20
    v_and_b32 v19, 0xffff0000, v20
    v_dot2_f32_bf16 v18, v179, s8, v18
    v_dot2_f32_bf16 v19, v179, s9, v19
    v_cvt_pk_bf16_f32 v20, v12, v13
    v_lshlrev_b32 v12, 16, v20
    v_and_b32 v13, 0xffff0000, v20
    v_dot2_f32_bf16 v12, v188, s8, v12
    v_dot2_f32_bf16 v13, v188, s9, v13
    v_cvt_pk_bf16_f32 v20, v14, v15
    v_lshlrev_b32 v14, 16, v20
    v_and_b32 v15, 0xffff0000, v20
    v_dot2_f32_bf16 v14, v189, s8, v14
    v_dot2_f32_bf16 v15, v189, s9, v15
    v_cvt_pk_bf16_f32 v20, v16, v17
    v_lshlrev_b32 v16, 16, v20
    v_and_b32 v17, 0xffff0000, v20
    v_dot2_f32_bf16 v16, v190, s8, v16
    v_dot2_f32_bf16 v17, v190, s9, v17
    v_cvt_pk_bf16_f32 v20, v18, v19
    v_lshlrev_b32 v18, 16, v20
    v_and_b32 v19, 0xffff0000, v20
    v_dot2_f32_bf16 v18, v191, s8, v18
    v_dot2_f32_bf16 v19, v191, s9, v19
    v_cvt_pk_bf16_f32 v188, v12, v13
    v_cvt_pk_bf16_f32 v189, v14, v15
    v_cvt_pk_bf16_f32 v190, v16, v17
    v_cvt_pk_bf16_f32 v191, v18, v19
    buffer_store_dwordx2 v[188:189], v6, s[52:55], s70 offen
    buffer_store_dwordx2 v[190:191], v8, s[52:55], s70 offen
L_kg_ker_r4_37:
    s_waitcnt vmcnt(0)
    v_dot2_f32_bf16 v12, v140, s8, 0
    v_dot2_f32_bf16 v13, v140, s9, 0
    v_dot2_f32_bf16 v14, v141, s8, 0
    v_dot2_f32_bf16 v15, v141, s9, 0
    v_dot2_f32_bf16 v16, v142, s8, 0
    v_dot2_f32_bf16 v17, v142, s9, 0
    v_dot2_f32_bf16 v18, v143, s8, 0
    v_dot2_f32_bf16 v19, v143, s9, 0
    v_dot2_f32_bf16 v12, v144, s8, v12
    v_dot2_f32_bf16 v13, v144, s9, v13
    v_dot2_f32_bf16 v14, v145, s8, v14
    v_dot2_f32_bf16 v15, v145, s9, v15
    v_dot2_f32_bf16 v16, v146, s8, v16
    v_dot2_f32_bf16 v17, v146, s9, v17
    v_dot2_f32_bf16 v18, v147, s8, v18
    v_dot2_f32_bf16 v19, v147, s9, v19
    v_dot2_f32_bf16 v12, v148, s8, v12
    v_dot2_f32_bf16 v13, v148, s9, v13
    v_dot2_f32_bf16 v14, v149, s8, v14
    v_dot2_f32_bf16 v15, v149, s9, v15
    v_dot2_f32_bf16 v16, v150, s8, v16
    v_dot2_f32_bf16 v17, v150, s9, v17
    v_dot2_f32_bf16 v18, v151, s8, v18
    v_dot2_f32_bf16 v19, v151, s9, v19
    v_dot2_f32_bf16 v12, v152, s8, v12
    v_dot2_f32_bf16 v13, v152, s9, v13
    v_dot2_f32_bf16 v14, v153, s8, v14
    v_dot2_f32_bf16 v15, v153, s9, v15
    v_dot2_f32_bf16 v16, v154, s8, v16
    v_dot2_f32_bf16 v17, v154, s9, v17
    v_dot2_f32_bf16 v18, v155, s8, v18
    v_dot2_f32_bf16 v19, v155, s9, v19
    v_dot2_f32_bf16 v12, v156, s8, v12
    v_dot2_f32_bf16 v13, v156, s9, v13
    v_dot2_f32_bf16 v14, v157, s8, v14
    v_dot2_f32_bf16 v15, v157, s9, v15
    v_dot2_f32_bf16 v16, v158, s8, v16
    v_dot2_f32_bf16 v17, v158, s9, v17
    v_dot2_f32_bf16 v18, v159, s8, v18
    v_dot2_f32_bf16 v19, v159, s9, v19
    v_dot2_f32_bf16 v12, v160, s8, v12
    v_dot2_f32_bf16 v13, v160, s9, v13
    v_dot2_f32_bf16 v14, v161, s8, v14
    v_dot2_f32_bf16 v15, v161, s9, v15
    v_dot2_f32_bf16 v16, v162, s8, v16
    v_dot2_f32_bf16 v17, v162, s9, v17
    v_dot2_f32_bf16 v18, v163, s8, v18
    v_dot2_f32_bf16 v19, v163, s9, v19
    v_dot2_f32_bf16 v12, v164, s8, v12
    v_dot2_f32_bf16 v13, v164, s9, v13
    v_dot2_f32_bf16 v14, v165, s8, v14
    v_dot2_f32_bf16 v15, v165, s9, v15
    v_dot2_f32_bf16 v16, v166, s8, v16
    v_dot2_f32_bf16 v17, v166, s9, v17
    v_dot2_f32_bf16 v18, v167, s8, v18
    v_dot2_f32_bf16 v19, v167, s9, v19
    v_dot2_f32_bf16 v12, v168, s8, v12
    v_dot2_f32_bf16 v13, v168, s9, v13
    v_dot2_f32_bf16 v14, v169, s8, v14
    v_dot2_f32_bf16 v15, v169, s9, v15
    v_dot2_f32_bf16 v16, v170, s8, v16
    v_dot2_f32_bf16 v17, v170, s9, v17
    v_dot2_f32_bf16 v18, v171, s8, v18
    v_dot2_f32_bf16 v19, v171, s9, v19
    s_cmp_eq_u32 s75, 1
    s_cselect_b64 vcc, -1, 0
    v_cndmask_b32 v24, v241, v245, vcc
    v_cndmask_b32 v25, v243, v247, vcc
    v_mul_f32 v12, v12, v24
    v_mul_f32 v13, v13, v24
    v_mul_f32 v14, v14, v24
    v_mul_f32 v15, v15, v24
    v_mul_f32 v16, v16, v25
    v_mul_f32 v17, v17, v25
    v_mul_f32 v18, v18, v25
    v_mul_f32 v19, v19, v25
    v_cvt_pk_bf16_f32 v20, v12, v13
    v_lshlrev_b32 v12, 16, v20
    v_and_b32 v13, 0xffff0000, v20
    v_dot2_f32_bf16 v12, v180, s8, v12
    v_dot2_f32_bf16 v13, v180, s9, v13
    v_cvt_pk_bf16_f32 v20, v14, v15
    v_lshlrev_b32 v14, 16, v20
    v_and_b32 v15, 0xffff0000, v20
    v_dot2_f32_bf16 v14, v181, s8, v14
    v_dot2_f32_bf16 v15, v181, s9, v15
    v_cvt_pk_bf16_f32 v20, v16, v17
    v_lshlrev_b32 v16, 16, v20
    v_and_b32 v17, 0xffff0000, v20
    v_dot2_f32_bf16 v16, v182, s8, v16
    v_dot2_f32_bf16 v17, v182, s9, v17
    v_cvt_pk_bf16_f32 v20, v18, v19
    v_lshlrev_b32 v18, 16, v20
    v_and_b32 v19, 0xffff0000, v20
    v_dot2_f32_bf16 v18, v183, s8, v18
    v_dot2_f32_bf16 v19, v183, s9, v19
    v_cvt_pk_bf16_f32 v20, v12, v13
    v_lshlrev_b32 v12, 16, v20
    v_and_b32 v13, 0xffff0000, v20
    v_dot2_f32_bf16 v12, v192, s8, v12
    v_dot2_f32_bf16 v13, v192, s9, v13
    v_cvt_pk_bf16_f32 v20, v14, v15
    v_lshlrev_b32 v14, 16, v20
    v_and_b32 v15, 0xffff0000, v20
    v_dot2_f32_bf16 v14, v193, s8, v14
    v_dot2_f32_bf16 v15, v193, s9, v15
    v_cvt_pk_bf16_f32 v20, v16, v17
    v_lshlrev_b32 v16, 16, v20
    v_and_b32 v17, 0xffff0000, v20
    v_dot2_f32_bf16 v16, v194, s8, v16
    v_dot2_f32_bf16 v17, v194, s9, v17
    v_cvt_pk_bf16_f32 v20, v18, v19
    v_lshlrev_b32 v18, 16, v20
    v_and_b32 v19, 0xffff0000, v20
    v_dot2_f32_bf16 v18, v195, s8, v18
    v_dot2_f32_bf16 v19, v195, s9, v19
    v_cvt_pk_bf16_f32 v192, v12, v13
    v_cvt_pk_bf16_f32 v193, v14, v15
    v_cvt_pk_bf16_f32 v194, v16, v17
    v_cvt_pk_bf16_f32 v195, v18, v19
    buffer_store_dwordx2 v[192:193], v6, s[52:55], s74 offen
    buffer_store_dwordx2 v[194:195], v8, s[52:55], s74 offen
L_kg_ker_exit_1:
    s_endpgm
L_code_end:

.section .rodata,"a"
.p2align 6
.amdhsa_kernel ka_kernel
  .amdhsa_next_free_vgpr 256
  .amdhsa_next_free_sgpr 96
  .amdhsa_accum_offset 128
  .amdhsa_group_segment_fixed_size 0
  .amdhsa_kernarg_size 112
  .amdhsa_user_sgpr_count 2
  .amdhsa_user_sgpr_kernarg_segment_ptr 1
  .amdhsa_system_sgpr_workgroup_id_x 1
  .amdhsa_float_denorm_mode_32 3
  .amdhsa_float_denorm_mode_16_64 3
.end_amdhsa_kernel

.p2align 6
.amdhsa_kernel kg_kernel
  .amdhsa_next_free_vgpr 512
  .amdhsa_next_free_sgpr 80
  .amdhsa_accum_offset 256
  .amdhsa_group_segment_fixed_size 0
  .amdhsa_kernarg_size 112
  .amdhsa_user_sgpr_count 2
  .amdhsa_user_sgpr_kernarg_segment_ptr 1
  .amdhsa_system_sgpr_workgroup_id_x 1
  .amdhsa_float_denorm_mode_32 3
  .amdhsa_float_denorm_mode_16_64 3
.end_amdhsa_kernel
```
